```python
import torch

def _softmax(x, axis=-1):
    return torch.softmax(x, dim=axis)

def _gelu(x):
    return torch.nn.functional.gelu(x, approximate='tanh')

def _silu(x):
    return torch.nn.functional.silu(x)

def _sigmoid(x):
    return torch.sigmoid(x)

def _layernorm(x, axis=-1, eps=1e-05):
    m = x.mean(dim=axis, keepdim=True)
    v = x.var(dim=axis, keepdim=True, unbiased=False)
    return (x - m) / torch.sqrt(v + eps)

def _scatter_add(tgt, idx, src, axis=0):
    return tgt.clone().index_add_(axis, idx, src)

def _segment_sum(src, seg, n):
    out = torch.zeros((n,) + src.shape[1:], dtype=src.dtype)
    return out.index_add_(0, seg, src)

def _pad(x, pw):
    flat = tuple((v for pair in reversed(pw) for v in pair))
    return torch.nn.functional.pad(x, flat)
kernel_name = 'adaLN_cond__memory_aug_recurrent_mem_tr__mixer_token_mlp__prompt'

def setup_inputs():

    _w = lambda a: (lambda t: t.to(torch.bfloat16) if t.is_floating_point() else t)(torch.as_tensor(a))

    def _A_setup():
        B, S, Dm = (1, 2048, 512)
        H, Dh = (32, 128)
        M, seg = (8, 32)
        seg = min(seg, S)
        S = S // seg * seg
        return {'x': _w((lambda *s: torch.randn(*s, dtype=torch.bfloat16) * 0.05)(B, S, Dm)), 'mem0': _w((lambda *s: torch.randn(*s, dtype=torch.bfloat16) * 0.4)(B, M, Dm)), 'Wq': _w((lambda *s: torch.randn(*s, dtype=torch.bfloat16) * 1.6)(Dm, H, Dh) * Dm ** (-0.5)), 'Wk': _w((lambda *s: torch.randn(*s, dtype=torch.bfloat16) * 1.6)(Dm, H, Dh) * Dm ** (-0.5)), 'Wv': _w((lambda *s: torch.randn(*s, dtype=torch.bfloat16) * 0.4)(Dm, H, Dh) * Dm ** (-0.5)), 'Wo': _w((lambda *s: torch.randn(*s, dtype=torch.bfloat16) * 0.4)(H, Dh, Dm) * (H * Dh) ** (-0.5)), 'seg_len': seg}
    _A_in = _A_setup()

    def _B_setup():
        B, S, D, F = (1, 2048, 512, 1792)
        return {'x': _w((lambda *s: torch.randn(*s, dtype=torch.bfloat16) * 0.05)(B, S, D)), 'w1': _w((lambda *s: torch.randn(*s, dtype=torch.bfloat16) * 0.8)(S, F) * S ** (-0.5)), 'b1': _w((lambda *s: torch.randn(*s, dtype=torch.bfloat16) * 12.8)(F) * 0.02), 'w2': _w((lambda *s: torch.randn(*s, dtype=torch.bfloat16) * 0.2)(F, S) * F ** (-0.5)), 'b2': _w((lambda *s: torch.randn(*s, dtype=torch.bfloat16) * 1.6)(S) * 0.02)}
    _B_in = _B_setup()
    return {'A_x': _A_in['x'], 'A_mem0': _A_in['mem0'], 'A_Wq': _A_in['Wq'], 'A_Wk': _A_in['Wk'], 'A_Wv': _A_in['Wv'], 'A_Wo': _A_in['Wo'], 'A_seg_len': _A_in['seg_len'], 'B_x': _B_in['x'], 'B_w1': _B_in['w1'], 'B_b1': _B_in['b1'], 'B_w2': _B_in['w2'], 'B_b2': _B_in['b2'], 'c': _w((lambda *s: torch.randn(*s, dtype=torch.bfloat16) * 0.1)(1, 512) * 8.0), 'w_mod': _w((lambda *s: torch.randn(*s, dtype=torch.bfloat16) * 0.1)(512, 6 * 512) * 512 ** (-0.5) * 8.0)}

def reference(A_x, A_mem0, A_Wq, A_Wk, A_Wv, A_Wo, A_seg_len, B_x, B_w1, B_b1, B_w2, B_b2, c, w_mod):

    def _A_ref(x, mem0, Wq, Wk, Wv, Wo, seg_len):
        B, S, Dm = x.shape
        H, Dh = (Wq.shape[1], Wq.shape[2])
        M = mem0.shape[1]
        scale = Dh ** (-0.5)
        n_seg = S // seg_len
        L = M + seg_len
        idx = torch.arange(L)
        mask = (idx[:, None] < M) | (idx[:, None] >= idx[None, :])
        mem = mem0
        outs = []
        for s in range(n_seg):
            xs = x[:, s * seg_len:(s + 1) * seg_len, :].clone()
            h = torch.concatenate([mem, xs], axis=1)
            q = torch.einsum('btd,dhe->bhte', h, Wq)
            k = torch.einsum('btd,dhe->bhte', h, Wk)
            v = torch.einsum('btd,dhe->bhte', h, Wv)
            scores = torch.einsum('bhqe,bhke->bhqk', q, k) * scale
            scores = torch.where(mask[None, None], scores, -1000000000.0)
            p = _softmax(scores, axis=-1)
            o = torch.einsum('bhqk,bhke->bhqe', p, v)
            o = torch.einsum('bhte,hed->btd', o, Wo)
            mem = o[:, :M, :].clone()
            outs.append(o[:, M:, :])
        return torch.concatenate(outs, axis=1)

    def _B_ref(x, w1, b1, w2, b2):
        B, S, D = x.shape
        h = _layernorm(x, axis=-1)
        u = torch.einsum('bsd,sf->bdf', h, w1) + b1
        u = _gelu(u)
        y = torch.einsum('bdf,fs->bds', u, w2) + b2
        return (lambda x, *d: x.permute(*d))(y, 0, 2, 1)
    x = A_x
    mod = (_silu(c) @ w_mod).reshape(c.shape[0], 6, 1, -1)
    sa, ca, ga, sb, cb, gb = (mod[:, 0].clone(), mod[:, 1].clone(), mod[:, 2].clone(), mod[:, 3].clone(), mod[:, 4].clone(), mod[:, 5].clone())
    h = _layernorm(x, axis=-1) * (1 + ca) + sa
    x = x + ga * _A_ref(h, A_mem0, A_Wq, A_Wk, A_Wv, A_Wo, A_seg_len)
    h = _layernorm(x, axis=-1) * (1 + cb) + sb
    x = x + gb * _B_ref(h, B_w1, B_b1, B_w2, B_b2)
    return x
```

```asm
; @launch kernel=mega_kernel grid=(256,1,1) block=(256,1,1) lds=163840
.amdgcn_target "amdgcn-amd-amdhsa--gfx950"
.text
    .globl mega_kernel
    .p2align 8
    .type mega_kernel,@function
mega_kernel:
    s_cmp_ge_u32 s2, 256
    s_cbranch_scc1 mega_kernel_exit
    s_load_dwordx16 s[16:31], s[0:1], 0
    s_load_dwordx16 s[32:47], s[0:1], 64
    s_load_dwordx2 s[48:49], s[0:1], 128
    s_waitcnt lgkmcnt(0)
    s_mov_b32 s52, s48
    s_and_b32 s53, s49, 0xffff
    s_mov_b32 s54, 0x10000000
    s_mov_b32 s55, 0x00020000
    s_mov_b32 s3, s2
    s_mov_b32 s60, s46
    s_and_b32 s61, s47, 0xffff
    s_mov_b32 s62, 0x100
    s_mov_b32 s63, 0x00020000
    v_lshrrev_b32 v1, 6, v0
    s_nop 0
    v_readfirstlane_b32 s4, v1
    s_nop 3
    s_cmp_lg_u32 s4, 0
    s_cbranch_scc1 AR_skip_1
    s_mov_b64 exec, 1
    s_getreg_b32 s8, hwreg(HW_REG_XCC_ID, 0, 4)
    v_mov_b32 v2, 0
    s_cmp_lg_u32 s8, 0
    s_cbranch_scc1 AR_wt_2
    v_mov_b32 v1, 1
    buffer_atomic_add v1, v2, s[60:63], 0 offen offset:0 sc0
    s_waitcnt vmcnt(0)
    v_readfirstlane_b32 s9, v1
    s_nop 0
    s_or_b32 s10, s9, 0x100
    s_cmp_lt_u32 s9, 32
    s_cbranch_scc1 AR_st_3
AR_wt_2:
    v_mov_b32 v1, 1
    buffer_atomic_add v1, v2, s[60:63], 0 offen offset:4 sc0
    s_waitcnt vmcnt(0)
    v_readfirstlane_b32 s9, v1
    s_nop 0
    s_add_u32 s10, s9, 0x1000
    s_cmp_lt_u32 s9, 224
    s_cbranch_scc1 AR_st_3
    s_sub_u32 s10, 255, s9
    s_and_b32 s10, s10, 31
AR_st_3:
    v_mov_b32 v1, s10
    ds_write_b32 v2, v1
    s_waitcnt lgkmcnt(0)
    s_mov_b64 exec, -1
AR_skip_1:
    s_barrier
    v_mov_b32 v2, 0
    ds_read_b32 v1, v2
    s_waitcnt lgkmcnt(0)
    v_readfirstlane_b32 s3, v1
    s_barrier
    s_lshr_b32 s76, s3, 8
    s_and_b32 s76, s76, 1
    s_mov_b32 s79, 0
    s_cmp_ge_u32 s3, 0x1000
    s_cbranch_scc1 WORKER_4
    s_and_b32 s3, s3, 31
    s_add_u32 s100, s3, 224
    s_mov_b32 s14, 63
    v_lshrrev_b32 v1, 6, v0
    s_nop 0
    v_readfirstlane_b32 s4, v1
    s_nop 3
    v_and_b32 v1, 63, v0
    v_and_b32 v2, 15, v1
    v_lshrrev_b32 v3, 4, v1
    v_lshrrev_b32 v4, 2, v2
    v_and_b32 v5, 3, v2
    v_lshrrev_b32 v6, 1, v3
    v_and_b32 v7, 1, v3
    v_lshlrev_b32 v112, 4, v1
    v_lshlrev_b32 v8, 4, v6
    v_lshl_add_u32 v8, v7, 2, v8
    v_add_u32 v8, v8, v4
    v_lshlrev_b32 v8, 5, v8
    v_lshl_add_u32 v113, v5, 3, v8
    s_lshl_b32 s6, s4, 5
    v_add_u32 v8, s6, v2
    v_lshlrev_b32 v8, 5, v8
    v_lshl_add_u32 v114, v3, 3, v8
    s_lshl_b32 s6, s4, 9
    v_and_b32 v8, 1, v2
    v_lshl_add_u32 v8, v4, 1, v8
    v_lshl_add_u32 v8, v8, 1, v6
    v_lshlrev_b32 v8, 4, v8
    v_lshl_add_u32 v8, v7, 3, v8
    v_and_b32 v9, 2, v2
    v_lshl_add_u32 v8, v9, 10, v8
    v_add_u32 v115, s6, v8
    v_lshlrev_b32 v8, 2, v1
    v_and_b32 v116, 127, v8
    s_lshl_b32 s6, s4, 2
    v_add_u32 v8, s6, v4
    v_lshlrev_b32 v8, 13, v8
    v_lshl_add_u32 v9, v3, 2, v5
    v_lshl_add_u32 v117, v9, 4, v8
    v_lshlrev_b32 v8, 5, v9
    v_lshl_add_u32 v8, v4, 3, v8
    v_lshl_add_u32 v118, v6, 30, v8
    s_mul_i32 s6, s4, 36864
    s_add_u32 s6, s6, 16384
    v_add_u32 v119, s6, v112
    v_mov_b32 v8, 0x4444
    v_mov_b32 v9, 0xeeee
    v_and_b32 v10, 1, v2
    v_cmp_eq_u32 vcc, 0, v10
    s_nop 1
    v_cndmask_b32 v120, v9, v8, vcc
    s_mov_b32 s56, s18
    s_and_b32 s57, s19, 0xffff
    s_mov_b32 s58, 0x2000
    s_mov_b32 s59, 0x00020000
    v_lshlrev_b32 v8, 5, v0
    buffer_load_dwordx4 v[104:107], v8, s[56:59], 0 offen
    buffer_load_dwordx4 v[108:111], v8, s[56:59], 0 offen offset:16
    s_lshl_b32 s6, s4, 4
    v_add_u32 v8, s6, v3
    v_lshlrev_b32 v8, 13, v8
    v_lshl_add_u32 v8, v2, 4, v8
    s_lshl_b32 s6, s3, 8
    v_add_u32 v121, s6, v8
    s_lshl_b32 s6, s4, 3
    v_add_u32 v8, s6, v6
    v_lshlrev_b32 v8, 10, v8
    v_and_b32 v9, 31, v1
    v_lshl_add_u32 v8, v9, 4, v8
    s_lshl_b32 s6, s3, 17
    v_add_u32 v122, s6, v8
    v_lshlrev_b32 v8, 4, v7
    v_lshl_add_u32 v8, v6, 3, v8
    v_lshrrev_b32 v9, 1, v4
    v_lshl_add_u32 v8, v9, 2, v8
    v_and_b32 v10, 1, v4
    v_add_u32 v8, v8, v10
    v_lshlrev_b32 v8, 8, v8
    v_lshl_add_u32 v8, v5, 3, v8
    v_lshlrev_b32 v11, 2, v7
    v_lshl_add_u32 v11, v9, 1, v11
    v_add_u32 v11, v11, v10
    s_lshl_b32 s6, s4, 1
    v_xor_b32 v11, s6, v11
    v_lshl_add_u32 v123, v11, 5, v8
    v_xor_b32 v127, 32, v123
    v_lshlrev_b32 v8, 4, v6
    v_lshl_add_u32 v8, v7, 2, v8
    v_lshl_add_u32 v8, v9, 3, v8
    v_add_u32 v8, v8, v10
    v_lshlrev_b32 v8, 9, v8
    v_lshl_add_u32 v8, v5, 5, v8
    s_lshl_b32 s6, s4, 7
    v_add_u32 v8, s6, v8
    v_lshlrev_b32 v11, 7, v7
    v_lshl_add_u32 v11, v10, 4, v11
    v_xor_b32 v124, v8, v11
    v_xor_b32 v1, 16, v124
    s_lshl_b32 s6, s4, 12
    v_add_u32 v8, s6, v112
    s_and_b32 s6, s4, 1
    s_lshl_b32 s6, s6, 7
    v_lshl_add_u32 v11, v7, 5, s6
    v_xor_b32 v125, v8, v11
    v_xor_b32 v2, 64, v125
    v_lshlrev_b32 v11, 4, v6
    v_xor_b32 v3, v8, v11
    v_xor_b32 v4, 0x80, v3
    s_mov_b32 s56, s20
    s_and_b32 s57, s21, 0xffff
    s_mov_b32 s58, 0x400000
    s_mov_b32 s59, 0x00020000
    s_mov_b32 s64, s22
    s_and_b32 s65, s23, 0xffff
    s_mov_b32 s66, 0x400000
    s_mov_b32 s67, 0x00020000
    s_mov_b32 s68, s24
    s_and_b32 s69, s25, 0xffff
    s_mov_b32 s70, 0x400000
    s_mov_b32 s71, 0x00020000
    s_mov_b32 s72, s26
    s_and_b32 s73, s27, 0xffff
    s_mov_b32 s74, 0x400000
    s_mov_b32 s75, 0x00020000
    s_mov_b32 s6, 1048576
    buffer_load_dwordx4 v[8:11], v121, s[68:71], s6 offen
    s_mov_b32 s6, 1081344
    buffer_load_dwordx4 v[12:15], v121, s[68:71], s6 offen
    s_mov_b32 s6, 1114112
    buffer_load_dwordx4 v[16:19], v121, s[68:71], s6 offen
    s_mov_b32 s6, 1146880
    buffer_load_dwordx4 v[20:23], v121, s[68:71], s6 offen
    s_mov_b32 s6, 2097152
    buffer_load_dwordx4 v[24:27], v121, s[68:71], s6 offen
    s_mov_b32 s6, 2129920
    buffer_load_dwordx4 v[28:31], v121, s[68:71], s6 offen
    s_mov_b32 s6, 2162688
    buffer_load_dwordx4 v[32:35], v121, s[68:71], s6 offen
    s_mov_b32 s6, 2195456
    buffer_load_dwordx4 v[36:39], v121, s[68:71], s6 offen
    s_mov_b32 s6, 3145728
    buffer_load_dwordx4 v[40:43], v121, s[68:71], s6 offen
    s_mov_b32 s6, 3178496
    buffer_load_dwordx4 v[44:47], v121, s[68:71], s6 offen
    s_mov_b32 s6, 3211264
    buffer_load_dwordx4 v[48:51], v121, s[68:71], s6 offen
    s_mov_b32 s6, 3244032
    buffer_load_dwordx4 v[52:55], v121, s[68:71], s6 offen
    s_mov_b32 s6, 0
    buffer_load_dwordx4 v[56:59], v122, s[72:75], s6 offen
    s_mov_b32 s6, 2048
    buffer_load_dwordx4 v[60:63], v122, s[72:75], s6 offen
    s_mov_b32 s6, 4096
    buffer_load_dwordx4 v[64:67], v122, s[72:75], s6 offen
    s_mov_b32 s6, 6144
    buffer_load_dwordx4 v[68:71], v122, s[72:75], s6 offen
    s_mov_b32 s6, 32768
    buffer_load_dwordx4 v[72:75], v122, s[72:75], s6 offen
    s_mov_b32 s6, 34816
    buffer_load_dwordx4 v[76:79], v122, s[72:75], s6 offen
    s_mov_b32 s6, 36864
    buffer_load_dwordx4 v[80:83], v122, s[72:75], s6 offen
    s_mov_b32 s6, 38912
    buffer_load_dwordx4 v[84:87], v122, s[72:75], s6 offen
    s_mov_b32 s6, 524288
    buffer_load_dwordx4 a[0:3], v121, s[56:59], s6 offen
    s_mov_b32 s6, 557056
    buffer_load_dwordx4 a[4:7], v121, s[56:59], s6 offen
    s_mov_b32 s6, 589824
    buffer_load_dwordx4 a[8:11], v121, s[56:59], s6 offen
    s_mov_b32 s6, 622592
    buffer_load_dwordx4 a[12:15], v121, s[56:59], s6 offen
    s_mov_b32 s6, 1048576
    buffer_load_dwordx4 a[16:19], v121, s[56:59], s6 offen
    s_mov_b32 s6, 1081344
    buffer_load_dwordx4 a[20:23], v121, s[56:59], s6 offen
    s_mov_b32 s6, 1114112
    buffer_load_dwordx4 a[24:27], v121, s[56:59], s6 offen
    s_mov_b32 s6, 1146880
    buffer_load_dwordx4 a[28:31], v121, s[56:59], s6 offen
    s_mov_b32 s6, 1572864
    buffer_load_dwordx4 a[32:35], v121, s[56:59], s6 offen
    s_mov_b32 s6, 1605632
    buffer_load_dwordx4 a[36:39], v121, s[56:59], s6 offen
    s_mov_b32 s6, 1638400
    buffer_load_dwordx4 a[40:43], v121, s[56:59], s6 offen
    s_mov_b32 s6, 1671168
    buffer_load_dwordx4 a[44:47], v121, s[56:59], s6 offen
    s_mov_b32 s6, 2097152
    buffer_load_dwordx4 a[48:51], v121, s[56:59], s6 offen
    s_mov_b32 s6, 2129920
    buffer_load_dwordx4 a[52:55], v121, s[56:59], s6 offen
    s_mov_b32 s6, 2162688
    buffer_load_dwordx4 a[56:59], v121, s[56:59], s6 offen
    s_mov_b32 s6, 2195456
    buffer_load_dwordx4 a[60:63], v121, s[56:59], s6 offen
    s_mov_b32 s6, 2621440
    buffer_load_dwordx4 a[64:67], v121, s[56:59], s6 offen
    s_mov_b32 s6, 2654208
    buffer_load_dwordx4 a[68:71], v121, s[56:59], s6 offen
    s_mov_b32 s6, 2686976
    buffer_load_dwordx4 a[72:75], v121, s[56:59], s6 offen
    s_mov_b32 s6, 2719744
    buffer_load_dwordx4 a[76:79], v121, s[56:59], s6 offen
    s_mov_b32 s6, 3145728
    buffer_load_dwordx4 a[80:83], v121, s[56:59], s6 offen
    s_mov_b32 s6, 3178496
    buffer_load_dwordx4 a[84:87], v121, s[56:59], s6 offen
    s_mov_b32 s6, 3211264
    buffer_load_dwordx4 a[88:91], v121, s[56:59], s6 offen
    s_mov_b32 s6, 3244032
    buffer_load_dwordx4 a[92:95], v121, s[56:59], s6 offen
    s_mov_b32 s6, 0
    buffer_load_dwordx4 a[96:99], v121, s[64:67], s6 offen
    s_mov_b32 s6, 32768
    buffer_load_dwordx4 a[100:103], v121, s[64:67], s6 offen
    s_mov_b32 s6, 65536
    buffer_load_dwordx4 a[104:107], v121, s[64:67], s6 offen
    s_mov_b32 s6, 98304
    buffer_load_dwordx4 a[108:111], v121, s[64:67], s6 offen
    s_mov_b32 s6, 524288
    buffer_load_dwordx4 a[112:115], v121, s[64:67], s6 offen
    s_mov_b32 s6, 557056
    buffer_load_dwordx4 a[116:119], v121, s[64:67], s6 offen
    s_mov_b32 s6, 589824
    buffer_load_dwordx4 a[120:123], v121, s[64:67], s6 offen
    s_mov_b32 s6, 622592
    buffer_load_dwordx4 a[124:127], v121, s[64:67], s6 offen
    s_mov_b32 s6, 1048576
    buffer_load_dwordx4 a[128:131], v121, s[64:67], s6 offen
    s_mov_b32 s6, 1081344
    buffer_load_dwordx4 a[132:135], v121, s[64:67], s6 offen
    s_mov_b32 s6, 1114112
    buffer_load_dwordx4 a[136:139], v121, s[64:67], s6 offen
    s_mov_b32 s6, 1146880
    buffer_load_dwordx4 a[140:143], v121, s[64:67], s6 offen
    s_waitcnt vmcnt(52)
    ds_write_b128 v125, v[8:11] offset:0
    ds_write_b128 v2, v[12:15] offset:1024
    ds_write_b128 v125, v[16:19] offset:2048
    ds_write_b128 v2, v[20:23] offset:3072
    s_waitcnt lgkmcnt(0)
    s_barrier
    ds_read_b64_tr_b16 v[8:9], v123 offset:0
    ds_read_b64_tr_b16 v[10:11], v123 offset:512
    ds_read_b64_tr_b16 v[12:13], v123 offset:8192
    ds_read_b64_tr_b16 v[14:15], v123 offset:8704
    ds_read_b64_tr_b16 v[16:17], v127 offset:0
    ds_read_b64_tr_b16 v[18:19], v127 offset:512
    ds_read_b64_tr_b16 v[20:21], v127 offset:8192
    ds_read_b64_tr_b16 v[22:23], v127 offset:8704
    s_waitcnt lgkmcnt(0)
    ds_write_b128 v119, v[8:11] offset:16384
    ds_write_b128 v119, v[12:15] offset:17408
    ds_write_b128 v119, v[16:19] offset:18432
    ds_write_b128 v119, v[20:23] offset:19456
    s_waitcnt lgkmcnt(0)
    s_mov_b32 s6, 2097152
    buffer_load_dwordx4 a[144:147], v121, s[64:67], s6 offen
    s_mov_b32 s6, 2129920
    buffer_load_dwordx4 a[148:151], v121, s[64:67], s6 offen
    s_mov_b32 s6, 2162688
    buffer_load_dwordx4 a[152:155], v121, s[64:67], s6 offen
    s_mov_b32 s6, 2195456
    buffer_load_dwordx4 a[156:159], v121, s[64:67], s6 offen
    s_waitcnt vmcnt(52)
    ds_write_b128 v125, v[24:27] offset:16384
    ds_write_b128 v2, v[28:31] offset:17408
    ds_write_b128 v125, v[32:35] offset:18432
    ds_write_b128 v2, v[36:39] offset:19456
    s_waitcnt lgkmcnt(0)
    s_barrier
    ds_read_b64_tr_b16 v[24:25], v123 offset:16384
    ds_read_b64_tr_b16 v[26:27], v123 offset:16896
    ds_read_b64_tr_b16 v[28:29], v123 offset:24576
    ds_read_b64_tr_b16 v[30:31], v123 offset:25088
    ds_read_b64_tr_b16 v[32:33], v127 offset:16384
    ds_read_b64_tr_b16 v[34:35], v127 offset:16896
    ds_read_b64_tr_b16 v[36:37], v127 offset:24576
    ds_read_b64_tr_b16 v[38:39], v127 offset:25088
    s_waitcnt lgkmcnt(0)
    ds_write_b128 v119, v[24:27] offset:20480
    ds_write_b128 v119, v[28:31] offset:21504
    ds_write_b128 v119, v[32:35] offset:22528
    ds_write_b128 v119, v[36:39] offset:23552
    s_waitcnt lgkmcnt(0)
    s_mov_b32 s6, 2621440
    buffer_load_dwordx4 a[160:163], v121, s[64:67], s6 offen
    s_mov_b32 s6, 2654208
    buffer_load_dwordx4 a[164:167], v121, s[64:67], s6 offen
    s_mov_b32 s6, 2686976
    buffer_load_dwordx4 a[168:171], v121, s[64:67], s6 offen
    s_mov_b32 s6, 2719744
    buffer_load_dwordx4 a[172:175], v121, s[64:67], s6 offen
    s_waitcnt vmcnt(52)
    ds_write_b128 v125, v[40:43] offset:0
    ds_write_b128 v2, v[44:47] offset:1024
    ds_write_b128 v125, v[48:51] offset:2048
    ds_write_b128 v2, v[52:55] offset:3072
    s_waitcnt lgkmcnt(0)
    s_barrier
    ds_read_b64_tr_b16 v[40:41], v123 offset:0
    ds_read_b64_tr_b16 v[42:43], v123 offset:512
    ds_read_b64_tr_b16 v[44:45], v123 offset:8192
    ds_read_b64_tr_b16 v[46:47], v123 offset:8704
    ds_read_b64_tr_b16 v[48:49], v127 offset:0
    ds_read_b64_tr_b16 v[50:51], v127 offset:512
    ds_read_b64_tr_b16 v[52:53], v127 offset:8192
    ds_read_b64_tr_b16 v[54:55], v127 offset:8704
    s_waitcnt lgkmcnt(0)
    ds_write_b128 v119, v[40:43] offset:24576
    ds_write_b128 v119, v[44:47] offset:25600
    ds_write_b128 v119, v[48:51] offset:26624
    ds_write_b128 v119, v[52:55] offset:27648
    s_waitcnt lgkmcnt(0)
    s_mov_b32 s6, 3145728
    buffer_load_dwordx4 a[176:179], v121, s[64:67], s6 offen
    s_mov_b32 s6, 3178496
    buffer_load_dwordx4 a[180:183], v121, s[64:67], s6 offen
    s_mov_b32 s6, 3211264
    buffer_load_dwordx4 a[184:187], v121, s[64:67], s6 offen
    s_mov_b32 s6, 3244032
    buffer_load_dwordx4 a[188:191], v121, s[64:67], s6 offen
    s_waitcnt vmcnt(52)
    ds_write_b128 v3, v[56:59] offset:16384
    ds_write_b128 v3, v[60:63] offset:17408
    ds_write_b128 v4, v[64:67] offset:18432
    ds_write_b128 v4, v[68:71] offset:19456
    s_waitcnt lgkmcnt(0)
    s_barrier
    ds_read_b64_tr_b16 v[56:57], v124 offset:16384
    ds_read_b64_tr_b16 v[58:59], v124 offset:17408
    ds_read_b64_tr_b16 v[60:61], v124 offset:16392
    ds_read_b64_tr_b16 v[62:63], v124 offset:17416
    ds_read_b64_tr_b16 v[64:65], v1 offset:16384
    ds_read_b64_tr_b16 v[66:67], v1 offset:17408
    ds_read_b64_tr_b16 v[68:69], v1 offset:16392
    ds_read_b64_tr_b16 v[70:71], v1 offset:17416
    s_waitcnt lgkmcnt(0)
    ds_write_b128 v119, v[56:59] offset:28672
    ds_write_b128 v119, v[60:63] offset:30720
    ds_write_b128 v119, v[64:67] offset:32768
    ds_write_b128 v119, v[68:71] offset:34816
    s_waitcnt lgkmcnt(0)
    s_mov_b32 s6, 3670016
    buffer_load_dwordx4 a[192:195], v121, s[64:67], s6 offen
    s_mov_b32 s6, 3702784
    buffer_load_dwordx4 a[196:199], v121, s[64:67], s6 offen
    s_mov_b32 s6, 3735552
    buffer_load_dwordx4 a[200:203], v121, s[64:67], s6 offen
    s_mov_b32 s6, 3768320
    buffer_load_dwordx4 a[204:207], v121, s[64:67], s6 offen
    s_waitcnt vmcnt(52)
    ds_write_b128 v3, v[72:75] offset:0
    ds_write_b128 v3, v[76:79] offset:1024
    ds_write_b128 v4, v[80:83] offset:2048
    ds_write_b128 v4, v[84:87] offset:3072
    s_waitcnt lgkmcnt(0)
    s_barrier
    ds_read_b64_tr_b16 v[72:73], v124 offset:0
    ds_read_b64_tr_b16 v[74:75], v124 offset:1024
    ds_read_b64_tr_b16 v[76:77], v124 offset:8
    ds_read_b64_tr_b16 v[78:79], v124 offset:1032
    ds_read_b64_tr_b16 v[80:81], v1 offset:0
    ds_read_b64_tr_b16 v[82:83], v1 offset:1024
    ds_read_b64_tr_b16 v[84:85], v1 offset:8
    ds_read_b64_tr_b16 v[86:87], v1 offset:1032
    s_waitcnt lgkmcnt(0)
    ds_write_b128 v119, v[72:75] offset:29696
    ds_write_b128 v119, v[76:79] offset:31744
    ds_write_b128 v119, v[80:83] offset:33792
    ds_write_b128 v119, v[84:87] offset:35840
    s_waitcnt lgkmcnt(0)
    s_mov_b32 s6, 524288
    buffer_load_dwordx4 a[208:211], v121, s[68:71], s6 offen
    s_mov_b32 s6, 557056
    buffer_load_dwordx4 a[212:215], v121, s[68:71], s6 offen
    s_mov_b32 s6, 589824
    buffer_load_dwordx4 a[216:219], v121, s[68:71], s6 offen
    s_mov_b32 s6, 622592
    buffer_load_dwordx4 a[220:223], v121, s[68:71], s6 offen
    s_waitcnt vmcnt(52)
    ds_write_b128 v125, a[0:3] offset:16384
    ds_write_b128 v2, a[4:7] offset:17408
    ds_write_b128 v125, a[8:11] offset:18432
    ds_write_b128 v2, a[12:15] offset:19456
    s_waitcnt lgkmcnt(0)
    s_barrier
    ds_read_b64_tr_b16 a[0:1], v123 offset:16384
    ds_read_b64_tr_b16 a[2:3], v123 offset:16896
    ds_read_b64_tr_b16 a[4:5], v123 offset:24576
    ds_read_b64_tr_b16 a[6:7], v123 offset:25088
    ds_read_b64_tr_b16 a[8:9], v127 offset:16384
    ds_read_b64_tr_b16 a[10:11], v127 offset:16896
    ds_read_b64_tr_b16 a[12:13], v127 offset:24576
    ds_read_b64_tr_b16 a[14:15], v127 offset:25088
    s_mov_b32 s6, 1572864
    buffer_load_dwordx4 a[224:227], v121, s[68:71], s6 offen
    s_mov_b32 s6, 1605632
    buffer_load_dwordx4 a[228:231], v121, s[68:71], s6 offen
    s_mov_b32 s6, 1638400
    buffer_load_dwordx4 a[232:235], v121, s[68:71], s6 offen
    s_mov_b32 s6, 1671168
    buffer_load_dwordx4 a[236:239], v121, s[68:71], s6 offen
    s_waitcnt vmcnt(52)
    ds_write_b128 v125, a[16:19] offset:0
    ds_write_b128 v2, a[20:23] offset:1024
    ds_write_b128 v125, a[24:27] offset:2048
    ds_write_b128 v2, a[28:31] offset:3072
    s_waitcnt lgkmcnt(0)
    s_barrier
    ds_read_b64_tr_b16 a[16:17], v123 offset:0
    ds_read_b64_tr_b16 a[18:19], v123 offset:512
    ds_read_b64_tr_b16 a[20:21], v123 offset:8192
    ds_read_b64_tr_b16 a[22:23], v123 offset:8704
    ds_read_b64_tr_b16 a[24:25], v127 offset:0
    ds_read_b64_tr_b16 a[26:27], v127 offset:512
    ds_read_b64_tr_b16 a[28:29], v127 offset:8192
    ds_read_b64_tr_b16 a[30:31], v127 offset:8704
    s_mov_b32 s6, 2621440
    buffer_load_dwordx4 v[128:131], v121, s[68:71], s6 offen
    s_mov_b32 s6, 2654208
    buffer_load_dwordx4 v[132:135], v121, s[68:71], s6 offen
    s_mov_b32 s6, 2686976
    buffer_load_dwordx4 v[136:139], v121, s[68:71], s6 offen
    s_mov_b32 s6, 2719744
    buffer_load_dwordx4 v[140:143], v121, s[68:71], s6 offen
    s_waitcnt vmcnt(52)
    ds_write_b128 v125, a[32:35] offset:16384
    ds_write_b128 v2, a[36:39] offset:17408
    ds_write_b128 v125, a[40:43] offset:18432
    ds_write_b128 v2, a[44:47] offset:19456
    s_waitcnt lgkmcnt(0)
    s_barrier
    ds_read_b64_tr_b16 a[32:33], v123 offset:16384
    ds_read_b64_tr_b16 a[34:35], v123 offset:16896
    ds_read_b64_tr_b16 a[36:37], v123 offset:24576
    ds_read_b64_tr_b16 a[38:39], v123 offset:25088
    ds_read_b64_tr_b16 a[40:41], v127 offset:16384
    ds_read_b64_tr_b16 a[42:43], v127 offset:16896
    ds_read_b64_tr_b16 a[44:45], v127 offset:24576
    ds_read_b64_tr_b16 a[46:47], v127 offset:25088
    s_mov_b32 s6, 3670016
    buffer_load_dwordx4 v[144:147], v121, s[68:71], s6 offen
    s_mov_b32 s6, 3702784
    buffer_load_dwordx4 v[148:151], v121, s[68:71], s6 offen
    s_mov_b32 s6, 3735552
    buffer_load_dwordx4 v[152:155], v121, s[68:71], s6 offen
    s_mov_b32 s6, 3768320
    buffer_load_dwordx4 v[156:159], v121, s[68:71], s6 offen
    s_waitcnt vmcnt(52)
    ds_write_b128 v125, a[48:51] offset:0
    ds_write_b128 v2, a[52:55] offset:1024
    ds_write_b128 v125, a[56:59] offset:2048
    ds_write_b128 v2, a[60:63] offset:3072
    s_waitcnt lgkmcnt(0)
    s_barrier
    ds_read_b64_tr_b16 a[48:49], v123 offset:0
    ds_read_b64_tr_b16 a[50:51], v123 offset:512
    ds_read_b64_tr_b16 a[52:53], v123 offset:8192
    ds_read_b64_tr_b16 a[54:55], v123 offset:8704
    ds_read_b64_tr_b16 a[56:57], v127 offset:0
    ds_read_b64_tr_b16 a[58:59], v127 offset:512
    ds_read_b64_tr_b16 a[60:61], v127 offset:8192
    ds_read_b64_tr_b16 a[62:63], v127 offset:8704
    s_mov_b32 s6, 65536
    buffer_load_dwordx4 v[160:163], v122, s[72:75], s6 offen
    s_mov_b32 s6, 67584
    buffer_load_dwordx4 v[168:171], v122, s[72:75], s6 offen
    s_mov_b32 s6, 69632
    buffer_load_dwordx4 v[176:179], v122, s[72:75], s6 offen
    s_mov_b32 s6, 71680
    buffer_load_dwordx4 v[184:187], v122, s[72:75], s6 offen
    s_waitcnt vmcnt(52)
    ds_write_b128 v125, a[64:67] offset:16384
    ds_write_b128 v2, a[68:71] offset:17408
    ds_write_b128 v125, a[72:75] offset:18432
    ds_write_b128 v2, a[76:79] offset:19456
    s_waitcnt lgkmcnt(0)
    s_barrier
    ds_read_b64_tr_b16 a[64:65], v123 offset:16384
    ds_read_b64_tr_b16 a[66:67], v123 offset:16896
    ds_read_b64_tr_b16 a[68:69], v123 offset:24576
    ds_read_b64_tr_b16 a[70:71], v123 offset:25088
    ds_read_b64_tr_b16 a[72:73], v127 offset:16384
    ds_read_b64_tr_b16 a[74:75], v127 offset:16896
    ds_read_b64_tr_b16 a[76:77], v127 offset:24576
    ds_read_b64_tr_b16 a[78:79], v127 offset:25088
    s_mov_b32 s6, 98304
    buffer_load_dwordx4 v[164:167], v122, s[72:75], s6 offen
    s_mov_b32 s6, 100352
    buffer_load_dwordx4 v[172:175], v122, s[72:75], s6 offen
    s_mov_b32 s6, 102400
    buffer_load_dwordx4 v[180:183], v122, s[72:75], s6 offen
    s_mov_b32 s6, 104448
    buffer_load_dwordx4 v[188:191], v122, s[72:75], s6 offen
    s_waitcnt vmcnt(52)
    ds_write_b128 v125, a[80:83] offset:0
    ds_write_b128 v2, a[84:87] offset:1024
    ds_write_b128 v125, a[88:91] offset:2048
    ds_write_b128 v2, a[92:95] offset:3072
    s_waitcnt lgkmcnt(0)
    s_barrier
    ds_read_b64_tr_b16 a[80:81], v123 offset:0
    ds_read_b64_tr_b16 a[82:83], v123 offset:512
    ds_read_b64_tr_b16 a[84:85], v123 offset:8192
    ds_read_b64_tr_b16 a[86:87], v123 offset:8704
    ds_read_b64_tr_b16 a[88:89], v127 offset:0
    ds_read_b64_tr_b16 a[90:91], v127 offset:512
    ds_read_b64_tr_b16 a[92:93], v127 offset:8192
    ds_read_b64_tr_b16 a[94:95], v127 offset:8704
    s_mov_b32 s6, 512
    buffer_load_dwordx4 v[192:195], v122, s[72:75], s6 offen
    s_mov_b32 s6, 2560
    buffer_load_dwordx4 v[200:203], v122, s[72:75], s6 offen
    s_mov_b32 s6, 4608
    buffer_load_dwordx4 v[208:211], v122, s[72:75], s6 offen
    s_mov_b32 s6, 6656
    buffer_load_dwordx4 v[216:219], v122, s[72:75], s6 offen
    s_waitcnt vmcnt(52)
    ds_write_b128 v125, a[96:99] offset:16384
    ds_write_b128 v2, a[100:103] offset:17408
    ds_write_b128 v125, a[104:107] offset:18432
    ds_write_b128 v2, a[108:111] offset:19456
    s_waitcnt lgkmcnt(0)
    s_barrier
    ds_read_b64_tr_b16 a[96:97], v123 offset:16384
    ds_read_b64_tr_b16 a[98:99], v123 offset:16896
    ds_read_b64_tr_b16 a[100:101], v123 offset:24576
    ds_read_b64_tr_b16 a[102:103], v123 offset:25088
    ds_read_b64_tr_b16 a[104:105], v127 offset:16384
    ds_read_b64_tr_b16 a[106:107], v127 offset:16896
    ds_read_b64_tr_b16 a[108:109], v127 offset:24576
    ds_read_b64_tr_b16 a[110:111], v127 offset:25088
    s_mov_b32 s6, 33280
    buffer_load_dwordx4 v[196:199], v122, s[72:75], s6 offen
    s_mov_b32 s6, 35328
    buffer_load_dwordx4 v[204:207], v122, s[72:75], s6 offen
    s_mov_b32 s6, 37376
    buffer_load_dwordx4 v[212:215], v122, s[72:75], s6 offen
    s_mov_b32 s6, 39424
    buffer_load_dwordx4 v[220:223], v122, s[72:75], s6 offen
    s_waitcnt vmcnt(52)
    ds_write_b128 v125, a[112:115] offset:0
    ds_write_b128 v2, a[116:119] offset:1024
    ds_write_b128 v125, a[120:123] offset:2048
    ds_write_b128 v2, a[124:127] offset:3072
    s_waitcnt lgkmcnt(0)
    s_barrier
    ds_read_b64_tr_b16 a[112:113], v123 offset:0
    ds_read_b64_tr_b16 a[114:115], v123 offset:512
    ds_read_b64_tr_b16 a[116:117], v123 offset:8192
    ds_read_b64_tr_b16 a[118:119], v123 offset:8704
    ds_read_b64_tr_b16 a[120:121], v127 offset:0
    ds_read_b64_tr_b16 a[122:123], v127 offset:512
    ds_read_b64_tr_b16 a[124:125], v127 offset:8192
    ds_read_b64_tr_b16 a[126:127], v127 offset:8704
    s_mov_b32 s6, 66048
    buffer_load_dwordx4 v[224:227], v122, s[72:75], s6 offen
    s_mov_b32 s6, 68096
    buffer_load_dwordx4 v[232:235], v122, s[72:75], s6 offen
    s_mov_b32 s6, 70144
    buffer_load_dwordx4 v[240:243], v122, s[72:75], s6 offen
    s_mov_b32 s6, 72192
    buffer_load_dwordx4 v[248:251], v122, s[72:75], s6 offen
    s_waitcnt vmcnt(52)
    ds_write_b128 v125, a[128:131] offset:16384
    ds_write_b128 v2, a[132:135] offset:17408
    ds_write_b128 v125, a[136:139] offset:18432
    ds_write_b128 v2, a[140:143] offset:19456
    s_waitcnt lgkmcnt(0)
    s_barrier
    ds_read_b64_tr_b16 a[128:129], v123 offset:16384
    ds_read_b64_tr_b16 a[130:131], v123 offset:16896
    ds_read_b64_tr_b16 a[132:133], v123 offset:24576
    ds_read_b64_tr_b16 a[134:135], v123 offset:25088
    ds_read_b64_tr_b16 a[136:137], v127 offset:16384
    ds_read_b64_tr_b16 a[138:139], v127 offset:16896
    ds_read_b64_tr_b16 a[140:141], v127 offset:24576
    ds_read_b64_tr_b16 a[142:143], v127 offset:25088
    s_mov_b32 s6, 98816
    buffer_load_dwordx4 v[228:231], v122, s[72:75], s6 offen
    s_mov_b32 s6, 100864
    buffer_load_dwordx4 v[236:239], v122, s[72:75], s6 offen
    s_mov_b32 s6, 102912
    buffer_load_dwordx4 v[244:247], v122, s[72:75], s6 offen
    s_mov_b32 s6, 104960
    buffer_load_dwordx4 v[252:255], v122, s[72:75], s6 offen
    s_waitcnt vmcnt(52)
    ds_write_b128 v125, a[144:147] offset:0
    ds_write_b128 v2, a[148:151] offset:1024
    ds_write_b128 v125, a[152:155] offset:2048
    ds_write_b128 v2, a[156:159] offset:3072
    s_waitcnt lgkmcnt(0)
    s_barrier
    ds_read_b64_tr_b16 a[144:145], v123 offset:0
    ds_read_b64_tr_b16 a[146:147], v123 offset:512
    ds_read_b64_tr_b16 a[148:149], v123 offset:8192
    ds_read_b64_tr_b16 a[150:151], v123 offset:8704
    ds_read_b64_tr_b16 a[152:153], v127 offset:0
    ds_read_b64_tr_b16 a[154:155], v127 offset:512
    ds_read_b64_tr_b16 a[156:157], v127 offset:8192
    ds_read_b64_tr_b16 a[158:159], v127 offset:8704
    s_mov_b32 s6, 0
    buffer_load_dwordx4 v[8:11], v121, s[56:59], s6 offen
    s_mov_b32 s6, 32768
    buffer_load_dwordx4 v[12:15], v121, s[56:59], s6 offen
    s_mov_b32 s6, 65536
    buffer_load_dwordx4 v[16:19], v121, s[56:59], s6 offen
    s_mov_b32 s6, 98304
    buffer_load_dwordx4 v[20:23], v121, s[56:59], s6 offen
    s_waitcnt vmcnt(52)
    ds_write_b128 v125, a[160:163] offset:16384
    ds_write_b128 v2, a[164:167] offset:17408
    ds_write_b128 v125, a[168:171] offset:18432
    ds_write_b128 v2, a[172:175] offset:19456
    s_waitcnt lgkmcnt(0)
    s_barrier
    ds_read_b64_tr_b16 a[160:161], v123 offset:16384
    ds_read_b64_tr_b16 a[162:163], v123 offset:16896
    ds_read_b64_tr_b16 a[164:165], v123 offset:24576
    ds_read_b64_tr_b16 a[166:167], v123 offset:25088
    ds_read_b64_tr_b16 a[168:169], v127 offset:16384
    ds_read_b64_tr_b16 a[170:171], v127 offset:16896
    ds_read_b64_tr_b16 a[172:173], v127 offset:24576
    ds_read_b64_tr_b16 a[174:175], v127 offset:25088
    s_mov_b32 s6, 3670016
    buffer_load_dwordx4 v[24:27], v121, s[56:59], s6 offen
    s_mov_b32 s6, 3702784
    buffer_load_dwordx4 v[28:31], v121, s[56:59], s6 offen
    s_mov_b32 s6, 3735552
    buffer_load_dwordx4 v[32:35], v121, s[56:59], s6 offen
    s_mov_b32 s6, 3768320
    buffer_load_dwordx4 v[36:39], v121, s[56:59], s6 offen
    s_waitcnt vmcnt(52)
    ds_write_b128 v125, a[176:179] offset:0
    ds_write_b128 v2, a[180:183] offset:1024
    ds_write_b128 v125, a[184:187] offset:2048
    ds_write_b128 v2, a[188:191] offset:3072
    s_waitcnt lgkmcnt(0)
    s_barrier
    ds_read_b64_tr_b16 a[176:177], v123 offset:0
    ds_read_b64_tr_b16 a[178:179], v123 offset:512
    ds_read_b64_tr_b16 a[180:181], v123 offset:8192
    ds_read_b64_tr_b16 a[182:183], v123 offset:8704
    ds_read_b64_tr_b16 a[184:185], v127 offset:0
    ds_read_b64_tr_b16 a[186:187], v127 offset:512
    ds_read_b64_tr_b16 a[188:189], v127 offset:8192
    ds_read_b64_tr_b16 a[190:191], v127 offset:8704
    s_mov_b32 s6, 1572864
    buffer_load_dwordx4 v[40:43], v121, s[64:67], s6 offen
    s_mov_b32 s6, 1605632
    buffer_load_dwordx4 v[44:47], v121, s[64:67], s6 offen
    s_mov_b32 s6, 1638400
    buffer_load_dwordx4 v[48:51], v121, s[64:67], s6 offen
    s_mov_b32 s6, 1671168
    buffer_load_dwordx4 v[52:55], v121, s[64:67], s6 offen
    s_waitcnt vmcnt(52)
    ds_write_b128 v125, a[192:195] offset:16384
    ds_write_b128 v2, a[196:199] offset:17408
    ds_write_b128 v125, a[200:203] offset:18432
    ds_write_b128 v2, a[204:207] offset:19456
    s_waitcnt lgkmcnt(0)
    s_barrier
    ds_read_b64_tr_b16 a[192:193], v123 offset:16384
    ds_read_b64_tr_b16 a[194:195], v123 offset:16896
    ds_read_b64_tr_b16 a[196:197], v123 offset:24576
    ds_read_b64_tr_b16 a[198:199], v123 offset:25088
    ds_read_b64_tr_b16 a[200:201], v127 offset:16384
    ds_read_b64_tr_b16 a[202:203], v127 offset:16896
    ds_read_b64_tr_b16 a[204:205], v127 offset:24576
    ds_read_b64_tr_b16 a[206:207], v127 offset:25088
    s_mov_b32 s6, 0
    buffer_load_dwordx4 v[56:59], v121, s[68:71], s6 offen
    s_mov_b32 s6, 32768
    buffer_load_dwordx4 v[60:63], v121, s[68:71], s6 offen
    s_mov_b32 s6, 65536
    buffer_load_dwordx4 v[64:67], v121, s[68:71], s6 offen
    s_mov_b32 s6, 98304
    buffer_load_dwordx4 v[68:71], v121, s[68:71], s6 offen
    s_waitcnt vmcnt(52)
    ds_write_b128 v125, a[208:211] offset:0
    ds_write_b128 v2, a[212:215] offset:1024
    ds_write_b128 v125, a[216:219] offset:2048
    ds_write_b128 v2, a[220:223] offset:3072
    s_waitcnt lgkmcnt(0)
    s_barrier
    ds_read_b64_tr_b16 a[208:209], v123 offset:0
    ds_read_b64_tr_b16 a[210:211], v123 offset:512
    ds_read_b64_tr_b16 a[212:213], v123 offset:8192
    ds_read_b64_tr_b16 a[214:215], v123 offset:8704
    ds_read_b64_tr_b16 a[216:217], v127 offset:0
    ds_read_b64_tr_b16 a[218:219], v127 offset:512
    ds_read_b64_tr_b16 a[220:221], v127 offset:8192
    ds_read_b64_tr_b16 a[222:223], v127 offset:8704
    v_mov_b32 v88, 0xff81ff81
    v_mov_b32 v89, 0xff81ff81
    v_mov_b32 v90, 0xff81ff81
    v_mov_b32 v91, 0xff81ff81
    s_lshl_b32 s6, s3, 13
    s_lshl_b32 s7, s4, 11
    s_add_u32 s6, s6, s7
    s_add_u32 s6, s6, 262144
    s_lshl_b32 s7, s3, 8
    s_add_u32 s7, s7, 229376
    buffer_store_dwordx4 v[88:91], v112, s[52:55], s6 offen sc1
    buffer_store_dwordx4 v[88:91], v112, s[52:55], s6 offen offset:1024 sc1
    buffer_store_dwordx2 v[88:89], v118, s[52:55], s7 offen sc1
    s_add_u32 s6, s6, 262144
    s_add_u32 s7, s7, 8192
    buffer_store_dwordx4 v[88:91], v112, s[52:55], s6 offen sc1
    buffer_store_dwordx4 v[88:91], v112, s[52:55], s6 offen offset:1024 sc1
    buffer_store_dwordx2 v[88:89], v118, s[52:55], s7 offen sc1
    s_add_u32 s6, s6, 262144
    s_add_u32 s7, s7, 8192
    buffer_store_dwordx4 v[88:91], v112, s[52:55], s6 offen sc1
    buffer_store_dwordx4 v[88:91], v112, s[52:55], s6 offen offset:1024 sc1
    buffer_store_dwordx2 v[88:89], v118, s[52:55], s7 offen sc1
    s_add_u32 s6, s6, 262144
    s_add_u32 s7, s7, 8192
    s_lshl_b32 s6, s3, 14
    s_lshl_b32 s7, s4, 12
    s_add_u32 s6, s6, s7
    s_add_u32 s6, s6, 9437184
    buffer_store_dwordx4 v[88:91], v112, s[52:55], s6 offen offset:0 sc1
    buffer_store_dwordx4 v[88:91], v112, s[52:55], s6 offen offset:1024 sc1
    buffer_store_dwordx4 v[88:91], v112, s[52:55], s6 offen offset:2048 sc1
    buffer_store_dwordx4 v[88:91], v112, s[52:55], s6 offen offset:3072 sc1
    v_mov_b32 v126, 0
    s_lshl_b32 s6, s3, 2
    s_add_u32 s6, s6, 253952
    s_mov_b32 s8, 0x00010001
    s_mov_b32 s9, 0x00010001
    s_mov_b64 exec, s[8:9]
    buffer_store_dword v126, v112, s[52:55], s6 offen sc1
    buffer_store_dword v126, v112, s[52:55], s6 offen offset:1024 sc1
    s_mov_b64 exec, -1
    s_waitcnt vmcnt(63)
    ds_write_b128 v125, a[224:227] offset:16384
    ds_write_b128 v2, a[228:231] offset:17408
    ds_write_b128 v125, a[232:235] offset:18432
    ds_write_b128 v2, a[236:239] offset:19456
    s_waitcnt lgkmcnt(0)
    s_barrier
    ds_read_b64_tr_b16 a[224:225], v123 offset:16384
    ds_read_b64_tr_b16 a[226:227], v123 offset:16896
    ds_read_b64_tr_b16 a[228:229], v123 offset:24576
    ds_read_b64_tr_b16 a[230:231], v123 offset:25088
    ds_read_b64_tr_b16 a[232:233], v127 offset:16384
    ds_read_b64_tr_b16 a[234:235], v127 offset:16896
    ds_read_b64_tr_b16 a[236:237], v127 offset:24576
    ds_read_b64_tr_b16 a[238:239], v127 offset:25088
    s_waitcnt vmcnt(59)
    ds_write_b128 v125, v[128:131] offset:0
    ds_write_b128 v2, v[132:135] offset:1024
    ds_write_b128 v125, v[136:139] offset:2048
    ds_write_b128 v2, v[140:143] offset:3072
    s_waitcnt lgkmcnt(0)
    s_barrier
    ds_read_b64_tr_b16 v[128:129], v123 offset:0
    ds_read_b64_tr_b16 v[130:131], v123 offset:512
    ds_read_b64_tr_b16 v[132:133], v123 offset:8192
    ds_read_b64_tr_b16 v[134:135], v123 offset:8704
    ds_read_b64_tr_b16 v[136:137], v127 offset:0
    ds_read_b64_tr_b16 v[138:139], v127 offset:512
    ds_read_b64_tr_b16 v[140:141], v127 offset:8192
    ds_read_b64_tr_b16 v[142:143], v127 offset:8704
    s_waitcnt vmcnt(55)
    ds_write_b128 v125, v[144:147] offset:16384
    ds_write_b128 v2, v[148:151] offset:17408
    ds_write_b128 v125, v[152:155] offset:18432
    ds_write_b128 v2, v[156:159] offset:19456
    s_waitcnt lgkmcnt(0)
    s_barrier
    ds_read_b64_tr_b16 v[144:145], v123 offset:16384
    ds_read_b64_tr_b16 v[146:147], v123 offset:16896
    ds_read_b64_tr_b16 v[148:149], v123 offset:24576
    ds_read_b64_tr_b16 v[150:151], v123 offset:25088
    ds_read_b64_tr_b16 v[152:153], v127 offset:16384
    ds_read_b64_tr_b16 v[154:155], v127 offset:16896
    ds_read_b64_tr_b16 v[156:157], v127 offset:24576
    ds_read_b64_tr_b16 v[158:159], v127 offset:25088
    s_waitcnt vmcnt(51)
    ds_write_b128 v3, v[160:163] offset:0
    ds_write_b128 v3, v[168:171] offset:1024
    ds_write_b128 v4, v[176:179] offset:2048
    ds_write_b128 v4, v[184:187] offset:3072
    s_waitcnt lgkmcnt(0)
    s_barrier
    ds_read_b64_tr_b16 v[160:161], v124 offset:0
    ds_read_b64_tr_b16 v[162:163], v124 offset:1024
    ds_read_b64_tr_b16 v[168:169], v124 offset:8
    ds_read_b64_tr_b16 v[170:171], v124 offset:1032
    ds_read_b64_tr_b16 v[176:177], v1 offset:0
    ds_read_b64_tr_b16 v[178:179], v1 offset:1024
    ds_read_b64_tr_b16 v[184:185], v1 offset:8
    ds_read_b64_tr_b16 v[186:187], v1 offset:1032
    s_waitcnt vmcnt(47)
    ds_write_b128 v3, v[164:167] offset:16384
    ds_write_b128 v3, v[172:175] offset:17408
    ds_write_b128 v4, v[180:183] offset:18432
    ds_write_b128 v4, v[188:191] offset:19456
    s_waitcnt lgkmcnt(0)
    s_barrier
    ds_read_b64_tr_b16 v[164:165], v124 offset:16384
    ds_read_b64_tr_b16 v[166:167], v124 offset:17408
    ds_read_b64_tr_b16 v[172:173], v124 offset:16392
    ds_read_b64_tr_b16 v[174:175], v124 offset:17416
    ds_read_b64_tr_b16 v[180:181], v1 offset:16384
    ds_read_b64_tr_b16 v[182:183], v1 offset:17408
    ds_read_b64_tr_b16 v[188:189], v1 offset:16392
    ds_read_b64_tr_b16 v[190:191], v1 offset:17416
    s_waitcnt vmcnt(43)
    ds_write_b128 v3, v[192:195] offset:0
    ds_write_b128 v3, v[200:203] offset:1024
    ds_write_b128 v4, v[208:211] offset:2048
    ds_write_b128 v4, v[216:219] offset:3072
    s_waitcnt lgkmcnt(0)
    s_barrier
    ds_read_b64_tr_b16 v[192:193], v124 offset:0
    ds_read_b64_tr_b16 v[194:195], v124 offset:1024
    ds_read_b64_tr_b16 v[200:201], v124 offset:8
    ds_read_b64_tr_b16 v[202:203], v124 offset:1032
    ds_read_b64_tr_b16 v[208:209], v1 offset:0
    ds_read_b64_tr_b16 v[210:211], v1 offset:1024
    ds_read_b64_tr_b16 v[216:217], v1 offset:8
    ds_read_b64_tr_b16 v[218:219], v1 offset:1032
    s_waitcnt vmcnt(39)
    ds_write_b128 v3, v[196:199] offset:16384
    ds_write_b128 v3, v[204:207] offset:17408
    ds_write_b128 v4, v[212:215] offset:18432
    ds_write_b128 v4, v[220:223] offset:19456
    s_waitcnt lgkmcnt(0)
    s_barrier
    ds_read_b64_tr_b16 v[196:197], v124 offset:16384
    ds_read_b64_tr_b16 v[198:199], v124 offset:17408
    ds_read_b64_tr_b16 v[204:205], v124 offset:16392
    ds_read_b64_tr_b16 v[206:207], v124 offset:17416
    ds_read_b64_tr_b16 v[212:213], v1 offset:16384
    ds_read_b64_tr_b16 v[214:215], v1 offset:17408
    ds_read_b64_tr_b16 v[220:221], v1 offset:16392
    ds_read_b64_tr_b16 v[222:223], v1 offset:17416
    s_waitcnt vmcnt(35)
    ds_write_b128 v3, v[224:227] offset:0
    ds_write_b128 v3, v[232:235] offset:1024
    ds_write_b128 v4, v[240:243] offset:2048
    ds_write_b128 v4, v[248:251] offset:3072
    s_waitcnt lgkmcnt(0)
    s_barrier
    ds_read_b64_tr_b16 v[224:225], v124 offset:0
    ds_read_b64_tr_b16 v[226:227], v124 offset:1024
    ds_read_b64_tr_b16 v[232:233], v124 offset:8
    ds_read_b64_tr_b16 v[234:235], v124 offset:1032
    ds_read_b64_tr_b16 v[240:241], v1 offset:0
    ds_read_b64_tr_b16 v[242:243], v1 offset:1024
    ds_read_b64_tr_b16 v[248:249], v1 offset:8
    ds_read_b64_tr_b16 v[250:251], v1 offset:1032
    s_waitcnt vmcnt(31)
    ds_write_b128 v3, v[228:231] offset:16384
    ds_write_b128 v3, v[236:239] offset:17408
    ds_write_b128 v4, v[244:247] offset:18432
    ds_write_b128 v4, v[252:255] offset:19456
    s_waitcnt lgkmcnt(0)
    s_barrier
    ds_read_b64_tr_b16 v[228:229], v124 offset:16384
    ds_read_b64_tr_b16 v[230:231], v124 offset:17408
    ds_read_b64_tr_b16 v[236:237], v124 offset:16392
    ds_read_b64_tr_b16 v[238:239], v124 offset:17416
    ds_read_b64_tr_b16 v[244:245], v1 offset:16384
    ds_read_b64_tr_b16 v[246:247], v1 offset:17408
    ds_read_b64_tr_b16 v[252:253], v1 offset:16392
    ds_read_b64_tr_b16 v[254:255], v1 offset:17416
    s_waitcnt vmcnt(27)
    s_barrier
    ds_write_b128 v125, v[8:11] offset:0
    ds_write_b128 v2, v[12:15] offset:1024
    ds_write_b128 v125, v[16:19] offset:2048
    ds_write_b128 v2, v[20:23] offset:3072
    s_waitcnt lgkmcnt(0)
    s_barrier
    ds_read_b64_tr_b16 v[8:9], v123 offset:0
    ds_read_b64_tr_b16 v[10:11], v123 offset:512
    ds_read_b64_tr_b16 v[12:13], v123 offset:8192
    ds_read_b64_tr_b16 v[14:15], v123 offset:8704
    ds_read_b64_tr_b16 v[16:17], v127 offset:0
    ds_read_b64_tr_b16 v[18:19], v127 offset:512
    ds_read_b64_tr_b16 v[20:21], v127 offset:8192
    ds_read_b64_tr_b16 v[22:23], v127 offset:8704
    s_waitcnt lgkmcnt(0)
    ds_write_b128 v119, v[8:11] offset:0
    ds_write_b128 v119, v[12:15] offset:1024
    ds_write_b128 v119, v[16:19] offset:2048
    ds_write_b128 v119, v[20:23] offset:3072
    s_waitcnt lgkmcnt(0)
    s_waitcnt vmcnt(23)
    s_barrier
    ds_write_b128 v125, v[24:27] offset:0
    ds_write_b128 v2, v[28:31] offset:1024
    ds_write_b128 v125, v[32:35] offset:2048
    ds_write_b128 v2, v[36:39] offset:3072
    s_waitcnt lgkmcnt(0)
    s_barrier
    ds_read_b64_tr_b16 v[24:25], v123 offset:0
    ds_read_b64_tr_b16 v[26:27], v123 offset:512
    ds_read_b64_tr_b16 v[28:29], v123 offset:8192
    ds_read_b64_tr_b16 v[30:31], v123 offset:8704
    ds_read_b64_tr_b16 v[32:33], v127 offset:0
    ds_read_b64_tr_b16 v[34:35], v127 offset:512
    ds_read_b64_tr_b16 v[36:37], v127 offset:8192
    ds_read_b64_tr_b16 v[38:39], v127 offset:8704
    s_waitcnt lgkmcnt(0)
    ds_write_b128 v119, v[24:27] offset:4096
    ds_write_b128 v119, v[28:31] offset:5120
    ds_write_b128 v119, v[32:35] offset:6144
    ds_write_b128 v119, v[36:39] offset:7168
    s_waitcnt lgkmcnt(0)
    s_waitcnt vmcnt(19)
    s_barrier
    ds_write_b128 v125, v[40:43] offset:0
    ds_write_b128 v2, v[44:47] offset:1024
    ds_write_b128 v125, v[48:51] offset:2048
    ds_write_b128 v2, v[52:55] offset:3072
    s_waitcnt lgkmcnt(0)
    s_barrier
    ds_read_b64_tr_b16 v[40:41], v123 offset:0
    ds_read_b64_tr_b16 v[42:43], v123 offset:512
    ds_read_b64_tr_b16 v[44:45], v123 offset:8192
    ds_read_b64_tr_b16 v[46:47], v123 offset:8704
    ds_read_b64_tr_b16 v[48:49], v127 offset:0
    ds_read_b64_tr_b16 v[50:51], v127 offset:512
    ds_read_b64_tr_b16 v[52:53], v127 offset:8192
    ds_read_b64_tr_b16 v[54:55], v127 offset:8704
    s_waitcnt lgkmcnt(0)
    ds_write_b128 v119, v[40:43] offset:8192
    ds_write_b128 v119, v[44:47] offset:9216
    ds_write_b128 v119, v[48:51] offset:10240
    ds_write_b128 v119, v[52:55] offset:11264
    s_waitcnt lgkmcnt(0)
    s_waitcnt vmcnt(15)
    s_barrier
    ds_write_b128 v125, v[56:59] offset:0
    ds_write_b128 v2, v[60:63] offset:1024
    ds_write_b128 v125, v[64:67] offset:2048
    ds_write_b128 v2, v[68:71] offset:3072
    s_waitcnt lgkmcnt(0)
    s_barrier
    ds_read_b64_tr_b16 v[56:57], v123 offset:0
    ds_read_b64_tr_b16 v[58:59], v123 offset:512
    ds_read_b64_tr_b16 v[60:61], v123 offset:8192
    ds_read_b64_tr_b16 v[62:63], v123 offset:8704
    ds_read_b64_tr_b16 v[64:65], v127 offset:0
    ds_read_b64_tr_b16 v[66:67], v127 offset:512
    ds_read_b64_tr_b16 v[68:69], v127 offset:8192
    ds_read_b64_tr_b16 v[70:71], v127 offset:8704
    s_waitcnt lgkmcnt(0)
    ds_write_b128 v119, v[56:59] offset:12288
    ds_write_b128 v119, v[60:63] offset:13312
    ds_write_b128 v119, v[64:67] offset:14336
    ds_write_b128 v119, v[68:71] offset:15360
    s_waitcnt lgkmcnt(0)
    s_waitcnt vmcnt(0) lgkmcnt(0)
    s_barrier
    s_cmp_lg_u32 s4, 0
    s_cbranch_scc1 R_noinc_5
    s_mov_b64 exec, 1
    v_mov_b32 v126, 1
    buffer_atomic_add v126, off, s[60:63], 0 offset:8
    s_mov_b64 exec, -1
R_noinc_5:
    v_and_b32 v9, 31, v0
    v_lshlrev_b32 v9, 8, v9
    v_lshrrev_b32 v10, 5, v0
    v_lshl_add_u32 v9, v10, 2, v9
    s_mov_b32 s6, 0xff81
    v_and_b32 v10, 0xffff, v104
    v_cmp_eq_u32 vcc, s6, v10
    s_nop 1
    v_cndmask_b32 v10, 0, 64, vcc
    v_or_b32 v104, v104, v10
    v_lshrrev_b32 v10, 16, v104
    v_cmp_eq_u32 vcc, s6, v10
    s_nop 1
    v_cndmask_b32 v10, 0, 64, vcc
    v_lshl_or_b32 v104, v10, 16, v104
    v_and_b32 v10, 0xffff, v105
    v_cmp_eq_u32 vcc, s6, v10
    s_nop 1
    v_cndmask_b32 v10, 0, 64, vcc
    v_or_b32 v105, v105, v10
    v_lshrrev_b32 v10, 16, v105
    v_cmp_eq_u32 vcc, s6, v10
    s_nop 1
    v_cndmask_b32 v10, 0, 64, vcc
    v_lshl_or_b32 v105, v10, 16, v105
    v_and_b32 v10, 0xffff, v106
    v_cmp_eq_u32 vcc, s6, v10
    s_nop 1
    v_cndmask_b32 v10, 0, 64, vcc
    v_or_b32 v106, v106, v10
    v_lshrrev_b32 v10, 16, v106
    v_cmp_eq_u32 vcc, s6, v10
    s_nop 1
    v_cndmask_b32 v10, 0, 64, vcc
    v_lshl_or_b32 v106, v10, 16, v106
    v_and_b32 v10, 0xffff, v107
    v_cmp_eq_u32 vcc, s6, v10
    s_nop 1
    v_cndmask_b32 v10, 0, 64, vcc
    v_or_b32 v107, v107, v10
    v_lshrrev_b32 v10, 16, v107
    v_cmp_eq_u32 vcc, s6, v10
    s_nop 1
    v_cndmask_b32 v10, 0, 64, vcc
    v_lshl_or_b32 v107, v10, 16, v107
    v_and_b32 v10, 0xffff, v108
    v_cmp_eq_u32 vcc, s6, v10
    s_nop 1
    v_cndmask_b32 v10, 0, 64, vcc
    v_or_b32 v108, v108, v10
    v_lshrrev_b32 v10, 16, v108
    v_cmp_eq_u32 vcc, s6, v10
    s_nop 1
    v_cndmask_b32 v10, 0, 64, vcc
    v_lshl_or_b32 v108, v10, 16, v108
    v_and_b32 v10, 0xffff, v109
    v_cmp_eq_u32 vcc, s6, v10
    s_nop 1
    v_cndmask_b32 v10, 0, 64, vcc
    v_or_b32 v109, v109, v10
    v_lshrrev_b32 v10, 16, v109
    v_cmp_eq_u32 vcc, s6, v10
    s_nop 1
    v_cndmask_b32 v10, 0, 64, vcc
    v_lshl_or_b32 v109, v10, 16, v109
    v_and_b32 v10, 0xffff, v110
    v_cmp_eq_u32 vcc, s6, v10
    s_nop 1
    v_cndmask_b32 v10, 0, 64, vcc
    v_or_b32 v110, v110, v10
    v_lshrrev_b32 v10, 16, v110
    v_cmp_eq_u32 vcc, s6, v10
    s_nop 1
    v_cndmask_b32 v10, 0, 64, vcc
    v_lshl_or_b32 v110, v10, 16, v110
    v_and_b32 v10, 0xffff, v111
    v_cmp_eq_u32 vcc, s6, v10
    s_nop 1
    v_cndmask_b32 v10, 0, 64, vcc
    v_or_b32 v111, v111, v10
    v_lshrrev_b32 v10, 16, v111
    v_cmp_eq_u32 vcc, s6, v10
    s_nop 1
    v_cndmask_b32 v10, 0, 64, vcc
    v_lshl_or_b32 v111, v10, 16, v111
    ds_write_b16 v9, v104 offset:0
    ds_write_b16_d16_hi v9, v104 offset:32
    ds_write_b16 v9, v105 offset:64
    ds_write_b16_d16_hi v9, v105 offset:96
    ds_write_b16 v9, v106 offset:2
    ds_write_b16_d16_hi v9, v106 offset:34
    ds_write_b16 v9, v107 offset:66
    ds_write_b16_d16_hi v9, v107 offset:98
    ds_write_b16 v9, v108 offset:128
    ds_write_b16_d16_hi v9, v108 offset:160
    ds_write_b16 v9, v109 offset:192
    ds_write_b16_d16_hi v9, v109 offset:224
    ds_write_b16 v9, v110 offset:130
    ds_write_b16_d16_hi v9, v110 offset:162
    ds_write_b16 v9, v111 offset:194
    ds_write_b16_d16_hi v9, v111 offset:226
    s_waitcnt lgkmcnt(0)
    v_mov_b32 v108, 0x3f003f00
    v_mov_b32 v109, 0x3f003f00
    v_mov_b32 v110, 0x3f003f00
    v_mov_b32 v111, 0x3f003f00
    s_mov_b32 s79, 0
    s_lshl_b32 s6, s3, 13
    s_lshl_b32 s7, s4, 11
    s_add_u32 s80, s6, s7
    s_add_u32 s80, s80, 33816576
    s_lshl_b32 s9, s4, 11
    s_add_u32 s81, s9, 8192
    s_add_u32 s92, s6, s9
    s_add_u32 s92, s92, 17039360
    s_lshl_b32 s70, s3, 2
    s_add_u32 s71, s70, 254976
    s_add_u32 s70, s70, 253952
    s_cmp_eq_u32 s4, 3
    s_cselect_b32 s70, s70, 0x40000000
    s_and_b32 s72, s3, 3
    s_lshl_b32 s72, s72, 8
    s_add_u32 s73, s72, 254976
    s_add_u32 s72, s72, 253952
    s_cmp_eq_u32 s4, 0
    s_cselect_b32 s72, s72, 0x40000000
    s_cmp_lt_u32 s3, 16
    s_cselect_b32 s66, s72, 0x40000000
    s_mov_b32 s74, 0x00010001
    s_mov_b32 s75, 0x00010001
    s_mov_b32 s82, 0x3e0293ee
    s_mov_b32 s83, 0xbe0293ee
    s_lshl_b32 s8, s3, 8
    s_add_u32 s85, s8, 262144
    s_add_u32 s86, s6, 262144
    s_add_u32 s84, s86, s9
    s_and_b32 s87, s4, 1
    s_lshl_b32 s87, s87, 24
    s_add_u32 s87, s87, s6
    s_add_u32 s87, s87, 17301504
    s_mov_b32 s88, 0
    s_add_u32 s89, s8, 229376
    s_add_u32 s77, s8, 9437184
    s_cmp_eq_u32 s4, 0
    s_cselect_b32 s77, s77, 0x40000000
    s_mov_b32 s90, 0
    s_mov_b32 s91, 524288
    s_mov_b32 s5, 0
    s_cmp_lg_u32 s4, 0
    s_cbranch_scc1 DA_6
    s_mov_b64 exec, 1
    v_mov_b32 v122, 1
    buffer_atomic_add v122, off, s[60:63], 0 offset:16
    s_mov_b64 exec, -1
DA_6:
    s_add_u32 s100, s3, 224
    s_mov_b32 s14, 63
    s_cmp_lg_u32 s4, 0
    s_cbranch_scc1 WDW_7
DW_8:
    buffer_load_dword v122, off, s[60:63], 0 offset:128 sc1
    s_add_u32 s79, s79, 1
    s_cmp_gt_u32 s79, 2097152
    s_cbranch_scc1 mega_kernel_exit
    s_waitcnt vmcnt(0)
    v_cmp_gt_u32 vcc, 0xc0, v122
    s_nop 0
    s_cbranch_vccz DWok_9
    s_sleep 8
    s_branch DW_8
DWok_9:
WDW_7:
    s_barrier
    s_lshl_b32 s78, s3, 7
    s_add_u32 s78, s78, 0
    s_add_u32 s67, s78, 8256
    s_mov_b32 s14, 3
FW_10:
    buffer_load_dword v126, off, s[52:55], s78 sc1
    buffer_load_dword v122, off, s[52:55], s67 sc1
    s_add_u32 s79, s79, 1
    s_cmp_gt_u32 s79, 2097152
    s_cbranch_scc1 mega_kernel_exit
    s_waitcnt vmcnt(0)
    v_min_u32 v126, v126, v122
    v_cmp_gt_u32 vcc, s14, v126
    s_nop 0
    s_cbranch_vccz FWok_11
    s_sleep 6
    s_branch FW_10
FWok_11:
    s_and_b32 s14, s4, 1
    s_cmp_eq_u32 s14, 1
    s_cselect_b32 s78, s67, s78
    s_sub_u32 s7, s80, 262144
    buffer_load_dwordx4 v[88:91], v112, s[52:55], s7 offen sc1
    buffer_load_dwordx4 v[92:95], v112, s[52:55], s7 offen offset:1024 sc1
    v_lshlrev_b32 v127, 2, v112
    s_add_u32 s9, s84, 0
    buffer_load_dwordx4 v[0:3], v112, s[52:55], s9 offen sc1
    buffer_load_dwordx4 v[0:3], v112, s[52:55], s9 offen offset:1024 sc1
    s_add_u32 s9, s84, 262144
    buffer_load_dwordx4 v[0:3], v112, s[52:55], s9 offen sc1
    buffer_load_dwordx4 v[0:3], v112, s[52:55], s9 offen offset:1024 sc1
    s_add_u32 s9, s84, 524288
    buffer_load_dwordx4 v[0:3], v112, s[52:55], s9 offen sc1
    buffer_load_dwordx4 v[0:3], v112, s[52:55], s9 offen offset:1024 sc1
    buffer_load_dwordx4 v[0:3], v112, s[52:55], s80 offen sc1
    buffer_load_dwordx4 v[0:3], v112, s[52:55], s80 offen offset:1024 sc1
    buffer_load_dwordx4 v[0:3], v112, s[52:55], s92 offen sc1
    buffer_load_dwordx4 v[0:3], v112, s[52:55], s92 offen offset:1024 sc1
    s_sub_u32 s8, s92, 262144
    s_mov_b32 m0, s81
    s_nop 0
    buffer_load_dwordx4 v112, s[52:55], s8 offen offset:0 sc1 lds
    buffer_load_dwordx4 v112, s[52:55], s8 offen offset:1024 sc1 lds
    ds_read_b128 v[32:35], v119 offset:0
    ds_read_b128 v[36:39], v119 offset:1024
    ds_read_b128 v[40:43], v119 offset:2048
    ds_read_b128 v[44:47], v119 offset:3072
    ds_read_b128 v[48:51], v119 offset:4096
    ds_read_b128 v[52:55], v119 offset:5120
    v_mov_b64 v[56:57], 0
    v_mov_b64 v[58:59], 0
    v_mov_b64 v[60:61], 0
    v_mov_b64 v[62:63], 0
    v_mov_b64 v[64:65], 0
    v_mov_b64 v[66:67], 0
    v_mov_b64 v[68:69], 0
    v_mov_b64 v[70:71], 0
    v_mov_b32 v80, 0xff81ff81
    v_mov_b32 v81, 0xff81ff81
    v_mov_b32 v82, 0xff81ff81
    v_mov_b32 v83, 0xff81ff81
    v_mov_b32 v122, 0
R_pollinit_13:
    buffer_load_dword v123, v122, s[60:63], 0 offen offset:8 sc1
    buffer_load_dword v124, v122, s[60:63], 0 offen offset:0 sc1
    s_add_u32 s79, s79, 1
    s_cmp_gt_u32 s79, 2097152
    s_cbranch_scc1 mega_kernel_exit
    s_waitcnt vmcnt(0)
    v_readfirstlane_b32 s6, v123
    v_readfirstlane_b32 s7, v124
    s_cmp_lt_u32 s6, 32
    s_cbranch_scc1 R_pollinit_13
    s_waitcnt lgkmcnt(0)
    s_barrier
    s_lshl_b32 s8, s3, 8
    v_and_b32 v122, 0xff, v118
    v_add_u32 v122, s8, v122
    ds_read_b64 v[124:125], v122
    s_waitcnt lgkmcnt(0)
    s_cmp_lt_u32 s7, 32
    s_cbranch_scc1 R_slow_15
    s_cmp_eq_u32 s76, 0
    s_cbranch_scc1 R_slow_15
R_top_16:
    ds_read_b64_tr_b16 v[0:1], v113 offset:0
    ds_read_b64_tr_b16 v[2:3], v113 offset:256
    ds_read_b64_tr_b16 v[4:5], v113 offset:1024
    ds_read_b64_tr_b16 v[6:7], v113 offset:1280
    ds_read_b64_tr_b16 v[8:9], v113 offset:2048
    ds_read_b64_tr_b16 v[10:11], v113 offset:2304
    s_lshl_b32 s6, s5, 18
    s_add_u32 s69, s91, s84
    buffer_store_dwordx4 v[80:83], v112, s[52:55], s69 offen offset:0
    s_cmp_lt_u32 s4, 2
    s_cbranch_scc1 R_notouch_19
    s_add_u32 s14, s5, 3
    s_min_u32 s14, s14, 64
    v_cmp_gt_u32 vcc, s14, v126
    s_nop 0
    s_cbranch_vccz R_pok_20
FW_21:
    buffer_load_dword v126, off, s[52:55], s78 sc1
    s_add_u32 s79, s79, 1
    s_cmp_gt_u32 s79, 2097152
    s_cbranch_scc1 mega_kernel_exit
    s_waitcnt vmcnt(0)
    v_cmp_gt_u32 vcc, s14, v126
    s_nop 0
    s_cbranch_vccz FWok_22
    s_sleep 1
    s_branch FW_21
FWok_22:
R_pok_20:
    s_add_u32 s9, s6, s87
    buffer_load_dword v126, v127, s[52:55], s9 offen sc1
    s_add_u32 s9, s9, 4096
    buffer_load_dword v126, v127, s[52:55], s9 offen sc1
    buffer_load_dword v126, off, s[52:55], s78 sc1
R_notouch_19:
    s_add_u32 s7, s6, s80
    s_add_u32 s8, s6, s92
    s_waitcnt lgkmcnt(4)
    v_smfmac_f32_16x16x64_bf16 v[56:59], v[0:3], v[32:39], v120
    ds_read_b64_tr_b16 v[12:13], v113 offset:3072
    ds_read_b64_tr_b16 v[14:15], v113 offset:3328
    v_smfmac_f32_16x16x64_bf16 v[60:63], v[0:3], v[40:47], v120
    ds_read_b64_tr_b16 v[16:17], v113 offset:4096
    ds_read_b64_tr_b16 v[18:19], v113 offset:4352
    s_waitcnt lgkmcnt(6)
    v_smfmac_f32_16x16x64_bf16 v[56:59], v[4:7], a[0:7], v120
    ds_read_b64_tr_b16 v[20:21], v113 offset:5120
    ds_read_b64_tr_b16 v[22:23], v113 offset:5376
    v_smfmac_f32_16x16x64_bf16 v[60:63], v[4:7], a[8:15], v120
    ds_read_b64_tr_b16 v[24:25], v113 offset:6144
    ds_read_b64_tr_b16 v[26:27], v113 offset:6400
    s_waitcnt lgkmcnt(8)
    v_smfmac_f32_16x16x64_bf16 v[56:59], v[8:11], a[16:23], v120
    ds_read_b64_tr_b16 v[28:29], v113 offset:7168
    ds_read_b64_tr_b16 v[30:31], v113 offset:7424
    v_smfmac_f32_16x16x64_bf16 v[60:63], v[8:11], a[24:31], v120
    s_lshl_b32 s10, s5, 13
    ds_read_b128 v[32:35], v119 offset:6144
    s_waitcnt lgkmcnt(9)
    v_smfmac_f32_16x16x64_bf16 v[56:59], v[12:15], a[32:39], v120
    s_add_u32 s10, s10, s77
    ds_read_b128 v[36:39], v119 offset:7168
    v_smfmac_f32_16x16x64_bf16 v[60:63], v[12:15], a[40:47], v120
    buffer_store_dwordx2 v[124:125], v118, s[52:55], s10 offen sc1
    ds_read_b128 v[40:43], v119 offset:8192
    s_waitcnt lgkmcnt(9)
    v_smfmac_f32_16x16x64_bf16 v[56:59], v[16:19], a[48:55], v120
    ds_read_b128 v[44:47], v119 offset:9216
    v_mov_b64 v[80:81], 0
    v_smfmac_f32_16x16x64_bf16 v[60:63], v[16:19], a[56:63], v120
    ds_read_b128 v[72:75], v112 offset:8192
    s_waitcnt lgkmcnt(9)
    v_mov_b64 v[82:83], 0
    v_smfmac_f32_16x16x64_bf16 v[56:59], v[20:23], a[64:71], v120
    ds_read_b128 v[76:79], v112 offset:9216
    v_mov_b64 v[84:85], 0
    v_smfmac_f32_16x16x64_bf16 v[60:63], v[20:23], a[72:79], v120
    ds_read_b128 v[96:99], v112 offset:10240
    s_waitcnt lgkmcnt(9)
    v_mov_b64 v[86:87], 0
    v_smfmac_f32_16x16x64_bf16 v[56:59], v[24:27], a[80:87], v120
    ds_read_b128 v[100:103], v112 offset:11264
    v_smfmac_f32_16x16x64_bf16 v[60:63], v[24:27], a[88:95], v120
    ds_read_b128 v[104:107], v112 offset:12288
    s_waitcnt lgkmcnt(9)
    v_smfmac_f32_16x16x64_bf16 v[56:59], v[28:31], v[48:55], v120
    s_barrier
    s_waitcnt lgkmcnt(7)
    v_smfmac_f32_16x16x64_bf16 v[60:63], v[28:31], v[32:39], v120
    ds_read_b128 v[48:51], v119 offset:10240
    v_smfmac_f32_16x16x64_bf16 v[64:67], v[0:3], a[96:103], v120
    ds_read_b128 v[52:55], v119 offset:11264
    v_smfmac_f32_16x16x64_bf16 v[68:71], v[0:3], a[104:111], v120
    ds_read_b128 v[32:35], v119 offset:12288
    v_smfmac_f32_16x16x64_bf16 v[64:67], v[4:7], a[112:119], v120
    ds_read_b128 v[36:39], v119 offset:13312
    v_add_f32 v56, v56, v57
    v_add_f32 v58, v58, v59
    v_smfmac_f32_16x16x64_bf16 v[68:71], v[4:7], a[120:127], v120
    v_cmp_u_f32 vcc, v56, v58
    v_cvt_pk_bf16_f32 v56, v56, v58
    v_add_f32 v60, v60, v61
    v_smfmac_f32_16x16x64_bf16 v[64:67], v[8:11], a[128:135], v120
    s_cbranch_vccnz R_bad_23
R_good_24:
    v_add_f32 v62, v62, v63
    v_cvt_pk_bf16_f32 v60, v60, v62
    v_smfmac_f32_16x16x64_bf16 v[68:71], v[8:11], a[136:143], v120
    ds_write2st64_b32 v114, v56, v60 offset0:0 offset1:2
    s_waitcnt lgkmcnt(10)
    v_smfmac_f32_16x16x64_bf16 v[64:67], v[12:15], v[40:47], v120
    s_add_u32 s10, s90, s85
    s_add_u32 s11, s90, s86
    s_waitcnt lgkmcnt(3)
    v_smfmac_f32_16x16x64_bf16 v[68:71], v[12:15], v[48:55], v120
    ds_read_b128 v[40:43], v119 offset:14336
    v_smfmac_f32_16x16x64_bf16 v[64:67], v[16:19], a[144:151], v120
    ds_read_b128 v[44:47], v119 offset:15360
    v_smfmac_f32_16x16x64_bf16 v[68:71], v[16:19], a[152:159], v120
    s_waitcnt lgkmcnt(2)
    v_smfmac_f32_16x16x64_bf16 v[64:67], v[20:23], a[160:167], v120
    s_barrier
    ds_read_b64_tr_b16 a[240:241], v113 offset:0
    ds_read_b64_tr_b16 a[242:243], v113 offset:256
    v_smfmac_f32_16x16x64_bf16 v[68:71], v[20:23], a[168:175], v120
    ds_read_b64_tr_b16 a[244:245], v113 offset:1024
    ds_read_b64_tr_b16 a[246:247], v113 offset:1280
    v_smfmac_f32_16x16x64_bf16 v[64:67], v[24:27], a[176:183], v120
    ds_read_b64_tr_b16 a[248:249], v113 offset:2048
    ds_read_b64_tr_b16 a[250:251], v113 offset:2304
    v_smfmac_f32_16x16x64_bf16 v[68:71], v[24:27], a[184:191], v120
    ds_read_b64_tr_b16 a[252:253], v113 offset:3072
    ds_read_b64_tr_b16 a[254:255], v113 offset:3328
    v_smfmac_f32_16x16x64_bf16 v[64:67], v[28:31], a[192:199], v120
    ds_read_b128 v[48:51], v119 offset:16384
    v_smfmac_f32_16x16x64_bf16 v[68:71], v[28:31], a[200:207], v120
    ds_read_b128 v[52:55], v119 offset:17408
    s_waitcnt lgkmcnt(8)
    v_mfma_f32_16x16x32_bf16 v[56:59], v[72:75], a[240:243], 0
    ds_read_b128 v[72:75], v112 offset:13312
    s_waitcnt lgkmcnt(7)
    v_mfma_f32_16x16x32_bf16 v[56:59], v[76:79], a[244:247], v[56:59]
    ds_read_b128 v[76:79], v112 offset:14336
    s_waitcnt lgkmcnt(6)
    v_add_f32 v64, v64, v65
    v_add_f32 v66, v66, v67
    v_mfma_f32_16x16x32_bf16 v[56:59], v[96:99], a[248:251], v[56:59]
    ds_read_b128 v[96:99], v112 offset:15360
    s_waitcnt lgkmcnt(5)
    v_cvt_pk_bf16_f32 v64, v64, v66
    v_add_f32 v68, v68, v69
    v_mfma_f32_16x16x32_bf16 v[56:59], v[100:103], a[252:255], v[56:59]
    s_add_u32 s12, s11, 4096
    s_mov_b32 s93, 0
    v_add_f32 v70, v70, v71
    v_cvt_pk_bf16_f32 v68, v68, v70
    v_mfma_f32_16x16x32_bf16 v[60:63], v[104:107], a[240:243], 0
    ds_write2st64_b32 v114, v64, v68 offset0:16 offset1:18
    s_add_u32 s15, s10, 131072
    s_mov_b32 s13, s88
    s_waitcnt lgkmcnt(3)
    v_mfma_f32_16x16x32_bf16 v[60:63], v[72:75], a[244:247], v[60:63]
    s_add_u32 s88, s88, 8192
    s_cmp_eq_u32 s88, 24576
    s_cselect_b32 s88, 0, s88
    s_waitcnt lgkmcnt(2)
    v_mfma_f32_16x16x32_bf16 v[60:63], v[76:79], a[248:251], v[60:63]
    s_mov_b32 s91, s90
    s_waitcnt lgkmcnt(1)
    v_max3_f32 v121, v56, v57, v58
    v_max_f32 v121, v121, v59
    v_mfma_f32_16x16x32_bf16 v[60:63], v[96:99], a[252:255], v[60:63]
    s_add_u32 s90, s90, 262144
    s_cmp_eq_u32 s90, 786432
    s_cselect_b32 s90, 0, s90
    v_smfmac_f32_16x16x64_bf16 v[80:83], v[0:3], v[32:39], v120
    s_waitcnt lgkmcnt(0)
    ds_read_b128 v[32:35], v119 offset:18432
    ds_read_b128 v[36:39], v119 offset:19456
    v_smfmac_f32_16x16x64_bf16 v[84:87], v[0:3], v[40:47], v120
    s_barrier
    ds_read_b64_tr_b16 v[64:65], v113 offset:4096
    ds_read_b64_tr_b16 v[66:67], v113 offset:4352
    v_max3_f32 v121, v121, v60, v61
    v_max3_f32 v121, v121, v62, v63
    v_smfmac_f32_16x16x64_bf16 v[80:83], v[4:7], a[208:215], v120
    ds_read_b64_tr_b16 v[68:69], v113 offset:5120
    ds_read_b64_tr_b16 v[70:71], v113 offset:5376
    v_mov_b32 v123, v121
    v_smfmac_f32_16x16x64_bf16 v[84:87], v[4:7], a[216:223], v120
    ds_read_b64_tr_b16 v[72:73], v113 offset:6144
    ds_read_b64_tr_b16 v[74:75], v113 offset:6400
    v_permlane32_swap_b32 v121, v123
    v_max_f32 v121, v121, v123
    v_smfmac_f32_16x16x64_bf16 v[80:83], v[8:11], v[48:55], v120
    ds_read_b64_tr_b16 v[76:77], v113 offset:7168
    ds_read_b64_tr_b16 v[78:79], v113 offset:7424
    s_waitcnt lgkmcnt(8)
    v_mov_b32 v123, v121
    v_smfmac_f32_16x16x64_bf16 v[84:87], v[8:11], v[32:39], v120
    ds_read_b128 v[40:43], v119 offset:20480
    s_waitcnt lgkmcnt(7)
    v_permlane16_swap_b32 v121, v123
    v_max_f32 v121, v121, v123
    v_mul_f32 v125, s83, v121
    v_mfma_f32_16x16x32_bf16 v[104:107], v[64:67], a[240:243], 0
    ds_read_b128 v[44:47], v119 offset:21504
    s_waitcnt lgkmcnt(6)
    v_fma_f32 v56, v56, s82, v125
    v_fma_f32 v57, v57, s82, v125
    v_fma_f32 v58, v58, s82, v125
    v_mfma_f32_16x16x32_bf16 v[104:107], v[68:71], a[244:247], v[104:107]
    ds_read_b128 v[48:51], v119 offset:22528
    s_waitcnt lgkmcnt(5)
    v_fma_f32 v59, v59, s82, v125
    v_fma_f32 v60, v60, s82, v125
    v_fma_f32 v61, v61, s82, v125
    v_mfma_f32_16x16x32_bf16 v[104:107], v[72:75], a[248:251], v[104:107]
    ds_read_b128 v[52:55], v119 offset:23552
    s_waitcnt lgkmcnt(4)
    v_fma_f32 v62, v62, s82, v125
    v_fma_f32 v63, v63, s82, v125
    v_exp_f32 v56, v56
    v_mfma_f32_16x16x32_bf16 v[104:107], v[76:79], a[252:255], v[104:107]
    ds_read_b128 v[32:35], v119 offset:24576
    v_exp_f32 v57, v57
    v_exp_f32 v58, v58
    v_exp_f32 v59, v59
    v_smfmac_f32_16x16x64_bf16 v[80:83], v[12:15], a[224:231], v120
    ds_read_b128 v[36:39], v119 offset:25600
    v_exp_f32 v60, v60
    v_exp_f32 v61, v61
    v_smfmac_f32_16x16x64_bf16 v[84:87], v[12:15], a[232:239], v120
    s_waitcnt lgkmcnt(4)
    v_exp_f32 v62, v62
    v_exp_f32 v63, v63
    v_cvt_pk_bf16_f32 v56, v56, v57
    v_smfmac_f32_16x16x64_bf16 v[80:83], v[16:19], v[40:47], v120
    v_cvt_pk_bf16_f32 v57, v58, v59
    v_cvt_pk_bf16_f32 v58, v60, v61
    v_cvt_pk_bf16_f32 v59, v62, v63
    s_nop 1
    v_mfma_f32_16x16x32_bf16 v[60:63], v[108:111], v[56:59], 0
    ds_read_b128 v[40:43], v119 offset:26624
    v_max3_f32 v122, v104, v105, v121
    v_mov_b32 v123, v122
    v_mfma_f32_16x16x32_bf16 v[96:99], v[88:91], v[56:59], 0
    ds_read_b128 v[44:47], v119 offset:27648
    s_add_u32 s68, s5, 1
    v_permlane32_swap_b32 v122, v123
    v_max_f32 v122, v122, v123
    v_mfma_f32_16x16x32_bf16 v[100:103], v[92:95], v[56:59], 0
    s_mul_i32 s68, s68, 0x01010101
    s_waitcnt lgkmcnt(4)
    v_mov_b32 v123, v122
    v_smfmac_f32_16x16x64_bf16 v[84:87], v[16:19], v[48:55], v120
    s_nop 0
    v_permlane16_swap_b32 v122, v123
    v_max_f32 v122, v122, v123
    v_smfmac_f32_16x16x64_bf16 v[80:83], v[20:23], v[128:135], v120
    ds_read_b128 v[48:51], v119 offset:28672
    v_mul_f32 v127, s83, v122
    v_fma_f32 v124, v121, s82, v127
    v_smfmac_f32_16x16x64_bf16 v[84:87], v[20:23], v[136:143], v120
    ds_read_b128 v[52:55], v119 offset:29696
    s_waitcnt lgkmcnt(4)
    v_fma_f32 v104, v104, s82, v127
    v_fma_f32 v105, v105, s82, v127
    v_smfmac_f32_16x16x64_bf16 v[80:83], v[24:27], v[32:39], v120
    s_waitcnt lgkmcnt(2)
    v_exp_f32 v124, v124
    v_exp_f32 v104, v104
    v_smfmac_f32_16x16x64_bf16 v[84:87], v[24:27], v[40:47], v120
    ds_read_b128 v[32:35], v119 offset:30720
    v_exp_f32 v105, v105
    v_add_f32 v122, v124, v124
    v_smfmac_f32_16x16x64_bf16 v[80:83], v[28:31], v[144:151], v120
    ds_read_b128 v[36:39], v119 offset:31744
    v_cvt_pk_bf16_f32 v104, v104, v104
    v_cvt_pk_bf16_f32 v105, v105, v105
    v_mul_f32 v60, v60, v122
    v_smfmac_f32_16x16x64_bf16 v[84:87], v[28:31], v[152:159], v120
    ds_read_b128 v[40:43], v119 offset:32768
    v_mul_f32 v96, v96, v124
    v_mul_f32 v97, v97, v124
    v_mul_f32 v98, v98, v124
    v_mul_f32 v99, v99, v124
    v_mfma_f32_16x16x16_bf16 v[60:63], v[108:109], v[104:105], v[60:63]
    ds_read_b128 v[44:47], v119 offset:33792
    v_mul_f32 v100, v100, v124
    v_mul_f32 v101, v101, v124
    v_mul_f32 v102, v102, v124
    v_mul_f32 v103, v103, v124
    v_cvt_pk_bf16_f32 v80, v80, v81
    v_cvt_pk_bf16_f32 v81, v82, v83
    v_cvt_pk_bf16_f32 v82, v84, v85
    v_cvt_pk_bf16_f32 v83, v86, v87
    v_mfma_f32_16x16x16_bf16 v[96:99], v[80:81], v[104:105], v[96:99]
    s_nop 0
    v_mfma_f32_16x16x16_bf16 v[100:103], v[82:83], v[104:105], v[100:103]
    v_rcp_f32 v125, v60
    v_mov_b64 v[0:1], 0
    v_mov_b64 v[2:3], 0
    v_mov_b64 v[4:5], 0
    v_mov_b64 v[6:7], 0
    v_mov_b64 v[8:9], 0
    v_mul_f32 v96, v96, v125
    v_mul_f32 v97, v97, v125
    v_mul_f32 v98, v98, v125
    v_mul_f32 v99, v99, v125
    v_cvt_pk_bf16_f32 v96, v96, v97
    v_cvt_pk_bf16_f32 v97, v98, v99
    v_mul_f32 v100, v100, v125
    v_mul_f32 v101, v101, v125
    v_mul_f32 v102, v102, v125
    v_mul_f32 v103, v103, v125
    v_cvt_pk_bf16_f32 v98, v100, v101
    v_cvt_pk_bf16_f32 v99, v102, v103
    ds_write2_b64 v115, v[96:97], v[98:99] offset0:0 offset1:32
    buffer_load_dwordx4 v[88:91], v112, s[52:55], s7 offen sc1
    buffer_load_dwordx4 v[92:95], v112, s[52:55], s7 offen offset:1024 sc1
    s_mov_b32 m0, s81
    v_mov_b32 v121, s68
    v_mov_b32 v104, 0xff81ff81
    v_mov_b32 v105, 0xff81ff81
    v_mov_b32 v106, 0xff81ff81
    v_mov_b32 v107, 0xff81ff81
    v_mov_b64 v[10:11], 0
    v_mov_b64 v[12:13], 0
    v_mov_b64 v[14:15], 0
    v_mov_b64 v[16:17], 0
    v_mov_b64 v[18:19], 0
    v_mov_b64 v[20:21], 0
    v_mov_b64 v[22:23], 0
    v_mov_b64 v[24:25], 0
    v_mov_b64 v[26:27], 0
    v_mov_b64 v[28:29], 0
    v_mov_b64 v[30:31], 0
    s_waitcnt lgkmcnt(0)
    s_barrier
    ds_read_b128 v[80:83], v112 offset:0
    ds_read_b128 v[84:87], v112 offset:1024
    buffer_load_dwordx4 v112, s[52:55], s8 offen offset:0 sc1 lds
    buffer_load_dwordx4 v112, s[52:55], s8 offen offset:1024 sc1 lds
    buffer_store_dwordx4 v[104:107], v112, s[52:55], s69 offen offset:1024
    s_waitcnt lgkmcnt(1)
    v_smfmac_f32_16x16x64_bf16 v[0:3], v[80:83], v[48:55], v120
    ds_read_b128 v[48:51], v119 offset:34816
    s_waitcnt lgkmcnt(1)
    v_smfmac_f32_16x16x64_bf16 v[0:3], v[84:87], v[160:167], v120
    ds_read_b128 v[52:55], v119 offset:35840
    v_smfmac_f32_16x16x64_bf16 v[4:7], v[80:83], v[32:39], v120
    v_smfmac_f32_16x16x64_bf16 v[4:7], v[84:87], v[168:175], v120
    v_smfmac_f32_16x16x64_bf16 v[8:11], v[80:83], v[40:47], v120
    s_nop 3
    v_add_f32 v0, v0, v1
    v_smfmac_f32_16x16x64_bf16 v[8:11], v[84:87], v[176:183], v120
    s_waitcnt lgkmcnt(0)
    v_add_f32 v2, v2, v3
    v_cvt_pk_bf16_f32 v96, v0, v2
    v_smfmac_f32_16x16x64_bf16 v[12:15], v[80:83], v[48:55], v120
    v_add_f32 v4, v4, v5
    v_smfmac_f32_16x16x64_bf16 v[12:15], v[84:87], v[184:191], v120
    v_add_f32 v6, v6, v7
    v_cvt_pk_bf16_f32 v97, v4, v6
    v_smfmac_f32_16x16x64_bf16 v[16:19], v[80:83], v[192:199], v120
    s_mov_b64 exec, s[74:75]
    buffer_store_dword v121, v112, s[52:55], s70 offen
    s_mov_b64 exec, -1
    v_add_f32 v8, v8, v9
    v_smfmac_f32_16x16x64_bf16 v[16:19], v[84:87], v[224:231], v120
    v_add_f32 v10, v10, v11
    v_cvt_pk_bf16_f32 v98, v8, v10
    v_smfmac_f32_16x16x64_bf16 v[20:23], v[80:83], v[200:207], v120
    v_add_f32 v12, v12, v13
    v_smfmac_f32_16x16x64_bf16 v[20:23], v[84:87], v[232:239], v120
    v_add_f32 v14, v14, v15
    v_cvt_pk_bf16_f32 v99, v12, v14
    v_smfmac_f32_16x16x64_bf16 v[24:27], v[80:83], v[208:215], v120
    buffer_store_dwordx4 v[96:99], v117, s[52:55], s10 offen
    v_add_f32 v16, v16, v17
    v_smfmac_f32_16x16x64_bf16 v[24:27], v[84:87], v[240:247], v120
    v_add_f32 v18, v18, v19
    v_cvt_pk_bf16_f32 v100, v16, v18
    v_smfmac_f32_16x16x64_bf16 v[28:31], v[80:83], v[216:223], v120
    v_add_f32 v20, v20, v21
    v_smfmac_f32_16x16x64_bf16 v[28:31], v[84:87], v[248:255], v120
    v_add_f32 v22, v22, v23
    v_cvt_pk_bf16_f32 v101, v20, v22
    s_nop 0
    v_add_f32 v24, v24, v25
    v_add_f32 v26, v26, v27
    v_cvt_pk_bf16_f32 v102, v24, v26
    s_nop 1
    v_add_f32 v28, v28, v29
    v_add_f32 v30, v30, v31
    v_cvt_pk_bf16_f32 v103, v28, v30
    buffer_store_dwordx4 v[100:103], v117, s[52:55], s15 offen
    s_barrier
    s_cmp_lg_u32 s4, 0
    s_cbranch_scc1 R_nored_25
    s_add_u32 s9, s88, s89
    v_mov_b32 v76, 0
R_hl_31:
    buffer_load_dword v76, v116, s[52:55], s72 offen sc1
    s_waitcnt vmcnt(8)
    v_cmp_ne_u32 vcc, v76, v121
    s_nop 0
    s_cbranch_vccz R_hok_32
    v_cmp_ne_u32 vcc, v76, v121
    s_nop 0
    s_cbranch_vccz R_hok_32
    buffer_load_dword v76, v116, s[52:55], s72 offen sc1
    s_waitcnt vmcnt(8)
    v_cmp_ne_u32 vcc, v76, v121
    s_nop 0
    s_cbranch_vccz R_hok_32
    v_cmp_ne_u32 vcc, v76, v121
    s_nop 0
    s_cbranch_vccz R_hok_32
    buffer_load_dword v76, v116, s[52:55], s72 offen sc1
    s_waitcnt vmcnt(8)
    v_cmp_ne_u32 vcc, v76, v121
    s_nop 0
    s_cbranch_vccz R_hok_32
    v_cmp_ne_u32 vcc, v76, v121
    s_nop 0
    s_cbranch_vccz R_hok_32
    buffer_load_dword v76, v116, s[52:55], s72 offen sc1
    s_waitcnt vmcnt(8)
    v_cmp_ne_u32 vcc, v76, v121
    s_nop 0
    s_cbranch_vccz R_hok_32
    v_cmp_ne_u32 vcc, v76, v121
    s_nop 0
    s_cbranch_vccz R_hok_32
    s_add_u32 s79, s79, 1
    s_cmp_gt_u32 s79, 2097152
    s_cbranch_scc1 mega_kernel_exit
    s_branch R_hl_31
R_hok_32:
R_poll1_28:
    buffer_load_dwordx4 v[0:3], v112, s[52:55], s11 offen offset:0 sc1
    buffer_load_dwordx4 v[4:7], v112, s[52:55], s11 offen offset:1024 sc1
    buffer_load_dwordx4 v[8:11], v112, s[52:55], s11 offen offset:2048 sc1
    buffer_load_dwordx4 v[12:15], v112, s[52:55], s11 offen offset:3072 sc1
    buffer_load_dwordx4 v[16:19], v112, s[52:55], s12 offen offset:0 sc1
    buffer_load_dwordx4 v[20:23], v112, s[52:55], s12 offen offset:1024 sc1
    buffer_load_dwordx4 v[24:27], v112, s[52:55], s12 offen offset:2048 sc1
    buffer_load_dwordx4 v[28:31], v112, s[52:55], s12 offen offset:3072 sc1
    s_add_u32 s79, s79, 1
    s_cmp_gt_u32 s79, 2097152
    s_cbranch_scc1 mega_kernel_exit
    v_bfe_u32 v122, v112, 4, 2
    v_bfe_u32 v123, v112, 6, 2
    v_mov_b32 v104, 0x3f80
    v_mov_b32 v105, 0x3f800000
    v_cmp_gt_u32 vcc, 3, v122
    s_nop 1
    v_cndmask_b32 v106, v105, v104, vcc
    v_cndmask_b32 v122, 0, v122, vcc
    v_or_b32 v122, 12, v122
    v_mul_u32_u24 v127, 0x1111, v122
    v_cmp_eq_u32 vcc, 0, v123
    s_nop 1
    v_cndmask_b32 v104, 0, v106, vcc
    v_cmp_eq_u32 vcc, 1, v123
    s_nop 1
    v_cndmask_b32 v105, 0, v106, vcc
    v_mov_b32 v106, v104
    v_mov_b32 v107, v105
    v_mov_b64 v[72:73], 0
    v_mov_b64 v[74:75], 0
    v_mov_b32 v126, v126
    v_mov_b32 v126, v126
    v_mov_b32 v126, v126
    v_mov_b32 v126, v126
    v_mov_b32 v126, v126
    v_mov_b32 v126, v126
    v_mov_b32 v126, v126
    v_mov_b32 v126, v126
    v_mov_b32 v126, v126
    v_mov_b32 v126, v126
    v_mov_b32 v126, v126
    v_mov_b32 v126, v126
    s_mov_b64 exec, s[74:75]
    buffer_store_dword v121, v112, s[52:55], s71 offen
    s_mov_b64 exec, -1
    v_mov_b32 v122, 0xff81ff81
    v_mov_b32 v123, 0xff81ff81
    s_waitcnt vmcnt(7)
    v_smfmac_f32_16x16x64_bf16 v[72:75], v[104:107], v[0:7], v127
    s_waitcnt vmcnt(5)
    v_smfmac_f32_16x16x64_bf16 v[72:75], v[104:107], v[8:15], v127
    s_waitcnt vmcnt(3)
    v_smfmac_f32_16x16x64_bf16 v[72:75], v[104:107], v[16:23], v127
    s_waitcnt vmcnt(1)
    v_smfmac_f32_16x16x64_bf16 v[72:75], v[104:107], v[24:31], v127
    v_mov_b32 v126, v126
    v_mov_b32 v126, v126
    v_mov_b32 v126, v126
    v_mov_b32 v126, v126
    v_mov_b32 v126, v126
    v_mov_b32 v126, v126
    v_mov_b32 v126, v126
    s_nop 0
    v_cmp_u_f32 vcc, v72, v73
    v_cmp_u_f32 s[14:15], v74, v75
    v_cvt_pk_bf16_f32 v124, v72, v74
    v_cvt_pk_bf16_f32 v125, v73, v75
    s_or_b64 vcc, vcc, s[14:15]
    s_cbranch_vccz R_ok1_29
    s_add_u32 s93, s93, 1
    s_and_b32 s14, s93, 3
    s_cbranch_scc1 R_poll1_28
    v_cmp_eq_u32 vcc, v122, v0
    v_cmp_eq_u32 s[14:15], v122, v1
    s_nop 0
    s_or_b64 vcc, vcc, s[14:15]
    v_cmp_eq_u32 s[14:15], v122, v2
    s_nop 0
    s_or_b64 vcc, vcc, s[14:15]
    v_cmp_eq_u32 s[14:15], v122, v3
    s_nop 0
    s_or_b64 vcc, vcc, s[14:15]
    v_cmp_eq_u32 s[14:15], v122, v4
    s_nop 0
    s_or_b64 vcc, vcc, s[14:15]
    v_cmp_eq_u32 s[14:15], v122, v5
    s_nop 0
    s_or_b64 vcc, vcc, s[14:15]
    v_cmp_eq_u32 s[14:15], v122, v6
    s_nop 0
    s_or_b64 vcc, vcc, s[14:15]
    v_cmp_eq_u32 s[14:15], v122, v7
    s_nop 0
    s_or_b64 vcc, vcc, s[14:15]
    v_cmp_eq_u32 s[14:15], v122, v8
    s_nop 0
    s_or_b64 vcc, vcc, s[14:15]
    v_cmp_eq_u32 s[14:15], v122, v9
    s_nop 0
    s_or_b64 vcc, vcc, s[14:15]
    v_cmp_eq_u32 s[14:15], v122, v10
    s_nop 0
    s_or_b64 vcc, vcc, s[14:15]
    v_cmp_eq_u32 s[14:15], v122, v11
    s_nop 0
    s_or_b64 vcc, vcc, s[14:15]
    v_cmp_eq_u32 s[14:15], v122, v12
    s_nop 0
    s_or_b64 vcc, vcc, s[14:15]
    v_cmp_eq_u32 s[14:15], v122, v13
    s_nop 0
    s_or_b64 vcc, vcc, s[14:15]
    v_cmp_eq_u32 s[14:15], v122, v14
    s_nop 0
    s_or_b64 vcc, vcc, s[14:15]
    v_cmp_eq_u32 s[14:15], v122, v15
    s_nop 0
    s_or_b64 vcc, vcc, s[14:15]
    v_cmp_eq_u32 s[14:15], v122, v16
    s_nop 0
    s_or_b64 vcc, vcc, s[14:15]
    v_cmp_eq_u32 s[14:15], v122, v17
    s_nop 0
    s_or_b64 vcc, vcc, s[14:15]
    v_cmp_eq_u32 s[14:15], v122, v18
    s_nop 0
    s_or_b64 vcc, vcc, s[14:15]
    v_cmp_eq_u32 s[14:15], v122, v19
    s_nop 0
    s_or_b64 vcc, vcc, s[14:15]
    v_cmp_eq_u32 s[14:15], v122, v20
    s_nop 0
    s_or_b64 vcc, vcc, s[14:15]
    v_cmp_eq_u32 s[14:15], v122, v21
    s_nop 0
    s_or_b64 vcc, vcc, s[14:15]
    v_cmp_eq_u32 s[14:15], v122, v22
    s_nop 0
    s_or_b64 vcc, vcc, s[14:15]
    v_cmp_eq_u32 s[14:15], v122, v23
    s_nop 0
    s_or_b64 vcc, vcc, s[14:15]
    v_cmp_eq_u32 s[14:15], v122, v24
    s_nop 0
    s_or_b64 vcc, vcc, s[14:15]
    v_cmp_eq_u32 s[14:15], v122, v25
    s_nop 0
    s_or_b64 vcc, vcc, s[14:15]
    v_cmp_eq_u32 s[14:15], v122, v26
    s_nop 0
    s_or_b64 vcc, vcc, s[14:15]
    v_cmp_eq_u32 s[14:15], v122, v27
    s_nop 0
    s_or_b64 vcc, vcc, s[14:15]
    v_cmp_eq_u32 s[14:15], v122, v28
    s_nop 0
    s_or_b64 vcc, vcc, s[14:15]
    v_cmp_eq_u32 s[14:15], v122, v29
    s_nop 0
    s_or_b64 vcc, vcc, s[14:15]
    v_cmp_eq_u32 s[14:15], v122, v30
    s_nop 0
    s_or_b64 vcc, vcc, s[14:15]
    v_cmp_eq_u32 s[14:15], v122, v31
    s_nop 0
    s_or_b64 vcc, vcc, s[14:15]
    s_cbranch_vccnz R_poll1_28
R_ok1_29:
    buffer_store_dwordx2 v[124:125], v118, s[52:55], s9 offen
    s_add_u32 s9, s13, s89
    buffer_store_dwordx2 v[122:123], v118, s[52:55], s9 offen
    ds_read_b128 v[32:35], v119 offset:0
    ds_read_b128 v[36:39], v119 offset:1024
    ds_read_b128 v[40:43], v119 offset:2048
    ds_read_b128 v[44:47], v119 offset:3072
    ds_read_b128 v[48:51], v119 offset:4096
    ds_read_b128 v[52:55], v119 offset:5120
    v_mov_b64 v[56:57], 0
    v_mov_b64 v[58:59], 0
    v_mov_b64 v[60:61], 0
    v_mov_b64 v[62:63], 0
    v_mov_b64 v[64:65], 0
    v_mov_b64 v[66:67], 0
    v_mov_b64 v[68:69], 0
    v_mov_b64 v[70:71], 0
    v_mov_b32 v80, 0xff81ff81
    v_mov_b32 v81, 0xff81ff81
    v_mov_b32 v82, 0xff81ff81
    v_mov_b32 v83, 0xff81ff81
    s_branch R_join_26
R_nored_25:
    ds_read_b128 v[32:35], v119 offset:0
    ds_read_b128 v[36:39], v119 offset:1024
    ds_read_b128 v[40:43], v119 offset:2048
    ds_read_b128 v[44:47], v119 offset:3072
    ds_read_b128 v[48:51], v119 offset:4096
    ds_read_b128 v[52:55], v119 offset:5120
    v_mov_b64 v[56:57], 0
    v_mov_b64 v[58:59], 0
    v_mov_b64 v[60:61], 0
    v_mov_b64 v[62:63], 0
    v_mov_b64 v[64:65], 0
    v_mov_b64 v[66:67], 0
    v_mov_b64 v[68:69], 0
    v_mov_b64 v[70:71], 0
    v_mov_b32 v80, 0xff81ff81
    v_mov_b32 v81, 0xff81ff81
    v_mov_b32 v82, 0xff81ff81
    v_mov_b32 v83, 0xff81ff81
    v_lshlrev_b32 v127, 2, v112
    s_cmp_lg_u32 s4, 3
    s_cbranch_scc1 R_join_26
    v_lshlrev_b32 v123, 3, v112
    s_sleep 6
    v_mov_b32 v76, 0
R_hl_33:
    buffer_load_dword v76, v116, s[52:55], s73 offen sc1
    s_waitcnt vmcnt(8)
    v_cmp_ne_u32 vcc, v76, v121
    s_nop 0
    s_cbranch_vccz R_hok_34
    v_cmp_ne_u32 vcc, v76, v121
    s_nop 0
    s_cbranch_vccz R_hok_34
    buffer_load_dword v76, v116, s[52:55], s73 offen sc1
    s_waitcnt vmcnt(8)
    v_cmp_ne_u32 vcc, v76, v121
    s_nop 0
    s_cbranch_vccz R_hok_34
    v_cmp_ne_u32 vcc, v76, v121
    s_nop 0
    s_cbranch_vccz R_hok_34
    buffer_load_dword v76, v116, s[52:55], s73 offen sc1
    s_waitcnt vmcnt(8)
    v_cmp_ne_u32 vcc, v76, v121
    s_nop 0
    s_cbranch_vccz R_hok_34
    v_cmp_ne_u32 vcc, v76, v121
    s_nop 0
    s_cbranch_vccz R_hok_34
    buffer_load_dword v76, v116, s[52:55], s73 offen sc1
    s_waitcnt vmcnt(8)
    v_cmp_ne_u32 vcc, v76, v121
    s_nop 0
    s_cbranch_vccz R_hok_34
    v_cmp_ne_u32 vcc, v76, v121
    s_nop 0
    s_cbranch_vccz R_hok_34
    s_add_u32 s79, s79, 1
    s_cmp_gt_u32 s79, 2097152
    s_cbranch_scc1 mega_kernel_exit
    s_branch R_hl_33
R_hok_34:
    s_add_u32 s9, s88, 229376
    s_mov_b32 m0, 0
    s_add_u32 s14, s9, 4096
    buffer_load_dwordx4 v112, s[52:55], s9 offen offset:0 sc1 lds
    buffer_load_dwordx4 v112, s[52:55], s9 offen offset:1024 sc1 lds
    buffer_load_dwordx4 v112, s[52:55], s9 offen offset:2048 sc1 lds
    buffer_load_dwordx4 v112, s[52:55], s9 offen offset:3072 sc1 lds
    s_movk_i32 m0, 4096
    s_nop 0
    buffer_load_dwordx4 v112, s[52:55], s14 offen offset:0 sc1 lds
    buffer_load_dwordx4 v112, s[52:55], s14 offen offset:1024 sc1 lds
    buffer_load_dwordx4 v112, s[52:55], s14 offen offset:2048 sc1 lds
    buffer_load_dwordx4 v112, s[52:55], s14 offen offset:3072 sc1 lds
R_join_26:
    s_waitcnt vmcnt(0) lgkmcnt(0)
R_join0_27:
    s_add_u32 s5, s5, 1
    s_cmp_lg_u32 s5, 63
    s_barrier
    s_cbranch_scc1 R_top_16
    s_branch R_done_14
R_bad_23:
    s_mov_b32 s14, 0xff81
    s_mov_b64 s[12:13], 0
    v_and_b32 v122, 0xffff, v0
    v_lshrrev_b32 v123, 16, v0
    v_cmp_eq_u32 vcc, s14, v122
    s_nop 0
    s_or_b64 s[12:13], s[12:13], vcc
    v_cmp_eq_u32 vcc, s14, v123
    s_nop 0
    s_or_b64 s[12:13], s[12:13], vcc
    v_and_b32 v122, 0xffff, v1
    v_lshrrev_b32 v123, 16, v1
    v_cmp_eq_u32 vcc, s14, v122
    s_nop 0
    s_or_b64 s[12:13], s[12:13], vcc
    v_cmp_eq_u32 vcc, s14, v123
    s_nop 0
    s_or_b64 s[12:13], s[12:13], vcc
    v_and_b32 v122, 0xffff, v2
    v_lshrrev_b32 v123, 16, v2
    v_cmp_eq_u32 vcc, s14, v122
    s_nop 0
    s_or_b64 s[12:13], s[12:13], vcc
    v_cmp_eq_u32 vcc, s14, v123
    s_nop 0
    s_or_b64 s[12:13], s[12:13], vcc
    v_and_b32 v122, 0xffff, v3
    v_lshrrev_b32 v123, 16, v3
    v_cmp_eq_u32 vcc, s14, v122
    s_nop 0
    s_or_b64 s[12:13], s[12:13], vcc
    v_cmp_eq_u32 vcc, s14, v123
    s_nop 0
    s_or_b64 s[12:13], s[12:13], vcc
    v_and_b32 v122, 0xffff, v4
    v_lshrrev_b32 v123, 16, v4
    v_cmp_eq_u32 vcc, s14, v122
    s_nop 0
    s_or_b64 s[12:13], s[12:13], vcc
    v_cmp_eq_u32 vcc, s14, v123
    s_nop 0
    s_or_b64 s[12:13], s[12:13], vcc
    v_and_b32 v122, 0xffff, v5
    v_lshrrev_b32 v123, 16, v5
    v_cmp_eq_u32 vcc, s14, v122
    s_nop 0
    s_or_b64 s[12:13], s[12:13], vcc
    v_cmp_eq_u32 vcc, s14, v123
    s_nop 0
    s_or_b64 s[12:13], s[12:13], vcc
    v_and_b32 v122, 0xffff, v6
    v_lshrrev_b32 v123, 16, v6
    v_cmp_eq_u32 vcc, s14, v122
    s_nop 0
    s_or_b64 s[12:13], s[12:13], vcc
    v_cmp_eq_u32 vcc, s14, v123
    s_nop 0
    s_or_b64 s[12:13], s[12:13], vcc
    v_and_b32 v122, 0xffff, v7
    v_lshrrev_b32 v123, 16, v7
    v_cmp_eq_u32 vcc, s14, v122
    s_nop 0
    s_or_b64 s[12:13], s[12:13], vcc
    v_cmp_eq_u32 vcc, s14, v123
    s_nop 0
    s_or_b64 s[12:13], s[12:13], vcc
    v_and_b32 v122, 0xffff, v8
    v_lshrrev_b32 v123, 16, v8
    v_cmp_eq_u32 vcc, s14, v122
    s_nop 0
    s_or_b64 s[12:13], s[12:13], vcc
    v_cmp_eq_u32 vcc, s14, v123
    s_nop 0
    s_or_b64 s[12:13], s[12:13], vcc
    v_and_b32 v122, 0xffff, v9
    v_lshrrev_b32 v123, 16, v9
    v_cmp_eq_u32 vcc, s14, v122
    s_nop 0
    s_or_b64 s[12:13], s[12:13], vcc
    v_cmp_eq_u32 vcc, s14, v123
    s_nop 0
    s_or_b64 s[12:13], s[12:13], vcc
    v_and_b32 v122, 0xffff, v10
    v_lshrrev_b32 v123, 16, v10
    v_cmp_eq_u32 vcc, s14, v122
    s_nop 0
    s_or_b64 s[12:13], s[12:13], vcc
    v_cmp_eq_u32 vcc, s14, v123
    s_nop 0
    s_or_b64 s[12:13], s[12:13], vcc
    v_and_b32 v122, 0xffff, v11
    v_lshrrev_b32 v123, 16, v11
    v_cmp_eq_u32 vcc, s14, v122
    s_nop 0
    s_or_b64 s[12:13], s[12:13], vcc
    v_cmp_eq_u32 vcc, s14, v123
    s_nop 0
    s_or_b64 s[12:13], s[12:13], vcc
    v_and_b32 v122, 0xffff, v12
    v_lshrrev_b32 v123, 16, v12
    v_cmp_eq_u32 vcc, s14, v122
    s_nop 0
    s_or_b64 s[12:13], s[12:13], vcc
    v_cmp_eq_u32 vcc, s14, v123
    s_nop 0
    s_or_b64 s[12:13], s[12:13], vcc
    v_and_b32 v122, 0xffff, v13
    v_lshrrev_b32 v123, 16, v13
    v_cmp_eq_u32 vcc, s14, v122
    s_nop 0
    s_or_b64 s[12:13], s[12:13], vcc
    v_cmp_eq_u32 vcc, s14, v123
    s_nop 0
    s_or_b64 s[12:13], s[12:13], vcc
    v_and_b32 v122, 0xffff, v14
    v_lshrrev_b32 v123, 16, v14
    v_cmp_eq_u32 vcc, s14, v122
    s_nop 0
    s_or_b64 s[12:13], s[12:13], vcc
    v_cmp_eq_u32 vcc, s14, v123
    s_nop 0
    s_or_b64 s[12:13], s[12:13], vcc
    v_and_b32 v122, 0xffff, v15
    v_lshrrev_b32 v123, 16, v15
    v_cmp_eq_u32 vcc, s14, v122
    s_nop 0
    s_or_b64 s[12:13], s[12:13], vcc
    v_cmp_eq_u32 vcc, s14, v123
    s_nop 0
    s_or_b64 s[12:13], s[12:13], vcc
    v_and_b32 v122, 0xffff, v16
    v_lshrrev_b32 v123, 16, v16
    v_cmp_eq_u32 vcc, s14, v122
    s_nop 0
    s_or_b64 s[12:13], s[12:13], vcc
    v_cmp_eq_u32 vcc, s14, v123
    s_nop 0
    s_or_b64 s[12:13], s[12:13], vcc
    v_and_b32 v122, 0xffff, v17
    v_lshrrev_b32 v123, 16, v17
    v_cmp_eq_u32 vcc, s14, v122
    s_nop 0
    s_or_b64 s[12:13], s[12:13], vcc
    v_cmp_eq_u32 vcc, s14, v123
    s_nop 0
    s_or_b64 s[12:13], s[12:13], vcc
    v_and_b32 v122, 0xffff, v18
    v_lshrrev_b32 v123, 16, v18
    v_cmp_eq_u32 vcc, s14, v122
    s_nop 0
    s_or_b64 s[12:13], s[12:13], vcc
    v_cmp_eq_u32 vcc, s14, v123
    s_nop 0
    s_or_b64 s[12:13], s[12:13], vcc
    v_and_b32 v122, 0xffff, v19
    v_lshrrev_b32 v123, 16, v19
    v_cmp_eq_u32 vcc, s14, v122
    s_nop 0
    s_or_b64 s[12:13], s[12:13], vcc
    v_cmp_eq_u32 vcc, s14, v123
    s_nop 0
    s_or_b64 s[12:13], s[12:13], vcc
    v_and_b32 v122, 0xffff, v20
    v_lshrrev_b32 v123, 16, v20
    v_cmp_eq_u32 vcc, s14, v122
    s_nop 0
    s_or_b64 s[12:13], s[12:13], vcc
    v_cmp_eq_u32 vcc, s14, v123
    s_nop 0
    s_or_b64 s[12:13], s[12:13], vcc
    v_and_b32 v122, 0xffff, v21
    v_lshrrev_b32 v123, 16, v21
    v_cmp_eq_u32 vcc, s14, v122
    s_nop 0
    s_or_b64 s[12:13], s[12:13], vcc
    v_cmp_eq_u32 vcc, s14, v123
    s_nop 0
    s_or_b64 s[12:13], s[12:13], vcc
    v_and_b32 v122, 0xffff, v22
    v_lshrrev_b32 v123, 16, v22
    v_cmp_eq_u32 vcc, s14, v122
    s_nop 0
    s_or_b64 s[12:13], s[12:13], vcc
    v_cmp_eq_u32 vcc, s14, v123
    s_nop 0
    s_or_b64 s[12:13], s[12:13], vcc
    v_and_b32 v122, 0xffff, v23
    v_lshrrev_b32 v123, 16, v23
    v_cmp_eq_u32 vcc, s14, v122
    s_nop 0
    s_or_b64 s[12:13], s[12:13], vcc
    v_cmp_eq_u32 vcc, s14, v123
    s_nop 0
    s_or_b64 s[12:13], s[12:13], vcc
    v_and_b32 v122, 0xffff, v24
    v_lshrrev_b32 v123, 16, v24
    v_cmp_eq_u32 vcc, s14, v122
    s_nop 0
    s_or_b64 s[12:13], s[12:13], vcc
    v_cmp_eq_u32 vcc, s14, v123
    s_nop 0
    s_or_b64 s[12:13], s[12:13], vcc
    v_and_b32 v122, 0xffff, v25
    v_lshrrev_b32 v123, 16, v25
    v_cmp_eq_u32 vcc, s14, v122
    s_nop 0
    s_or_b64 s[12:13], s[12:13], vcc
    v_cmp_eq_u32 vcc, s14, v123
    s_nop 0
    s_or_b64 s[12:13], s[12:13], vcc
    v_and_b32 v122, 0xffff, v26
    v_lshrrev_b32 v123, 16, v26
    v_cmp_eq_u32 vcc, s14, v122
    s_nop 0
    s_or_b64 s[12:13], s[12:13], vcc
    v_cmp_eq_u32 vcc, s14, v123
    s_nop 0
    s_or_b64 s[12:13], s[12:13], vcc
    v_and_b32 v122, 0xffff, v27
    v_lshrrev_b32 v123, 16, v27
    v_cmp_eq_u32 vcc, s14, v122
    s_nop 0
    s_or_b64 s[12:13], s[12:13], vcc
    v_cmp_eq_u32 vcc, s14, v123
    s_nop 0
    s_or_b64 s[12:13], s[12:13], vcc
    v_and_b32 v122, 0xffff, v28
    v_lshrrev_b32 v123, 16, v28
    v_cmp_eq_u32 vcc, s14, v122
    s_nop 0
    s_or_b64 s[12:13], s[12:13], vcc
    v_cmp_eq_u32 vcc, s14, v123
    s_nop 0
    s_or_b64 s[12:13], s[12:13], vcc
    v_and_b32 v122, 0xffff, v29
    v_lshrrev_b32 v123, 16, v29
    v_cmp_eq_u32 vcc, s14, v122
    s_nop 0
    s_or_b64 s[12:13], s[12:13], vcc
    v_cmp_eq_u32 vcc, s14, v123
    s_nop 0
    s_or_b64 s[12:13], s[12:13], vcc
    v_and_b32 v122, 0xffff, v30
    v_lshrrev_b32 v123, 16, v30
    v_cmp_eq_u32 vcc, s14, v122
    s_nop 0
    s_or_b64 s[12:13], s[12:13], vcc
    v_cmp_eq_u32 vcc, s14, v123
    s_nop 0
    s_or_b64 s[12:13], s[12:13], vcc
    v_and_b32 v122, 0xffff, v31
    v_lshrrev_b32 v123, 16, v31
    v_cmp_eq_u32 vcc, s14, v122
    s_nop 0
    s_or_b64 s[12:13], s[12:13], vcc
    v_cmp_eq_u32 vcc, s14, v123
    s_nop 0
    s_or_b64 s[12:13], s[12:13], vcc
    s_cmp_eq_u64 s[12:13], 0
    s_cbranch_scc1 R_good_24
    s_add_u32 s79, s79, 1
    s_cmp_gt_u32 s79, 2097152
    s_cbranch_scc1 mega_kernel_exit
    s_waitcnt lgkmcnt(0)
    s_barrier
    s_cmp_lg_u32 s4, 1
    s_cbranch_scc1 R_nd_35
    s_add_u32 s9, s88, 229376
    s_mov_b32 m0, 0
    s_add_u32 s14, s9, 4096
    buffer_load_dwordx4 v112, s[52:55], s9 offen offset:0 sc1 lds
    buffer_load_dwordx4 v112, s[52:55], s9 offen offset:1024 sc1 lds
    buffer_load_dwordx4 v112, s[52:55], s9 offen offset:2048 sc1 lds
    buffer_load_dwordx4 v112, s[52:55], s9 offen offset:3072 sc1 lds
    s_movk_i32 m0, 4096
    s_nop 0
    buffer_load_dwordx4 v112, s[52:55], s14 offen offset:0 sc1 lds
    buffer_load_dwordx4 v112, s[52:55], s14 offen offset:1024 sc1 lds
    buffer_load_dwordx4 v112, s[52:55], s14 offen offset:2048 sc1 lds
    buffer_load_dwordx4 v112, s[52:55], s14 offen offset:3072 sc1 lds
    s_waitcnt vmcnt(0)
R_nd_35:
    ds_read_b128 v[32:35], v119 offset:0
    ds_read_b128 v[36:39], v119 offset:1024
    ds_read_b128 v[40:43], v119 offset:2048
    ds_read_b128 v[44:47], v119 offset:3072
    ds_read_b128 v[48:51], v119 offset:4096
    ds_read_b128 v[52:55], v119 offset:5120
    v_mov_b64 v[56:57], 0
    v_mov_b64 v[58:59], 0
    v_mov_b64 v[60:61], 0
    v_mov_b64 v[62:63], 0
    v_mov_b64 v[64:65], 0
    v_mov_b64 v[66:67], 0
    v_mov_b64 v[68:69], 0
    v_mov_b64 v[70:71], 0
    v_mov_b32 v80, 0xff81ff81
    v_mov_b32 v81, 0xff81ff81
    v_mov_b32 v82, 0xff81ff81
    v_mov_b32 v83, 0xff81ff81
    s_waitcnt lgkmcnt(0)
    s_barrier
    s_branch R_top_16
R_slow_15:
R_top_36:
    ds_read_b64_tr_b16 v[0:1], v113 offset:0
    ds_read_b64_tr_b16 v[2:3], v113 offset:256
    ds_read_b64_tr_b16 v[4:5], v113 offset:1024
    ds_read_b64_tr_b16 v[6:7], v113 offset:1280
    ds_read_b64_tr_b16 v[8:9], v113 offset:2048
    ds_read_b64_tr_b16 v[10:11], v113 offset:2304
    s_lshl_b32 s6, s5, 18
    s_add_u32 s69, s91, s84
    buffer_store_dwordx4 v[80:83], v112, s[52:55], s69 offen offset:0 sc1
    s_cmp_lt_u32 s4, 2
    s_cbranch_scc1 R_notouch_39
    s_add_u32 s14, s5, 3
    s_min_u32 s14, s14, 64
    v_cmp_gt_u32 vcc, s14, v126
    s_nop 0
    s_cbranch_vccz R_pok_40
FW_41:
    buffer_load_dword v126, off, s[52:55], s78 sc1
    s_add_u32 s79, s79, 1
    s_cmp_gt_u32 s79, 2097152
    s_cbranch_scc1 mega_kernel_exit
    s_waitcnt vmcnt(0)
    v_cmp_gt_u32 vcc, s14, v126
    s_nop 0
    s_cbranch_vccz FWok_42
    s_sleep 1
    s_branch FW_41
FWok_42:
R_pok_40:
    s_add_u32 s9, s6, s87
    buffer_load_dword v126, v127, s[52:55], s9 offen sc1
    s_add_u32 s9, s9, 4096
    buffer_load_dword v126, v127, s[52:55], s9 offen sc1
    buffer_load_dword v126, off, s[52:55], s78 sc1
R_notouch_39:
    s_add_u32 s7, s6, s80
    s_add_u32 s8, s6, s92
    s_waitcnt lgkmcnt(4)
    v_smfmac_f32_16x16x64_bf16 v[56:59], v[0:3], v[32:39], v120
    ds_read_b64_tr_b16 v[12:13], v113 offset:3072
    ds_read_b64_tr_b16 v[14:15], v113 offset:3328
    v_smfmac_f32_16x16x64_bf16 v[60:63], v[0:3], v[40:47], v120
    ds_read_b64_tr_b16 v[16:17], v113 offset:4096
    ds_read_b64_tr_b16 v[18:19], v113 offset:4352
    s_waitcnt lgkmcnt(6)
    v_smfmac_f32_16x16x64_bf16 v[56:59], v[4:7], a[0:7], v120
    ds_read_b64_tr_b16 v[20:21], v113 offset:5120
    ds_read_b64_tr_b16 v[22:23], v113 offset:5376
    v_smfmac_f32_16x16x64_bf16 v[60:63], v[4:7], a[8:15], v120
    ds_read_b64_tr_b16 v[24:25], v113 offset:6144
    ds_read_b64_tr_b16 v[26:27], v113 offset:6400
    s_waitcnt lgkmcnt(8)
    v_smfmac_f32_16x16x64_bf16 v[56:59], v[8:11], a[16:23], v120
    ds_read_b64_tr_b16 v[28:29], v113 offset:7168
    ds_read_b64_tr_b16 v[30:31], v113 offset:7424
    v_smfmac_f32_16x16x64_bf16 v[60:63], v[8:11], a[24:31], v120
    s_lshl_b32 s10, s5, 13
    ds_read_b128 v[32:35], v119 offset:6144
    s_waitcnt lgkmcnt(9)
    v_smfmac_f32_16x16x64_bf16 v[56:59], v[12:15], a[32:39], v120
    s_add_u32 s10, s10, s77
    ds_read_b128 v[36:39], v119 offset:7168
    v_smfmac_f32_16x16x64_bf16 v[60:63], v[12:15], a[40:47], v120
    buffer_store_dwordx2 v[124:125], v118, s[52:55], s10 offen sc1
    ds_read_b128 v[40:43], v119 offset:8192
    s_waitcnt lgkmcnt(9)
    v_smfmac_f32_16x16x64_bf16 v[56:59], v[16:19], a[48:55], v120
    ds_read_b128 v[44:47], v119 offset:9216
    v_mov_b64 v[80:81], 0
    v_smfmac_f32_16x16x64_bf16 v[60:63], v[16:19], a[56:63], v120
    ds_read_b128 v[72:75], v112 offset:8192
    s_waitcnt lgkmcnt(9)
    v_mov_b64 v[82:83], 0
    v_smfmac_f32_16x16x64_bf16 v[56:59], v[20:23], a[64:71], v120
    ds_read_b128 v[76:79], v112 offset:9216
    v_mov_b64 v[84:85], 0
    v_smfmac_f32_16x16x64_bf16 v[60:63], v[20:23], a[72:79], v120
    ds_read_b128 v[96:99], v112 offset:10240
    s_waitcnt lgkmcnt(9)
    v_mov_b64 v[86:87], 0
    v_smfmac_f32_16x16x64_bf16 v[56:59], v[24:27], a[80:87], v120
    ds_read_b128 v[100:103], v112 offset:11264
    v_smfmac_f32_16x16x64_bf16 v[60:63], v[24:27], a[88:95], v120
    ds_read_b128 v[104:107], v112 offset:12288
    s_waitcnt lgkmcnt(9)
    v_smfmac_f32_16x16x64_bf16 v[56:59], v[28:31], v[48:55], v120
    s_barrier
    s_waitcnt lgkmcnt(7)
    v_smfmac_f32_16x16x64_bf16 v[60:63], v[28:31], v[32:39], v120
    ds_read_b128 v[48:51], v119 offset:10240
    v_smfmac_f32_16x16x64_bf16 v[64:67], v[0:3], a[96:103], v120
    ds_read_b128 v[52:55], v119 offset:11264
    v_smfmac_f32_16x16x64_bf16 v[68:71], v[0:3], a[104:111], v120
    ds_read_b128 v[32:35], v119 offset:12288
    v_smfmac_f32_16x16x64_bf16 v[64:67], v[4:7], a[112:119], v120
    ds_read_b128 v[36:39], v119 offset:13312
    v_add_f32 v56, v56, v57
    v_add_f32 v58, v58, v59
    v_smfmac_f32_16x16x64_bf16 v[68:71], v[4:7], a[120:127], v120
    v_cmp_u_f32 vcc, v56, v58
    v_cvt_pk_bf16_f32 v56, v56, v58
    v_add_f32 v60, v60, v61
    v_smfmac_f32_16x16x64_bf16 v[64:67], v[8:11], a[128:135], v120
    s_cbranch_vccnz R_bad_43
R_good_44:
    v_add_f32 v62, v62, v63
    v_cvt_pk_bf16_f32 v60, v60, v62
    v_smfmac_f32_16x16x64_bf16 v[68:71], v[8:11], a[136:143], v120
    ds_write2st64_b32 v114, v56, v60 offset0:0 offset1:2
    s_waitcnt lgkmcnt(10)
    v_smfmac_f32_16x16x64_bf16 v[64:67], v[12:15], v[40:47], v120
    s_add_u32 s10, s90, s85
    s_add_u32 s11, s90, s86
    s_waitcnt lgkmcnt(3)
    v_smfmac_f32_16x16x64_bf16 v[68:71], v[12:15], v[48:55], v120
    ds_read_b128 v[40:43], v119 offset:14336
    v_smfmac_f32_16x16x64_bf16 v[64:67], v[16:19], a[144:151], v120
    ds_read_b128 v[44:47], v119 offset:15360
    v_smfmac_f32_16x16x64_bf16 v[68:71], v[16:19], a[152:159], v120
    s_waitcnt lgkmcnt(2)
    v_smfmac_f32_16x16x64_bf16 v[64:67], v[20:23], a[160:167], v120
    s_barrier
    ds_read_b64_tr_b16 a[240:241], v113 offset:0
    ds_read_b64_tr_b16 a[242:243], v113 offset:256
    v_smfmac_f32_16x16x64_bf16 v[68:71], v[20:23], a[168:175], v120
    ds_read_b64_tr_b16 a[244:245], v113 offset:1024
    ds_read_b64_tr_b16 a[246:247], v113 offset:1280
    v_smfmac_f32_16x16x64_bf16 v[64:67], v[24:27], a[176:183], v120
    ds_read_b64_tr_b16 a[248:249], v113 offset:2048
    ds_read_b64_tr_b16 a[250:251], v113 offset:2304
    v_smfmac_f32_16x16x64_bf16 v[68:71], v[24:27], a[184:191], v120
    ds_read_b64_tr_b16 a[252:253], v113 offset:3072
    ds_read_b64_tr_b16 a[254:255], v113 offset:3328
    v_smfmac_f32_16x16x64_bf16 v[64:67], v[28:31], a[192:199], v120
    ds_read_b128 v[48:51], v119 offset:16384
    v_smfmac_f32_16x16x64_bf16 v[68:71], v[28:31], a[200:207], v120
    ds_read_b128 v[52:55], v119 offset:17408
    s_waitcnt lgkmcnt(8)
    v_mfma_f32_16x16x32_bf16 v[56:59], v[72:75], a[240:243], 0
    ds_read_b128 v[72:75], v112 offset:13312
    s_waitcnt lgkmcnt(7)
    v_mfma_f32_16x16x32_bf16 v[56:59], v[76:79], a[244:247], v[56:59]
    ds_read_b128 v[76:79], v112 offset:14336
    s_waitcnt lgkmcnt(6)
    v_add_f32 v64, v64, v65
    v_add_f32 v66, v66, v67
    v_mfma_f32_16x16x32_bf16 v[56:59], v[96:99], a[248:251], v[56:59]
    ds_read_b128 v[96:99], v112 offset:15360
    s_waitcnt lgkmcnt(5)
    v_cvt_pk_bf16_f32 v64, v64, v66
    v_add_f32 v68, v68, v69
    v_mfma_f32_16x16x32_bf16 v[56:59], v[100:103], a[252:255], v[56:59]
    s_add_u32 s12, s11, 4096
    s_mov_b32 s93, 0
    v_add_f32 v70, v70, v71
    v_cvt_pk_bf16_f32 v68, v68, v70
    v_mfma_f32_16x16x32_bf16 v[60:63], v[104:107], a[240:243], 0
    ds_write2st64_b32 v114, v64, v68 offset0:16 offset1:18
    s_add_u32 s15, s10, 131072
    s_mov_b32 s13, s88
    s_waitcnt lgkmcnt(3)
    v_mfma_f32_16x16x32_bf16 v[60:63], v[72:75], a[244:247], v[60:63]
    s_add_u32 s88, s88, 8192
    s_cmp_eq_u32 s88, 24576
    s_cselect_b32 s88, 0, s88
    s_waitcnt lgkmcnt(2)
    v_mfma_f32_16x16x32_bf16 v[60:63], v[76:79], a[248:251], v[60:63]
    s_mov_b32 s91, s90
    s_waitcnt lgkmcnt(1)
    v_max3_f32 v121, v56, v57, v58
    v_max_f32 v121, v121, v59
    v_mfma_f32_16x16x32_bf16 v[60:63], v[96:99], a[252:255], v[60:63]
    s_add_u32 s90, s90, 262144
    s_cmp_eq_u32 s90, 786432
    s_cselect_b32 s90, 0, s90
    v_smfmac_f32_16x16x64_bf16 v[80:83], v[0:3], v[32:39], v120
    s_waitcnt lgkmcnt(0)
    ds_read_b128 v[32:35], v119 offset:18432
    ds_read_b128 v[36:39], v119 offset:19456
    v_smfmac_f32_16x16x64_bf16 v[84:87], v[0:3], v[40:47], v120
    s_barrier
    ds_read_b64_tr_b16 v[64:65], v113 offset:4096
    ds_read_b64_tr_b16 v[66:67], v113 offset:4352
    v_max3_f32 v121, v121, v60, v61
    v_max3_f32 v121, v121, v62, v63
    v_smfmac_f32_16x16x64_bf16 v[80:83], v[4:7], a[208:215], v120
    ds_read_b64_tr_b16 v[68:69], v113 offset:5120
    ds_read_b64_tr_b16 v[70:71], v113 offset:5376
    v_mov_b32 v123, v121
    v_smfmac_f32_16x16x64_bf16 v[84:87], v[4:7], a[216:223], v120
    ds_read_b64_tr_b16 v[72:73], v113 offset:6144
    ds_read_b64_tr_b16 v[74:75], v113 offset:6400
    v_permlane32_swap_b32 v121, v123
    v_max_f32 v121, v121, v123
    v_smfmac_f32_16x16x64_bf16 v[80:83], v[8:11], v[48:55], v120
    ds_read_b64_tr_b16 v[76:77], v113 offset:7168
    ds_read_b64_tr_b16 v[78:79], v113 offset:7424
    s_waitcnt lgkmcnt(8)
    v_mov_b32 v123, v121
    v_smfmac_f32_16x16x64_bf16 v[84:87], v[8:11], v[32:39], v120
    ds_read_b128 v[40:43], v119 offset:20480
    s_waitcnt lgkmcnt(7)
    v_permlane16_swap_b32 v121, v123
    v_max_f32 v121, v121, v123
    v_mul_f32 v125, s83, v121
    v_mfma_f32_16x16x32_bf16 v[104:107], v[64:67], a[240:243], 0
    ds_read_b128 v[44:47], v119 offset:21504
    s_waitcnt lgkmcnt(6)
    v_fma_f32 v56, v56, s82, v125
    v_fma_f32 v57, v57, s82, v125
    v_fma_f32 v58, v58, s82, v125
    v_mfma_f32_16x16x32_bf16 v[104:107], v[68:71], a[244:247], v[104:107]
    ds_read_b128 v[48:51], v119 offset:22528
    s_waitcnt lgkmcnt(5)
    v_fma_f32 v59, v59, s82, v125
    v_fma_f32 v60, v60, s82, v125
    v_fma_f32 v61, v61, s82, v125
    v_mfma_f32_16x16x32_bf16 v[104:107], v[72:75], a[248:251], v[104:107]
    ds_read_b128 v[52:55], v119 offset:23552
    s_waitcnt lgkmcnt(4)
    v_fma_f32 v62, v62, s82, v125
    v_fma_f32 v63, v63, s82, v125
    v_exp_f32 v56, v56
    v_mfma_f32_16x16x32_bf16 v[104:107], v[76:79], a[252:255], v[104:107]
    ds_read_b128 v[32:35], v119 offset:24576
    v_exp_f32 v57, v57
    v_exp_f32 v58, v58
    v_exp_f32 v59, v59
    v_smfmac_f32_16x16x64_bf16 v[80:83], v[12:15], a[224:231], v120
    ds_read_b128 v[36:39], v119 offset:25600
    v_exp_f32 v60, v60
    v_exp_f32 v61, v61
    v_smfmac_f32_16x16x64_bf16 v[84:87], v[12:15], a[232:239], v120
    s_waitcnt lgkmcnt(4)
    v_exp_f32 v62, v62
    v_exp_f32 v63, v63
    v_cvt_pk_bf16_f32 v56, v56, v57
    v_smfmac_f32_16x16x64_bf16 v[80:83], v[16:19], v[40:47], v120
    v_cvt_pk_bf16_f32 v57, v58, v59
    v_cvt_pk_bf16_f32 v58, v60, v61
    v_cvt_pk_bf16_f32 v59, v62, v63
    s_nop 1
    v_mfma_f32_16x16x32_bf16 v[60:63], v[108:111], v[56:59], 0
    ds_read_b128 v[40:43], v119 offset:26624
    v_max3_f32 v122, v104, v105, v121
    v_mov_b32 v123, v122
    v_mfma_f32_16x16x32_bf16 v[96:99], v[88:91], v[56:59], 0
    ds_read_b128 v[44:47], v119 offset:27648
    s_add_u32 s68, s5, 1
    v_permlane32_swap_b32 v122, v123
    v_max_f32 v122, v122, v123
    v_mfma_f32_16x16x32_bf16 v[100:103], v[92:95], v[56:59], 0
    s_mul_i32 s68, s68, 0x01010101
    s_waitcnt lgkmcnt(4)
    v_mov_b32 v123, v122
    v_smfmac_f32_16x16x64_bf16 v[84:87], v[16:19], v[48:55], v120
    s_nop 0
    v_permlane16_swap_b32 v122, v123
    v_max_f32 v122, v122, v123
    v_smfmac_f32_16x16x64_bf16 v[80:83], v[20:23], v[128:135], v120
    ds_read_b128 v[48:51], v119 offset:28672
    v_mul_f32 v127, s83, v122
    v_fma_f32 v124, v121, s82, v127
    v_smfmac_f32_16x16x64_bf16 v[84:87], v[20:23], v[136:143], v120
    ds_read_b128 v[52:55], v119 offset:29696
    s_waitcnt lgkmcnt(4)
    v_fma_f32 v104, v104, s82, v127
    v_fma_f32 v105, v105, s82, v127
    v_smfmac_f32_16x16x64_bf16 v[80:83], v[24:27], v[32:39], v120
    s_waitcnt lgkmcnt(2)
    v_exp_f32 v124, v124
    v_exp_f32 v104, v104
    v_smfmac_f32_16x16x64_bf16 v[84:87], v[24:27], v[40:47], v120
    ds_read_b128 v[32:35], v119 offset:30720
    v_exp_f32 v105, v105
    v_add_f32 v122, v124, v124
    v_smfmac_f32_16x16x64_bf16 v[80:83], v[28:31], v[144:151], v120
    ds_read_b128 v[36:39], v119 offset:31744
    v_cvt_pk_bf16_f32 v104, v104, v104
    v_cvt_pk_bf16_f32 v105, v105, v105
    v_mul_f32 v60, v60, v122
    v_smfmac_f32_16x16x64_bf16 v[84:87], v[28:31], v[152:159], v120
    ds_read_b128 v[40:43], v119 offset:32768
    v_mul_f32 v96, v96, v124
    v_mul_f32 v97, v97, v124
    v_mul_f32 v98, v98, v124
    v_mul_f32 v99, v99, v124
    v_mfma_f32_16x16x16_bf16 v[60:63], v[108:109], v[104:105], v[60:63]
    ds_read_b128 v[44:47], v119 offset:33792
    v_mul_f32 v100, v100, v124
    v_mul_f32 v101, v101, v124
    v_mul_f32 v102, v102, v124
    v_mul_f32 v103, v103, v124
    v_cvt_pk_bf16_f32 v80, v80, v81
    v_cvt_pk_bf16_f32 v81, v82, v83
    v_cvt_pk_bf16_f32 v82, v84, v85
    v_cvt_pk_bf16_f32 v83, v86, v87
    v_mfma_f32_16x16x16_bf16 v[96:99], v[80:81], v[104:105], v[96:99]
    s_nop 0
    v_mfma_f32_16x16x16_bf16 v[100:103], v[82:83], v[104:105], v[100:103]
    v_rcp_f32 v125, v60
    v_mov_b64 v[0:1], 0
    v_mov_b64 v[2:3], 0
    v_mov_b64 v[4:5], 0
    v_mov_b64 v[6:7], 0
    v_mov_b64 v[8:9], 0
    v_mul_f32 v96, v96, v125
    v_mul_f32 v97, v97, v125
    v_mul_f32 v98, v98, v125
    v_mul_f32 v99, v99, v125
    v_cvt_pk_bf16_f32 v96, v96, v97
    v_cvt_pk_bf16_f32 v97, v98, v99
    v_mul_f32 v100, v100, v125
    v_mul_f32 v101, v101, v125
    v_mul_f32 v102, v102, v125
    v_mul_f32 v103, v103, v125
    v_cvt_pk_bf16_f32 v98, v100, v101
    v_cvt_pk_bf16_f32 v99, v102, v103
    ds_write2_b64 v115, v[96:97], v[98:99] offset0:0 offset1:32
    buffer_load_dwordx4 v[88:91], v112, s[52:55], s7 offen sc1
    buffer_load_dwordx4 v[92:95], v112, s[52:55], s7 offen offset:1024 sc1
    s_mov_b32 m0, s81
    v_mov_b32 v121, s68
    v_mov_b32 v104, 0xff81ff81
    v_mov_b32 v105, 0xff81ff81
    v_mov_b32 v106, 0xff81ff81
    v_mov_b32 v107, 0xff81ff81
    v_mov_b64 v[10:11], 0
    v_mov_b64 v[12:13], 0
    v_mov_b64 v[14:15], 0
    v_mov_b64 v[16:17], 0
    v_mov_b64 v[18:19], 0
    v_mov_b64 v[20:21], 0
    v_mov_b64 v[22:23], 0
    v_mov_b64 v[24:25], 0
    v_mov_b64 v[26:27], 0
    v_mov_b64 v[28:29], 0
    v_mov_b64 v[30:31], 0
    s_waitcnt lgkmcnt(0)
    s_barrier
    ds_read_b128 v[80:83], v112 offset:0
    ds_read_b128 v[84:87], v112 offset:1024
    buffer_load_dwordx4 v112, s[52:55], s8 offen offset:0 sc1 lds
    buffer_load_dwordx4 v112, s[52:55], s8 offen offset:1024 sc1 lds
    buffer_store_dwordx4 v[104:107], v112, s[52:55], s69 offen offset:1024 sc1
    s_waitcnt lgkmcnt(1)
    v_smfmac_f32_16x16x64_bf16 v[0:3], v[80:83], v[48:55], v120
    ds_read_b128 v[48:51], v119 offset:34816
    s_waitcnt lgkmcnt(1)
    v_smfmac_f32_16x16x64_bf16 v[0:3], v[84:87], v[160:167], v120
    ds_read_b128 v[52:55], v119 offset:35840
    v_smfmac_f32_16x16x64_bf16 v[4:7], v[80:83], v[32:39], v120
    v_smfmac_f32_16x16x64_bf16 v[4:7], v[84:87], v[168:175], v120
    v_smfmac_f32_16x16x64_bf16 v[8:11], v[80:83], v[40:47], v120
    s_nop 3
    v_add_f32 v0, v0, v1
    v_smfmac_f32_16x16x64_bf16 v[8:11], v[84:87], v[176:183], v120
    s_waitcnt lgkmcnt(0)
    v_add_f32 v2, v2, v3
    v_cvt_pk_bf16_f32 v96, v0, v2
    v_smfmac_f32_16x16x64_bf16 v[12:15], v[80:83], v[48:55], v120
    v_add_f32 v4, v4, v5
    v_smfmac_f32_16x16x64_bf16 v[12:15], v[84:87], v[184:191], v120
    v_add_f32 v6, v6, v7
    v_cvt_pk_bf16_f32 v97, v4, v6
    v_smfmac_f32_16x16x64_bf16 v[16:19], v[80:83], v[192:199], v120
    s_mov_b64 exec, s[74:75]
    buffer_store_dword v121, v112, s[52:55], s70 offen sc1
    s_mov_b64 exec, -1
    v_add_f32 v8, v8, v9
    v_smfmac_f32_16x16x64_bf16 v[16:19], v[84:87], v[224:231], v120
    v_add_f32 v10, v10, v11
    v_cvt_pk_bf16_f32 v98, v8, v10
    v_smfmac_f32_16x16x64_bf16 v[20:23], v[80:83], v[200:207], v120
    v_add_f32 v12, v12, v13
    v_smfmac_f32_16x16x64_bf16 v[20:23], v[84:87], v[232:239], v120
    v_add_f32 v14, v14, v15
    v_cvt_pk_bf16_f32 v99, v12, v14
    v_smfmac_f32_16x16x64_bf16 v[24:27], v[80:83], v[208:215], v120
    buffer_store_dwordx4 v[96:99], v117, s[52:55], s10 offen sc1
    v_add_f32 v16, v16, v17
    v_smfmac_f32_16x16x64_bf16 v[24:27], v[84:87], v[240:247], v120
    v_add_f32 v18, v18, v19
    v_cvt_pk_bf16_f32 v100, v16, v18
    v_smfmac_f32_16x16x64_bf16 v[28:31], v[80:83], v[216:223], v120
    v_add_f32 v20, v20, v21
    v_smfmac_f32_16x16x64_bf16 v[28:31], v[84:87], v[248:255], v120
    v_add_f32 v22, v22, v23
    v_cvt_pk_bf16_f32 v101, v20, v22
    s_nop 0
    v_add_f32 v24, v24, v25
    v_add_f32 v26, v26, v27
    v_cvt_pk_bf16_f32 v102, v24, v26
    s_nop 1
    v_add_f32 v28, v28, v29
    v_add_f32 v30, v30, v31
    v_cvt_pk_bf16_f32 v103, v28, v30
    buffer_store_dwordx4 v[100:103], v117, s[52:55], s15 offen sc1
    s_barrier
    s_cmp_lg_u32 s4, 0
    s_cbranch_scc1 R_nored_45
    s_add_u32 s9, s88, s89
    v_mov_b32 v76, 0
R_hl_51:
    buffer_load_dword v76, v116, s[52:55], s72 offen sc1
    s_waitcnt vmcnt(8)
    v_cmp_ne_u32 vcc, v76, v121
    s_nop 0
    s_cbranch_vccz R_hok_52
    v_cmp_ne_u32 vcc, v76, v121
    s_nop 0
    s_cbranch_vccz R_hok_52
    buffer_load_dword v76, v116, s[52:55], s72 offen sc1
    s_waitcnt vmcnt(8)
    v_cmp_ne_u32 vcc, v76, v121
    s_nop 0
    s_cbranch_vccz R_hok_52
    v_cmp_ne_u32 vcc, v76, v121
    s_nop 0
    s_cbranch_vccz R_hok_52
    buffer_load_dword v76, v116, s[52:55], s72 offen sc1
    s_waitcnt vmcnt(8)
    v_cmp_ne_u32 vcc, v76, v121
    s_nop 0
    s_cbranch_vccz R_hok_52
    v_cmp_ne_u32 vcc, v76, v121
    s_nop 0
    s_cbranch_vccz R_hok_52
    buffer_load_dword v76, v116, s[52:55], s72 offen sc1
    s_waitcnt vmcnt(8)
    v_cmp_ne_u32 vcc, v76, v121
    s_nop 0
    s_cbranch_vccz R_hok_52
    v_cmp_ne_u32 vcc, v76, v121
    s_nop 0
    s_cbranch_vccz R_hok_52
    s_add_u32 s79, s79, 1
    s_cmp_gt_u32 s79, 2097152
    s_cbranch_scc1 mega_kernel_exit
    s_branch R_hl_51
R_hok_52:
R_poll1_48:
    buffer_load_dwordx4 v[0:3], v112, s[52:55], s11 offen offset:0 sc1
    buffer_load_dwordx4 v[4:7], v112, s[52:55], s11 offen offset:1024 sc1
    buffer_load_dwordx4 v[8:11], v112, s[52:55], s11 offen offset:2048 sc1
    buffer_load_dwordx4 v[12:15], v112, s[52:55], s11 offen offset:3072 sc1
    buffer_load_dwordx4 v[16:19], v112, s[52:55], s12 offen offset:0 sc1
    buffer_load_dwordx4 v[20:23], v112, s[52:55], s12 offen offset:1024 sc1
    buffer_load_dwordx4 v[24:27], v112, s[52:55], s12 offen offset:2048 sc1
    buffer_load_dwordx4 v[28:31], v112, s[52:55], s12 offen offset:3072 sc1
    s_add_u32 s79, s79, 1
    s_cmp_gt_u32 s79, 2097152
    s_cbranch_scc1 mega_kernel_exit
    v_bfe_u32 v122, v112, 4, 2
    v_bfe_u32 v123, v112, 6, 2
    v_mov_b32 v104, 0x3f80
    v_mov_b32 v105, 0x3f800000
    v_cmp_gt_u32 vcc, 3, v122
    s_nop 1
    v_cndmask_b32 v106, v105, v104, vcc
    v_cndmask_b32 v122, 0, v122, vcc
    v_or_b32 v122, 12, v122
    v_mul_u32_u24 v127, 0x1111, v122
    v_cmp_eq_u32 vcc, 0, v123
    s_nop 1
    v_cndmask_b32 v104, 0, v106, vcc
    v_cmp_eq_u32 vcc, 1, v123
    s_nop 1
    v_cndmask_b32 v105, 0, v106, vcc
    v_mov_b32 v106, v104
    v_mov_b32 v107, v105
    v_mov_b64 v[72:73], 0
    v_mov_b64 v[74:75], 0
    v_mov_b32 v126, v126
    v_mov_b32 v126, v126
    v_mov_b32 v126, v126
    v_mov_b32 v126, v126
    v_mov_b32 v126, v126
    v_mov_b32 v126, v126
    v_mov_b32 v126, v126
    v_mov_b32 v126, v126
    v_mov_b32 v126, v126
    v_mov_b32 v126, v126
    v_mov_b32 v126, v126
    v_mov_b32 v126, v126
    s_mov_b64 exec, s[74:75]
    buffer_store_dword v121, v112, s[52:55], s71 offen sc1
    s_mov_b64 exec, -1
    v_mov_b32 v122, 0xff81ff81
    v_mov_b32 v123, 0xff81ff81
    s_waitcnt vmcnt(7)
    v_smfmac_f32_16x16x64_bf16 v[72:75], v[104:107], v[0:7], v127
    s_waitcnt vmcnt(5)
    v_smfmac_f32_16x16x64_bf16 v[72:75], v[104:107], v[8:15], v127
    s_waitcnt vmcnt(3)
    v_smfmac_f32_16x16x64_bf16 v[72:75], v[104:107], v[16:23], v127
    s_waitcnt vmcnt(1)
    v_smfmac_f32_16x16x64_bf16 v[72:75], v[104:107], v[24:31], v127
    v_mov_b32 v126, v126
    v_mov_b32 v126, v126
    v_mov_b32 v126, v126
    v_mov_b32 v126, v126
    v_mov_b32 v126, v126
    v_mov_b32 v126, v126
    v_mov_b32 v126, v126
    s_nop 0
    v_cmp_u_f32 vcc, v72, v73
    v_cmp_u_f32 s[14:15], v74, v75
    v_cvt_pk_bf16_f32 v124, v72, v74
    v_cvt_pk_bf16_f32 v125, v73, v75
    s_or_b64 vcc, vcc, s[14:15]
    s_cbranch_vccz R_ok1_49
    s_add_u32 s93, s93, 1
    s_and_b32 s14, s93, 3
    s_cbranch_scc1 R_poll1_48
    v_cmp_eq_u32 vcc, v122, v0
    v_cmp_eq_u32 s[14:15], v122, v1
    s_nop 0
    s_or_b64 vcc, vcc, s[14:15]
    v_cmp_eq_u32 s[14:15], v122, v2
    s_nop 0
    s_or_b64 vcc, vcc, s[14:15]
    v_cmp_eq_u32 s[14:15], v122, v3
    s_nop 0
    s_or_b64 vcc, vcc, s[14:15]
    v_cmp_eq_u32 s[14:15], v122, v4
    s_nop 0
    s_or_b64 vcc, vcc, s[14:15]
    v_cmp_eq_u32 s[14:15], v122, v5
    s_nop 0
    s_or_b64 vcc, vcc, s[14:15]
    v_cmp_eq_u32 s[14:15], v122, v6
    s_nop 0
    s_or_b64 vcc, vcc, s[14:15]
    v_cmp_eq_u32 s[14:15], v122, v7
    s_nop 0
    s_or_b64 vcc, vcc, s[14:15]
    v_cmp_eq_u32 s[14:15], v122, v8
    s_nop 0
    s_or_b64 vcc, vcc, s[14:15]
    v_cmp_eq_u32 s[14:15], v122, v9
    s_nop 0
    s_or_b64 vcc, vcc, s[14:15]
    v_cmp_eq_u32 s[14:15], v122, v10
    s_nop 0
    s_or_b64 vcc, vcc, s[14:15]
    v_cmp_eq_u32 s[14:15], v122, v11
    s_nop 0
    s_or_b64 vcc, vcc, s[14:15]
    v_cmp_eq_u32 s[14:15], v122, v12
    s_nop 0
    s_or_b64 vcc, vcc, s[14:15]
    v_cmp_eq_u32 s[14:15], v122, v13
    s_nop 0
    s_or_b64 vcc, vcc, s[14:15]
    v_cmp_eq_u32 s[14:15], v122, v14
    s_nop 0
    s_or_b64 vcc, vcc, s[14:15]
    v_cmp_eq_u32 s[14:15], v122, v15
    s_nop 0
    s_or_b64 vcc, vcc, s[14:15]
    v_cmp_eq_u32 s[14:15], v122, v16
    s_nop 0
    s_or_b64 vcc, vcc, s[14:15]
    v_cmp_eq_u32 s[14:15], v122, v17
    s_nop 0
    s_or_b64 vcc, vcc, s[14:15]
    v_cmp_eq_u32 s[14:15], v122, v18
    s_nop 0
    s_or_b64 vcc, vcc, s[14:15]
    v_cmp_eq_u32 s[14:15], v122, v19
    s_nop 0
    s_or_b64 vcc, vcc, s[14:15]
    v_cmp_eq_u32 s[14:15], v122, v20
    s_nop 0
    s_or_b64 vcc, vcc, s[14:15]
    v_cmp_eq_u32 s[14:15], v122, v21
    s_nop 0
    s_or_b64 vcc, vcc, s[14:15]
    v_cmp_eq_u32 s[14:15], v122, v22
    s_nop 0
    s_or_b64 vcc, vcc, s[14:15]
    v_cmp_eq_u32 s[14:15], v122, v23
    s_nop 0
    s_or_b64 vcc, vcc, s[14:15]
    v_cmp_eq_u32 s[14:15], v122, v24
    s_nop 0
    s_or_b64 vcc, vcc, s[14:15]
    v_cmp_eq_u32 s[14:15], v122, v25
    s_nop 0
    s_or_b64 vcc, vcc, s[14:15]
    v_cmp_eq_u32 s[14:15], v122, v26
    s_nop 0
    s_or_b64 vcc, vcc, s[14:15]
    v_cmp_eq_u32 s[14:15], v122, v27
    s_nop 0
    s_or_b64 vcc, vcc, s[14:15]
    v_cmp_eq_u32 s[14:15], v122, v28
    s_nop 0
    s_or_b64 vcc, vcc, s[14:15]
    v_cmp_eq_u32 s[14:15], v122, v29
    s_nop 0
    s_or_b64 vcc, vcc, s[14:15]
    v_cmp_eq_u32 s[14:15], v122, v30
    s_nop 0
    s_or_b64 vcc, vcc, s[14:15]
    v_cmp_eq_u32 s[14:15], v122, v31
    s_nop 0
    s_or_b64 vcc, vcc, s[14:15]
    s_cbranch_vccnz R_poll1_48
R_ok1_49:
    buffer_store_dwordx2 v[124:125], v118, s[52:55], s9 offen sc1
    s_add_u32 s9, s13, s89
    buffer_store_dwordx2 v[122:123], v118, s[52:55], s9 offen sc1
    ds_read_b128 v[32:35], v119 offset:0
    ds_read_b128 v[36:39], v119 offset:1024
    ds_read_b128 v[40:43], v119 offset:2048
    ds_read_b128 v[44:47], v119 offset:3072
    ds_read_b128 v[48:51], v119 offset:4096
    ds_read_b128 v[52:55], v119 offset:5120
    v_mov_b64 v[56:57], 0
    v_mov_b64 v[58:59], 0
    v_mov_b64 v[60:61], 0
    v_mov_b64 v[62:63], 0
    v_mov_b64 v[64:65], 0
    v_mov_b64 v[66:67], 0
    v_mov_b64 v[68:69], 0
    v_mov_b64 v[70:71], 0
    v_mov_b32 v80, 0xff81ff81
    v_mov_b32 v81, 0xff81ff81
    v_mov_b32 v82, 0xff81ff81
    v_mov_b32 v83, 0xff81ff81
    s_branch R_join_46
R_nored_45:
    ds_read_b128 v[32:35], v119 offset:0
    ds_read_b128 v[36:39], v119 offset:1024
    ds_read_b128 v[40:43], v119 offset:2048
    ds_read_b128 v[44:47], v119 offset:3072
    ds_read_b128 v[48:51], v119 offset:4096
    ds_read_b128 v[52:55], v119 offset:5120
    v_mov_b64 v[56:57], 0
    v_mov_b64 v[58:59], 0
    v_mov_b64 v[60:61], 0
    v_mov_b64 v[62:63], 0
    v_mov_b64 v[64:65], 0
    v_mov_b64 v[66:67], 0
    v_mov_b64 v[68:69], 0
    v_mov_b64 v[70:71], 0
    v_mov_b32 v80, 0xff81ff81
    v_mov_b32 v81, 0xff81ff81
    v_mov_b32 v82, 0xff81ff81
    v_mov_b32 v83, 0xff81ff81
    v_lshlrev_b32 v127, 2, v112
    s_cmp_lg_u32 s4, 3
    s_cbranch_scc1 R_join_46
    v_lshlrev_b32 v123, 3, v112
    s_sleep 6
    v_mov_b32 v76, 0
R_hl_53:
    buffer_load_dword v76, v116, s[52:55], s73 offen sc1
    s_waitcnt vmcnt(8)
    v_cmp_ne_u32 vcc, v76, v121
    s_nop 0
    s_cbranch_vccz R_hok_54
    v_cmp_ne_u32 vcc, v76, v121
    s_nop 0
    s_cbranch_vccz R_hok_54
    buffer_load_dword v76, v116, s[52:55], s73 offen sc1
    s_waitcnt vmcnt(8)
    v_cmp_ne_u32 vcc, v76, v121
    s_nop 0
    s_cbranch_vccz R_hok_54
    v_cmp_ne_u32 vcc, v76, v121
    s_nop 0
    s_cbranch_vccz R_hok_54
    buffer_load_dword v76, v116, s[52:55], s73 offen sc1
    s_waitcnt vmcnt(8)
    v_cmp_ne_u32 vcc, v76, v121
    s_nop 0
    s_cbranch_vccz R_hok_54
    v_cmp_ne_u32 vcc, v76, v121
    s_nop 0
    s_cbranch_vccz R_hok_54
    buffer_load_dword v76, v116, s[52:55], s73 offen sc1
    s_waitcnt vmcnt(8)
    v_cmp_ne_u32 vcc, v76, v121
    s_nop 0
    s_cbranch_vccz R_hok_54
    v_cmp_ne_u32 vcc, v76, v121
    s_nop 0
    s_cbranch_vccz R_hok_54
    s_add_u32 s79, s79, 1
    s_cmp_gt_u32 s79, 2097152
    s_cbranch_scc1 mega_kernel_exit
    s_branch R_hl_53
R_hok_54:
    s_add_u32 s9, s88, 229376
    s_mov_b32 m0, 0
    s_add_u32 s14, s9, 4096
    buffer_load_dwordx4 v112, s[52:55], s9 offen offset:0 sc1 lds
    buffer_load_dwordx4 v112, s[52:55], s9 offen offset:1024 sc1 lds
    buffer_load_dwordx4 v112, s[52:55], s9 offen offset:2048 sc1 lds
    buffer_load_dwordx4 v112, s[52:55], s9 offen offset:3072 sc1 lds
    s_movk_i32 m0, 4096
    s_nop 0
    buffer_load_dwordx4 v112, s[52:55], s14 offen offset:0 sc1 lds
    buffer_load_dwordx4 v112, s[52:55], s14 offen offset:1024 sc1 lds
    buffer_load_dwordx4 v112, s[52:55], s14 offen offset:2048 sc1 lds
    buffer_load_dwordx4 v112, s[52:55], s14 offen offset:3072 sc1 lds
R_join_46:
    s_waitcnt vmcnt(0) lgkmcnt(0)
R_join0_47:
    s_add_u32 s5, s5, 1
    s_cmp_lg_u32 s5, 63
    s_barrier
    s_cbranch_scc1 R_top_36
    s_branch R_done_14
R_bad_43:
    s_mov_b32 s14, 0xff81
    s_mov_b64 s[12:13], 0
    v_and_b32 v122, 0xffff, v0
    v_lshrrev_b32 v123, 16, v0
    v_cmp_eq_u32 vcc, s14, v122
    s_nop 0
    s_or_b64 s[12:13], s[12:13], vcc
    v_cmp_eq_u32 vcc, s14, v123
    s_nop 0
    s_or_b64 s[12:13], s[12:13], vcc
    v_and_b32 v122, 0xffff, v1
    v_lshrrev_b32 v123, 16, v1
    v_cmp_eq_u32 vcc, s14, v122
    s_nop 0
    s_or_b64 s[12:13], s[12:13], vcc
    v_cmp_eq_u32 vcc, s14, v123
    s_nop 0
    s_or_b64 s[12:13], s[12:13], vcc
    v_and_b32 v122, 0xffff, v2
    v_lshrrev_b32 v123, 16, v2
    v_cmp_eq_u32 vcc, s14, v122
    s_nop 0
    s_or_b64 s[12:13], s[12:13], vcc
    v_cmp_eq_u32 vcc, s14, v123
    s_nop 0
    s_or_b64 s[12:13], s[12:13], vcc
    v_and_b32 v122, 0xffff, v3
    v_lshrrev_b32 v123, 16, v3
    v_cmp_eq_u32 vcc, s14, v122
    s_nop 0
    s_or_b64 s[12:13], s[12:13], vcc
    v_cmp_eq_u32 vcc, s14, v123
    s_nop 0
    s_or_b64 s[12:13], s[12:13], vcc
    v_and_b32 v122, 0xffff, v4
    v_lshrrev_b32 v123, 16, v4
    v_cmp_eq_u32 vcc, s14, v122
    s_nop 0
    s_or_b64 s[12:13], s[12:13], vcc
    v_cmp_eq_u32 vcc, s14, v123
    s_nop 0
    s_or_b64 s[12:13], s[12:13], vcc
    v_and_b32 v122, 0xffff, v5
    v_lshrrev_b32 v123, 16, v5
    v_cmp_eq_u32 vcc, s14, v122
    s_nop 0
    s_or_b64 s[12:13], s[12:13], vcc
    v_cmp_eq_u32 vcc, s14, v123
    s_nop 0
    s_or_b64 s[12:13], s[12:13], vcc
    v_and_b32 v122, 0xffff, v6
    v_lshrrev_b32 v123, 16, v6
    v_cmp_eq_u32 vcc, s14, v122
    s_nop 0
    s_or_b64 s[12:13], s[12:13], vcc
    v_cmp_eq_u32 vcc, s14, v123
    s_nop 0
    s_or_b64 s[12:13], s[12:13], vcc
    v_and_b32 v122, 0xffff, v7
    v_lshrrev_b32 v123, 16, v7
    v_cmp_eq_u32 vcc, s14, v122
    s_nop 0
    s_or_b64 s[12:13], s[12:13], vcc
    v_cmp_eq_u32 vcc, s14, v123
    s_nop 0
    s_or_b64 s[12:13], s[12:13], vcc
    v_and_b32 v122, 0xffff, v8
    v_lshrrev_b32 v123, 16, v8
    v_cmp_eq_u32 vcc, s14, v122
    s_nop 0
    s_or_b64 s[12:13], s[12:13], vcc
    v_cmp_eq_u32 vcc, s14, v123
    s_nop 0
    s_or_b64 s[12:13], s[12:13], vcc
    v_and_b32 v122, 0xffff, v9
    v_lshrrev_b32 v123, 16, v9
    v_cmp_eq_u32 vcc, s14, v122
    s_nop 0
    s_or_b64 s[12:13], s[12:13], vcc
    v_cmp_eq_u32 vcc, s14, v123
    s_nop 0
    s_or_b64 s[12:13], s[12:13], vcc
    v_and_b32 v122, 0xffff, v10
    v_lshrrev_b32 v123, 16, v10
    v_cmp_eq_u32 vcc, s14, v122
    s_nop 0
    s_or_b64 s[12:13], s[12:13], vcc
    v_cmp_eq_u32 vcc, s14, v123
    s_nop 0
    s_or_b64 s[12:13], s[12:13], vcc
    v_and_b32 v122, 0xffff, v11
    v_lshrrev_b32 v123, 16, v11
    v_cmp_eq_u32 vcc, s14, v122
    s_nop 0
    s_or_b64 s[12:13], s[12:13], vcc
    v_cmp_eq_u32 vcc, s14, v123
    s_nop 0
    s_or_b64 s[12:13], s[12:13], vcc
    v_and_b32 v122, 0xffff, v12
    v_lshrrev_b32 v123, 16, v12
    v_cmp_eq_u32 vcc, s14, v122
    s_nop 0
    s_or_b64 s[12:13], s[12:13], vcc
    v_cmp_eq_u32 vcc, s14, v123
    s_nop 0
    s_or_b64 s[12:13], s[12:13], vcc
    v_and_b32 v122, 0xffff, v13
    v_lshrrev_b32 v123, 16, v13
    v_cmp_eq_u32 vcc, s14, v122
    s_nop 0
    s_or_b64 s[12:13], s[12:13], vcc
    v_cmp_eq_u32 vcc, s14, v123
    s_nop 0
    s_or_b64 s[12:13], s[12:13], vcc
    v_and_b32 v122, 0xffff, v14
    v_lshrrev_b32 v123, 16, v14
    v_cmp_eq_u32 vcc, s14, v122
    s_nop 0
    s_or_b64 s[12:13], s[12:13], vcc
    v_cmp_eq_u32 vcc, s14, v123
    s_nop 0
    s_or_b64 s[12:13], s[12:13], vcc
    v_and_b32 v122, 0xffff, v15
    v_lshrrev_b32 v123, 16, v15
    v_cmp_eq_u32 vcc, s14, v122
    s_nop 0
    s_or_b64 s[12:13], s[12:13], vcc
    v_cmp_eq_u32 vcc, s14, v123
    s_nop 0
    s_or_b64 s[12:13], s[12:13], vcc
    v_and_b32 v122, 0xffff, v16
    v_lshrrev_b32 v123, 16, v16
    v_cmp_eq_u32 vcc, s14, v122
    s_nop 0
    s_or_b64 s[12:13], s[12:13], vcc
    v_cmp_eq_u32 vcc, s14, v123
    s_nop 0
    s_or_b64 s[12:13], s[12:13], vcc
    v_and_b32 v122, 0xffff, v17
    v_lshrrev_b32 v123, 16, v17
    v_cmp_eq_u32 vcc, s14, v122
    s_nop 0
    s_or_b64 s[12:13], s[12:13], vcc
    v_cmp_eq_u32 vcc, s14, v123
    s_nop 0
    s_or_b64 s[12:13], s[12:13], vcc
    v_and_b32 v122, 0xffff, v18
    v_lshrrev_b32 v123, 16, v18
    v_cmp_eq_u32 vcc, s14, v122
    s_nop 0
    s_or_b64 s[12:13], s[12:13], vcc
    v_cmp_eq_u32 vcc, s14, v123
    s_nop 0
    s_or_b64 s[12:13], s[12:13], vcc
    v_and_b32 v122, 0xffff, v19
    v_lshrrev_b32 v123, 16, v19
    v_cmp_eq_u32 vcc, s14, v122
    s_nop 0
    s_or_b64 s[12:13], s[12:13], vcc
    v_cmp_eq_u32 vcc, s14, v123
    s_nop 0
    s_or_b64 s[12:13], s[12:13], vcc
    v_and_b32 v122, 0xffff, v20
    v_lshrrev_b32 v123, 16, v20
    v_cmp_eq_u32 vcc, s14, v122
    s_nop 0
    s_or_b64 s[12:13], s[12:13], vcc
    v_cmp_eq_u32 vcc, s14, v123
    s_nop 0
    s_or_b64 s[12:13], s[12:13], vcc
    v_and_b32 v122, 0xffff, v21
    v_lshrrev_b32 v123, 16, v21
    v_cmp_eq_u32 vcc, s14, v122
    s_nop 0
    s_or_b64 s[12:13], s[12:13], vcc
    v_cmp_eq_u32 vcc, s14, v123
    s_nop 0
    s_or_b64 s[12:13], s[12:13], vcc
    v_and_b32 v122, 0xffff, v22
    v_lshrrev_b32 v123, 16, v22
    v_cmp_eq_u32 vcc, s14, v122
    s_nop 0
    s_or_b64 s[12:13], s[12:13], vcc
    v_cmp_eq_u32 vcc, s14, v123
    s_nop 0
    s_or_b64 s[12:13], s[12:13], vcc
    v_and_b32 v122, 0xffff, v23
    v_lshrrev_b32 v123, 16, v23
    v_cmp_eq_u32 vcc, s14, v122
    s_nop 0
    s_or_b64 s[12:13], s[12:13], vcc
    v_cmp_eq_u32 vcc, s14, v123
    s_nop 0
    s_or_b64 s[12:13], s[12:13], vcc
    v_and_b32 v122, 0xffff, v24
    v_lshrrev_b32 v123, 16, v24
    v_cmp_eq_u32 vcc, s14, v122
    s_nop 0
    s_or_b64 s[12:13], s[12:13], vcc
    v_cmp_eq_u32 vcc, s14, v123
    s_nop 0
    s_or_b64 s[12:13], s[12:13], vcc
    v_and_b32 v122, 0xffff, v25
    v_lshrrev_b32 v123, 16, v25
    v_cmp_eq_u32 vcc, s14, v122
    s_nop 0
    s_or_b64 s[12:13], s[12:13], vcc
    v_cmp_eq_u32 vcc, s14, v123
    s_nop 0
    s_or_b64 s[12:13], s[12:13], vcc
    v_and_b32 v122, 0xffff, v26
    v_lshrrev_b32 v123, 16, v26
    v_cmp_eq_u32 vcc, s14, v122
    s_nop 0
    s_or_b64 s[12:13], s[12:13], vcc
    v_cmp_eq_u32 vcc, s14, v123
    s_nop 0
    s_or_b64 s[12:13], s[12:13], vcc
    v_and_b32 v122, 0xffff, v27
    v_lshrrev_b32 v123, 16, v27
    v_cmp_eq_u32 vcc, s14, v122
    s_nop 0
    s_or_b64 s[12:13], s[12:13], vcc
    v_cmp_eq_u32 vcc, s14, v123
    s_nop 0
    s_or_b64 s[12:13], s[12:13], vcc
    v_and_b32 v122, 0xffff, v28
    v_lshrrev_b32 v123, 16, v28
    v_cmp_eq_u32 vcc, s14, v122
    s_nop 0
    s_or_b64 s[12:13], s[12:13], vcc
    v_cmp_eq_u32 vcc, s14, v123
    s_nop 0
    s_or_b64 s[12:13], s[12:13], vcc
    v_and_b32 v122, 0xffff, v29
    v_lshrrev_b32 v123, 16, v29
    v_cmp_eq_u32 vcc, s14, v122
    s_nop 0
    s_or_b64 s[12:13], s[12:13], vcc
    v_cmp_eq_u32 vcc, s14, v123
    s_nop 0
    s_or_b64 s[12:13], s[12:13], vcc
    v_and_b32 v122, 0xffff, v30
    v_lshrrev_b32 v123, 16, v30
    v_cmp_eq_u32 vcc, s14, v122
    s_nop 0
    s_or_b64 s[12:13], s[12:13], vcc
    v_cmp_eq_u32 vcc, s14, v123
    s_nop 0
    s_or_b64 s[12:13], s[12:13], vcc
    v_and_b32 v122, 0xffff, v31
    v_lshrrev_b32 v123, 16, v31
    v_cmp_eq_u32 vcc, s14, v122
    s_nop 0
    s_or_b64 s[12:13], s[12:13], vcc
    v_cmp_eq_u32 vcc, s14, v123
    s_nop 0
    s_or_b64 s[12:13], s[12:13], vcc
    s_cmp_eq_u64 s[12:13], 0
    s_cbranch_scc1 R_good_44
    s_add_u32 s79, s79, 1
    s_cmp_gt_u32 s79, 2097152
    s_cbranch_scc1 mega_kernel_exit
    s_waitcnt lgkmcnt(0)
    s_barrier
    s_cmp_lg_u32 s4, 1
    s_cbranch_scc1 R_nd_55
    s_add_u32 s9, s88, 229376
    s_mov_b32 m0, 0
    s_add_u32 s14, s9, 4096
    buffer_load_dwordx4 v112, s[52:55], s9 offen offset:0 sc1 lds
    buffer_load_dwordx4 v112, s[52:55], s9 offen offset:1024 sc1 lds
    buffer_load_dwordx4 v112, s[52:55], s9 offen offset:2048 sc1 lds
    buffer_load_dwordx4 v112, s[52:55], s9 offen offset:3072 sc1 lds
    s_movk_i32 m0, 4096
    s_nop 0
    buffer_load_dwordx4 v112, s[52:55], s14 offen offset:0 sc1 lds
    buffer_load_dwordx4 v112, s[52:55], s14 offen offset:1024 sc1 lds
    buffer_load_dwordx4 v112, s[52:55], s14 offen offset:2048 sc1 lds
    buffer_load_dwordx4 v112, s[52:55], s14 offen offset:3072 sc1 lds
    s_waitcnt vmcnt(0)
R_nd_55:
    ds_read_b128 v[32:35], v119 offset:0
    ds_read_b128 v[36:39], v119 offset:1024
    ds_read_b128 v[40:43], v119 offset:2048
    ds_read_b128 v[44:47], v119 offset:3072
    ds_read_b128 v[48:51], v119 offset:4096
    ds_read_b128 v[52:55], v119 offset:5120
    v_mov_b64 v[56:57], 0
    v_mov_b64 v[58:59], 0
    v_mov_b64 v[60:61], 0
    v_mov_b64 v[62:63], 0
    v_mov_b64 v[64:65], 0
    v_mov_b64 v[66:67], 0
    v_mov_b64 v[68:69], 0
    v_mov_b64 v[70:71], 0
    v_mov_b32 v80, 0xff81ff81
    v_mov_b32 v81, 0xff81ff81
    v_mov_b32 v82, 0xff81ff81
    v_mov_b32 v83, 0xff81ff81
    s_waitcnt lgkmcnt(0)
    s_barrier
    s_branch R_top_36
R_done_14:
    s_waitcnt vmcnt(0)
    s_barrier
RF_top_56:
    ds_read_b64_tr_b16 v[0:1], v113 offset:0
    ds_read_b64_tr_b16 v[2:3], v113 offset:256
    ds_read_b64_tr_b16 v[4:5], v113 offset:1024
    ds_read_b64_tr_b16 v[6:7], v113 offset:1280
    ds_read_b64_tr_b16 v[8:9], v113 offset:2048
    ds_read_b64_tr_b16 v[10:11], v113 offset:2304
    ds_read_b64_tr_b16 v[12:13], v113 offset:3072
    ds_read_b64_tr_b16 v[14:15], v113 offset:3328
    ds_read_b64_tr_b16 v[16:17], v113 offset:4096
    ds_read_b64_tr_b16 v[18:19], v113 offset:4352
    ds_read_b64_tr_b16 v[20:21], v113 offset:5120
    ds_read_b64_tr_b16 v[22:23], v113 offset:5376
    ds_read_b64_tr_b16 v[24:25], v113 offset:6144
    ds_read_b64_tr_b16 v[26:27], v113 offset:6400
    ds_read_b64_tr_b16 v[28:29], v113 offset:7168
    ds_read_b64_tr_b16 v[30:31], v113 offset:7424
    ds_read_b128 v[32:35], v119 offset:8192
    ds_read_b128 v[36:39], v119 offset:9216
    ds_read_b128 v[40:43], v119 offset:10240
    ds_read_b128 v[44:47], v119 offset:11264
    ds_read_b128 v[48:51], v119 offset:12288
    ds_read_b128 v[52:55], v119 offset:13312
    ds_read_b128 v[56:59], v119 offset:14336
    ds_read_b128 v[60:63], v119 offset:15360
    ds_read_b128 v[72:75], v119 offset:16384
    ds_read_b128 v[76:79], v119 offset:17408
    ds_read_b128 v[88:91], v119 offset:18432
    ds_read_b128 v[92:95], v119 offset:19456
    ds_read_b128 v[96:99], v119 offset:20480
    ds_read_b128 v[100:103], v119 offset:21504
    v_mov_b64 v[64:65], 0
    v_mov_b64 v[80:81], 0
    v_mov_b64 v[66:67], 0
    v_mov_b64 v[82:83], 0
    v_mov_b64 v[68:69], 0
    v_mov_b64 v[84:85], 0
    v_mov_b64 v[70:71], 0
    v_mov_b64 v[86:87], 0
    s_waitcnt lgkmcnt(0)
    v_smfmac_f32_16x16x64_bf16 v[64:67], v[12:15], v[32:39], v120
    ds_read_b128 v[32:35], v119 offset:22528
    ds_read_b128 v[36:39], v119 offset:23552
    v_smfmac_f32_16x16x64_bf16 v[68:71], v[12:15], v[40:47], v120
    ds_read_b128 v[40:43], v119 offset:24576
    ds_read_b128 v[44:47], v119 offset:25600
    v_smfmac_f32_16x16x64_bf16 v[80:83], v[0:3], v[48:55], v120
    ds_read_b128 v[48:51], v119 offset:26624
    ds_read_b128 v[52:55], v119 offset:27648
    v_smfmac_f32_16x16x64_bf16 v[84:87], v[0:3], v[56:63], v120
    v_smfmac_f32_16x16x64_bf16 v[80:83], v[8:11], v[72:79], v120
    v_smfmac_f32_16x16x64_bf16 v[84:87], v[8:11], v[88:95], v120
    v_smfmac_f32_16x16x64_bf16 v[80:83], v[16:19], v[96:103], v120
    v_smfmac_f32_16x16x64_bf16 v[64:67], v[0:3], a[96:103], v120
    v_smfmac_f32_16x16x64_bf16 v[68:71], v[0:3], a[104:111], v120
    v_smfmac_f32_16x16x64_bf16 v[64:67], v[4:7], a[112:119], v120
    v_smfmac_f32_16x16x64_bf16 v[68:71], v[4:7], a[120:127], v120
    v_smfmac_f32_16x16x64_bf16 v[64:67], v[8:11], a[128:135], v120
    v_smfmac_f32_16x16x64_bf16 v[68:71], v[8:11], a[136:143], v120
    v_smfmac_f32_16x16x64_bf16 v[64:67], v[16:19], a[144:151], v120
    v_smfmac_f32_16x16x64_bf16 v[68:71], v[16:19], a[152:159], v120
    v_smfmac_f32_16x16x64_bf16 v[64:67], v[20:23], a[160:167], v120
    v_smfmac_f32_16x16x64_bf16 v[68:71], v[20:23], a[168:175], v120
    v_smfmac_f32_16x16x64_bf16 v[64:67], v[24:27], a[176:183], v120
    v_smfmac_f32_16x16x64_bf16 v[68:71], v[24:27], a[184:191], v120
    v_smfmac_f32_16x16x64_bf16 v[64:67], v[28:31], a[192:199], v120
    v_smfmac_f32_16x16x64_bf16 v[68:71], v[28:31], a[200:207], v120
    v_smfmac_f32_16x16x64_bf16 v[80:83], v[4:7], a[208:215], v120
    v_smfmac_f32_16x16x64_bf16 v[84:87], v[4:7], a[216:223], v120
    v_smfmac_f32_16x16x64_bf16 v[80:83], v[12:15], a[224:231], v120
    v_smfmac_f32_16x16x64_bf16 v[84:87], v[12:15], a[232:239], v120
    v_smfmac_f32_16x16x64_bf16 v[80:83], v[20:23], v[128:135], v120
    v_smfmac_f32_16x16x64_bf16 v[84:87], v[20:23], v[136:143], v120
    v_smfmac_f32_16x16x64_bf16 v[80:83], v[28:31], v[144:151], v120
    v_smfmac_f32_16x16x64_bf16 v[84:87], v[28:31], v[152:159], v120
    s_waitcnt lgkmcnt(0)
    v_smfmac_f32_16x16x64_bf16 v[84:87], v[16:19], v[32:39], v120
    v_smfmac_f32_16x16x64_bf16 v[80:83], v[24:27], v[40:47], v120
    v_smfmac_f32_16x16x64_bf16 v[84:87], v[24:27], v[48:55], v120
    v_bfe_u32 v122, v112, 4, 4
    v_bfe_u32 v123, v112, 8, 2
    v_bfe_u32 v121, v122, 2, 1
    v_lshlrev_b32 v121, 8, v121
    v_lshl_add_u32 v121, v123, 5, v121
    v_lshrrev_b32 v127, 3, v122
    v_lshl_add_u32 v121, v127, 3, v121
    v_and_b32 v127, 3, v122
    v_lshl_add_u32 v121, v127, 1, v121
    v_lshrrev_b32 v127, 1, v123
    v_lshl_add_u32 v127, v127, 4, v122
    v_lshlrev_b32 v127, 4, v127
    v_and_b32 v123, 1, v123
    v_lshl_add_u32 v127, v123, 2, v127
    s_lshl_b32 s6, s3, 13
    s_lshl_b32 s7, s4, 10
    s_add_u32 s8, s6, s7
    s_add_u32 s8, s8, 71307392
    s_lshl_b32 s7, s4, 11
    s_add_u32 s9, s6, s7
    s_add_u32 s9, s9, 88080392
    v_add_f32 v64, v64, v65
    v_add_f32 v66, v66, v67
    v_add_f32 v68, v68, v69
    v_add_f32 v70, v70, v71
    v_add_f32 v80, v80, v81
    v_add_f32 v82, v82, v83
    v_add_f32 v84, v84, v85
    v_add_f32 v86, v86, v87
    v_cmp_u_f32 vcc, v64, v66
    s_nop 0
    s_cbranch_vccz RF_good_57
    s_mov_b32 s14, 0xff81
    s_mov_b64 s[12:13], 0
    v_and_b32 v122, 0xffff, v0
    v_lshrrev_b32 v123, 16, v0
    v_cmp_eq_u32 vcc, s14, v122
    s_nop 0
    s_or_b64 s[12:13], s[12:13], vcc
    v_cmp_eq_u32 vcc, s14, v123
    s_nop 0
    s_or_b64 s[12:13], s[12:13], vcc
    v_and_b32 v122, 0xffff, v1
    v_lshrrev_b32 v123, 16, v1
    v_cmp_eq_u32 vcc, s14, v122
    s_nop 0
    s_or_b64 s[12:13], s[12:13], vcc
    v_cmp_eq_u32 vcc, s14, v123
    s_nop 0
    s_or_b64 s[12:13], s[12:13], vcc
    v_and_b32 v122, 0xffff, v2
    v_lshrrev_b32 v123, 16, v2
    v_cmp_eq_u32 vcc, s14, v122
    s_nop 0
    s_or_b64 s[12:13], s[12:13], vcc
    v_cmp_eq_u32 vcc, s14, v123
    s_nop 0
    s_or_b64 s[12:13], s[12:13], vcc
    v_and_b32 v122, 0xffff, v3
    v_lshrrev_b32 v123, 16, v3
    v_cmp_eq_u32 vcc, s14, v122
    s_nop 0
    s_or_b64 s[12:13], s[12:13], vcc
    v_cmp_eq_u32 vcc, s14, v123
    s_nop 0
    s_or_b64 s[12:13], s[12:13], vcc
    v_and_b32 v122, 0xffff, v4
    v_lshrrev_b32 v123, 16, v4
    v_cmp_eq_u32 vcc, s14, v122
    s_nop 0
    s_or_b64 s[12:13], s[12:13], vcc
    v_cmp_eq_u32 vcc, s14, v123
    s_nop 0
    s_or_b64 s[12:13], s[12:13], vcc
    v_and_b32 v122, 0xffff, v5
    v_lshrrev_b32 v123, 16, v5
    v_cmp_eq_u32 vcc, s14, v122
    s_nop 0
    s_or_b64 s[12:13], s[12:13], vcc
    v_cmp_eq_u32 vcc, s14, v123
    s_nop 0
    s_or_b64 s[12:13], s[12:13], vcc
    v_and_b32 v122, 0xffff, v6
    v_lshrrev_b32 v123, 16, v6
    v_cmp_eq_u32 vcc, s14, v122
    s_nop 0
    s_or_b64 s[12:13], s[12:13], vcc
    v_cmp_eq_u32 vcc, s14, v123
    s_nop 0
    s_or_b64 s[12:13], s[12:13], vcc
    v_and_b32 v122, 0xffff, v7
    v_lshrrev_b32 v123, 16, v7
    v_cmp_eq_u32 vcc, s14, v122
    s_nop 0
    s_or_b64 s[12:13], s[12:13], vcc
    v_cmp_eq_u32 vcc, s14, v123
    s_nop 0
    s_or_b64 s[12:13], s[12:13], vcc
    v_and_b32 v122, 0xffff, v8
    v_lshrrev_b32 v123, 16, v8
    v_cmp_eq_u32 vcc, s14, v122
    s_nop 0
    s_or_b64 s[12:13], s[12:13], vcc
    v_cmp_eq_u32 vcc, s14, v123
    s_nop 0
    s_or_b64 s[12:13], s[12:13], vcc
    v_and_b32 v122, 0xffff, v9
    v_lshrrev_b32 v123, 16, v9
    v_cmp_eq_u32 vcc, s14, v122
    s_nop 0
    s_or_b64 s[12:13], s[12:13], vcc
    v_cmp_eq_u32 vcc, s14, v123
    s_nop 0
    s_or_b64 s[12:13], s[12:13], vcc
    v_and_b32 v122, 0xffff, v10
    v_lshrrev_b32 v123, 16, v10
    v_cmp_eq_u32 vcc, s14, v122
    s_nop 0
    s_or_b64 s[12:13], s[12:13], vcc
    v_cmp_eq_u32 vcc, s14, v123
    s_nop 0
    s_or_b64 s[12:13], s[12:13], vcc
    v_and_b32 v122, 0xffff, v11
    v_lshrrev_b32 v123, 16, v11
    v_cmp_eq_u32 vcc, s14, v122
    s_nop 0
    s_or_b64 s[12:13], s[12:13], vcc
    v_cmp_eq_u32 vcc, s14, v123
    s_nop 0
    s_or_b64 s[12:13], s[12:13], vcc
    v_and_b32 v122, 0xffff, v12
    v_lshrrev_b32 v123, 16, v12
    v_cmp_eq_u32 vcc, s14, v122
    s_nop 0
    s_or_b64 s[12:13], s[12:13], vcc
    v_cmp_eq_u32 vcc, s14, v123
    s_nop 0
    s_or_b64 s[12:13], s[12:13], vcc
    v_and_b32 v122, 0xffff, v13
    v_lshrrev_b32 v123, 16, v13
    v_cmp_eq_u32 vcc, s14, v122
    s_nop 0
    s_or_b64 s[12:13], s[12:13], vcc
    v_cmp_eq_u32 vcc, s14, v123
    s_nop 0
    s_or_b64 s[12:13], s[12:13], vcc
    v_and_b32 v122, 0xffff, v14
    v_lshrrev_b32 v123, 16, v14
    v_cmp_eq_u32 vcc, s14, v122
    s_nop 0
    s_or_b64 s[12:13], s[12:13], vcc
    v_cmp_eq_u32 vcc, s14, v123
    s_nop 0
    s_or_b64 s[12:13], s[12:13], vcc
    v_and_b32 v122, 0xffff, v15
    v_lshrrev_b32 v123, 16, v15
    v_cmp_eq_u32 vcc, s14, v122
    s_nop 0
    s_or_b64 s[12:13], s[12:13], vcc
    v_cmp_eq_u32 vcc, s14, v123
    s_nop 0
    s_or_b64 s[12:13], s[12:13], vcc
    v_and_b32 v122, 0xffff, v16
    v_lshrrev_b32 v123, 16, v16
    v_cmp_eq_u32 vcc, s14, v122
    s_nop 0
    s_or_b64 s[12:13], s[12:13], vcc
    v_cmp_eq_u32 vcc, s14, v123
    s_nop 0
    s_or_b64 s[12:13], s[12:13], vcc
    v_and_b32 v122, 0xffff, v17
    v_lshrrev_b32 v123, 16, v17
    v_cmp_eq_u32 vcc, s14, v122
    s_nop 0
    s_or_b64 s[12:13], s[12:13], vcc
    v_cmp_eq_u32 vcc, s14, v123
    s_nop 0
    s_or_b64 s[12:13], s[12:13], vcc
    v_and_b32 v122, 0xffff, v18
    v_lshrrev_b32 v123, 16, v18
    v_cmp_eq_u32 vcc, s14, v122
    s_nop 0
    s_or_b64 s[12:13], s[12:13], vcc
    v_cmp_eq_u32 vcc, s14, v123
    s_nop 0
    s_or_b64 s[12:13], s[12:13], vcc
    v_and_b32 v122, 0xffff, v19
    v_lshrrev_b32 v123, 16, v19
    v_cmp_eq_u32 vcc, s14, v122
    s_nop 0
    s_or_b64 s[12:13], s[12:13], vcc
    v_cmp_eq_u32 vcc, s14, v123
    s_nop 0
    s_or_b64 s[12:13], s[12:13], vcc
    v_and_b32 v122, 0xffff, v20
    v_lshrrev_b32 v123, 16, v20
    v_cmp_eq_u32 vcc, s14, v122
    s_nop 0
    s_or_b64 s[12:13], s[12:13], vcc
    v_cmp_eq_u32 vcc, s14, v123
    s_nop 0
    s_or_b64 s[12:13], s[12:13], vcc
    v_and_b32 v122, 0xffff, v21
    v_lshrrev_b32 v123, 16, v21
    v_cmp_eq_u32 vcc, s14, v122
    s_nop 0
    s_or_b64 s[12:13], s[12:13], vcc
    v_cmp_eq_u32 vcc, s14, v123
    s_nop 0
    s_or_b64 s[12:13], s[12:13], vcc
    v_and_b32 v122, 0xffff, v22
    v_lshrrev_b32 v123, 16, v22
    v_cmp_eq_u32 vcc, s14, v122
    s_nop 0
    s_or_b64 s[12:13], s[12:13], vcc
    v_cmp_eq_u32 vcc, s14, v123
    s_nop 0
    s_or_b64 s[12:13], s[12:13], vcc
    v_and_b32 v122, 0xffff, v23
    v_lshrrev_b32 v123, 16, v23
    v_cmp_eq_u32 vcc, s14, v122
    s_nop 0
    s_or_b64 s[12:13], s[12:13], vcc
    v_cmp_eq_u32 vcc, s14, v123
    s_nop 0
    s_or_b64 s[12:13], s[12:13], vcc
    v_and_b32 v122, 0xffff, v24
    v_lshrrev_b32 v123, 16, v24
    v_cmp_eq_u32 vcc, s14, v122
    s_nop 0
    s_or_b64 s[12:13], s[12:13], vcc
    v_cmp_eq_u32 vcc, s14, v123
    s_nop 0
    s_or_b64 s[12:13], s[12:13], vcc
    v_and_b32 v122, 0xffff, v25
    v_lshrrev_b32 v123, 16, v25
    v_cmp_eq_u32 vcc, s14, v122
    s_nop 0
    s_or_b64 s[12:13], s[12:13], vcc
    v_cmp_eq_u32 vcc, s14, v123
    s_nop 0
    s_or_b64 s[12:13], s[12:13], vcc
    v_and_b32 v122, 0xffff, v26
    v_lshrrev_b32 v123, 16, v26
    v_cmp_eq_u32 vcc, s14, v122
    s_nop 0
    s_or_b64 s[12:13], s[12:13], vcc
    v_cmp_eq_u32 vcc, s14, v123
    s_nop 0
    s_or_b64 s[12:13], s[12:13], vcc
    v_and_b32 v122, 0xffff, v27
    v_lshrrev_b32 v123, 16, v27
    v_cmp_eq_u32 vcc, s14, v122
    s_nop 0
    s_or_b64 s[12:13], s[12:13], vcc
    v_cmp_eq_u32 vcc, s14, v123
    s_nop 0
    s_or_b64 s[12:13], s[12:13], vcc
    v_and_b32 v122, 0xffff, v28
    v_lshrrev_b32 v123, 16, v28
    v_cmp_eq_u32 vcc, s14, v122
    s_nop 0
    s_or_b64 s[12:13], s[12:13], vcc
    v_cmp_eq_u32 vcc, s14, v123
    s_nop 0
    s_or_b64 s[12:13], s[12:13], vcc
    v_and_b32 v122, 0xffff, v29
    v_lshrrev_b32 v123, 16, v29
    v_cmp_eq_u32 vcc, s14, v122
    s_nop 0
    s_or_b64 s[12:13], s[12:13], vcc
    v_cmp_eq_u32 vcc, s14, v123
    s_nop 0
    s_or_b64 s[12:13], s[12:13], vcc
    v_and_b32 v122, 0xffff, v30
    v_lshrrev_b32 v123, 16, v30
    v_cmp_eq_u32 vcc, s14, v122
    s_nop 0
    s_or_b64 s[12:13], s[12:13], vcc
    v_cmp_eq_u32 vcc, s14, v123
    s_nop 0
    s_or_b64 s[12:13], s[12:13], vcc
    v_and_b32 v122, 0xffff, v31
    v_lshrrev_b32 v123, 16, v31
    v_cmp_eq_u32 vcc, s14, v122
    s_nop 0
    s_or_b64 s[12:13], s[12:13], vcc
    v_cmp_eq_u32 vcc, s14, v123
    s_nop 0
    s_or_b64 s[12:13], s[12:13], vcc
    s_cmp_eq_u64 s[12:13], 0
    s_cbranch_scc1 RF_good_57
    s_add_u32 s79, s79, 1
    s_cmp_gt_u32 s79, 2097152
    s_cbranch_scc1 mega_kernel_exit
    s_barrier
    s_cmp_lg_u32 s4, 1
    s_cbranch_scc1 RF_nd_58
    s_add_u32 s9, s88, 229376
    s_mov_b32 m0, 0
    s_add_u32 s14, s9, 4096
    buffer_load_dwordx4 v112, s[52:55], s9 offen offset:0 sc1 lds
    buffer_load_dwordx4 v112, s[52:55], s9 offen offset:1024 sc1 lds
    buffer_load_dwordx4 v112, s[52:55], s9 offen offset:2048 sc1 lds
    buffer_load_dwordx4 v112, s[52:55], s9 offen offset:3072 sc1 lds
    s_movk_i32 m0, 4096
    s_nop 0
    buffer_load_dwordx4 v112, s[52:55], s14 offen offset:0 sc1 lds
    buffer_load_dwordx4 v112, s[52:55], s14 offen offset:1024 sc1 lds
    buffer_load_dwordx4 v112, s[52:55], s14 offen offset:2048 sc1 lds
    buffer_load_dwordx4 v112, s[52:55], s14 offen offset:3072 sc1 lds
    s_waitcnt vmcnt(0)
RF_nd_58:
    s_barrier
    s_branch RF_top_56
RF_good_57:
    v_cvt_pk_bf16_f32 v64, v64, v66
    v_cvt_pk_bf16_f32 v68, v68, v70
    v_cvt_pk_bf16_f32 v80, v80, v82
    v_cvt_pk_bf16_f32 v84, v84, v86
    buffer_store_short v64, v121, s[52:55], s8 offen offset:0 sc1
    buffer_store_short_d16_hi v64, v121, s[52:55], s8 offen offset:16 sc1
    buffer_store_dword v80, v127, s[52:55], s9 offen offset:512 sc1
    buffer_store_dword v80, v127, s[52:55], s9 offen offset:0 sc1
    buffer_store_short v68, v121, s[52:55], s8 offen offset:512 sc1
    buffer_store_short_d16_hi v68, v121, s[52:55], s8 offen offset:528 sc1
    buffer_store_dword v84, v127, s[52:55], s9 offen offset:1536 sc1
    buffer_store_dword v84, v127, s[52:55], s9 offen offset:1024 sc1
    s_waitcnt vmcnt(0)
    s_barrier
    s_lshl_b32 s6, s3, 7
    s_add_u32 s6, s6, 64
    s_mov_b32 s7, 64
    s_cmp_lg_u32 s4, 0
    s_cbranch_scc1 FS_59
    s_mov_b64 exec, 1
    v_mov_b32 v122, s7
    buffer_store_dword v122, off, s[52:55], s6 sc1
    s_mov_b64 exec, -1
FS_59:
    s_waitcnt vmcnt(0)
    s_branch mega_kernel_exit
WORKER_4:
    s_sub_u32 s100, s3, 0x1000
    s_mov_b32 s5, 1
    s_cmp_lt_u32 s100, 32
    s_cbranch_scc1 W_nomod_60
    s_cmp_lg_u32 s100, 223
    s_cbranch_scc1 W_noz_61
    v_mov_b32 v4, 0
    v_mov_b32 v5, 0
    v_mov_b32 v6, 0
    v_mov_b32 v7, 0
    v_lshlrev_b32 v1, 4, v0
    s_mov_b32 s6, 0
    buffer_store_dwordx4 v[4:7], v1, s[52:55], s6 offen sc1
    s_mov_b32 s6, 4096
    buffer_store_dwordx4 v[4:7], v1, s[52:55], s6 offen sc1
    s_mov_b32 s6, 8192
    buffer_store_dwordx4 v[4:7], v1, s[52:55], s6 offen sc1
    s_mov_b32 s6, 12288
    buffer_store_dwordx4 v[4:7], v1, s[52:55], s6 offen sc1
    s_mov_b32 s6, 16384
    buffer_store_dwordx4 v[4:7], v1, s[52:55], s6 offen sc1
    s_mov_b32 s6, 20480
    buffer_store_dwordx4 v[4:7], v1, s[52:55], s6 offen sc1
    s_mov_b32 s6, 24576
    buffer_store_dwordx4 v[4:7], v1, s[52:55], s6 offen sc1
    s_mov_b32 s6, 28672
    buffer_store_dwordx4 v[4:7], v1, s[52:55], s6 offen sc1
    s_mov_b32 s6, 32768
    buffer_store_dwordx4 v[4:7], v1, s[52:55], s6 offen sc1
    s_mov_b32 s6, 36864
    buffer_store_dwordx4 v[4:7], v1, s[52:55], s6 offen sc1
    s_mov_b32 s6, 40960
    buffer_store_dwordx4 v[4:7], v1, s[52:55], s6 offen sc1
    s_mov_b32 s6, 45056
    buffer_store_dwordx4 v[4:7], v1, s[52:55], s6 offen sc1
    s_mov_b32 s6, 49152
    buffer_store_dwordx4 v[4:7], v1, s[52:55], s6 offen sc1
    s_mov_b32 s6, 53248
    buffer_store_dwordx4 v[4:7], v1, s[52:55], s6 offen sc1
W_noz_61:
    s_sub_u32 s3, s100, 32
    s_mov_b32 s56, s42
    s_and_b32 s57, s43, 0xffff
    s_mov_b32 s58, 0x300000
    s_mov_b32 s59, 0x00020000
    s_mov_b32 s64, s40
    s_and_b32 s65, s41, 0xffff
    s_mov_b32 s66, 0x400
    s_mov_b32 s67, 0x00020000
    s_mul_i32 s4, s3, 2731
    s_lshr_b32 s4, s4, 16
    s_mul_i32 s5, s4, 24
    s_sub_u32 s5, s3, s5
    v_lshrrev_b32 v1, 4, v0
    v_and_b32 v2, 15, v0
    s_lshl_b32 s6, s4, 6
    v_add_u32 v3, s6, v1
    s_movk_i32 s7, 6144
    v_mul_lo_u32 v4, v3, s7
    s_lshl_b32 s8, s5, 8
    v_lshl_add_u32 v4, v2, 4, v4
    v_add_u32 v4, s8, v4
    v_lshlrev_b32 v5, 1, v3
    s_mov_b32 s9, 0
    buffer_load_dwordx4 v[8:11], v4, s[56:59], s9 offen
    buffer_load_ushort v24, v5, s[64:67], 0 offen offset:0
    s_mov_b32 s9, 98304
    buffer_load_dwordx4 v[12:15], v4, s[56:59], s9 offen
    buffer_load_ushort v25, v5, s[64:67], 0 offen offset:32
    s_mov_b32 s9, 196608
    buffer_load_dwordx4 v[16:19], v4, s[56:59], s9 offen
    buffer_load_ushort v26, v5, s[64:67], 0 offen offset:64
    s_mov_b32 s9, 294912
    buffer_load_dwordx4 v[20:23], v4, s[56:59], s9 offen
    buffer_load_ushort v27, v5, s[64:67], 0 offen offset:96
    s_waitcnt vmcnt(0)
    s_mov_b32 s9, 0xbfb8aa3b
    v_lshlrev_b32 v24, 16, v24
    v_mul_f32 v28, s9, v24
    v_exp_f32 v28, v28
    s_nop 0
    v_add_f32 v28, 1.0, v28
    v_rcp_f32 v28, v28
    s_nop 0
    v_mul_f32 v24, v24, v28
    v_cvt_pk_bf16_f32 v24, v24, v24
    v_lshlrev_b32 v24, 16, v24
    v_lshlrev_b32 v25, 16, v25
    v_mul_f32 v28, s9, v25
    v_exp_f32 v28, v28
    s_nop 0
    v_add_f32 v28, 1.0, v28
    v_rcp_f32 v28, v28
    s_nop 0
    v_mul_f32 v25, v25, v28
    v_cvt_pk_bf16_f32 v25, v25, v25
    v_lshlrev_b32 v25, 16, v25
    v_lshlrev_b32 v26, 16, v26
    v_mul_f32 v28, s9, v26
    v_exp_f32 v28, v28
    s_nop 0
    v_add_f32 v28, 1.0, v28
    v_rcp_f32 v28, v28
    s_nop 0
    v_mul_f32 v26, v26, v28
    v_cvt_pk_bf16_f32 v26, v26, v26
    v_lshlrev_b32 v26, 16, v26
    v_lshlrev_b32 v27, 16, v27
    v_mul_f32 v28, s9, v27
    v_exp_f32 v28, v28
    s_nop 0
    v_add_f32 v28, 1.0, v28
    v_rcp_f32 v28, v28
    s_nop 0
    v_mul_f32 v27, v27, v28
    v_cvt_pk_bf16_f32 v27, v27, v27
    v_lshlrev_b32 v27, 16, v27
    v_lshlrev_b32 v28, 16, v8
    v_and_b32 v29, 0xffff0000, v8
    v_mul_f32 v32, v28, v24
    v_mul_f32 v33, v29, v24
    v_lshlrev_b32 v28, 16, v9
    v_and_b32 v29, 0xffff0000, v9
    v_mul_f32 v34, v28, v24
    v_mul_f32 v35, v29, v24
    v_lshlrev_b32 v28, 16, v10
    v_and_b32 v29, 0xffff0000, v10
    v_mul_f32 v36, v28, v24
    v_mul_f32 v37, v29, v24
    v_lshlrev_b32 v28, 16, v11
    v_and_b32 v29, 0xffff0000, v11
    v_mul_f32 v38, v28, v24
    v_mul_f32 v39, v29, v24
    v_lshlrev_b32 v28, 16, v12
    v_and_b32 v29, 0xffff0000, v12
    v_fmac_f32 v32, v28, v25
    v_fmac_f32 v33, v29, v25
    v_lshlrev_b32 v28, 16, v13
    v_and_b32 v29, 0xffff0000, v13
    v_fmac_f32 v34, v28, v25
    v_fmac_f32 v35, v29, v25
    v_lshlrev_b32 v28, 16, v14
    v_and_b32 v29, 0xffff0000, v14
    v_fmac_f32 v36, v28, v25
    v_fmac_f32 v37, v29, v25
    v_lshlrev_b32 v28, 16, v15
    v_and_b32 v29, 0xffff0000, v15
    v_fmac_f32 v38, v28, v25
    v_fmac_f32 v39, v29, v25
    v_lshlrev_b32 v28, 16, v16
    v_and_b32 v29, 0xffff0000, v16
    v_fmac_f32 v32, v28, v26
    v_fmac_f32 v33, v29, v26
    v_lshlrev_b32 v28, 16, v17
    v_and_b32 v29, 0xffff0000, v17
    v_fmac_f32 v34, v28, v26
    v_fmac_f32 v35, v29, v26
    v_lshlrev_b32 v28, 16, v18
    v_and_b32 v29, 0xffff0000, v18
    v_fmac_f32 v36, v28, v26
    v_fmac_f32 v37, v29, v26
    v_lshlrev_b32 v28, 16, v19
    v_and_b32 v29, 0xffff0000, v19
    v_fmac_f32 v38, v28, v26
    v_fmac_f32 v39, v29, v26
    v_lshlrev_b32 v28, 16, v20
    v_and_b32 v29, 0xffff0000, v20
    v_fmac_f32 v32, v28, v27
    v_fmac_f32 v33, v29, v27
    v_lshlrev_b32 v28, 16, v21
    v_and_b32 v29, 0xffff0000, v21
    v_fmac_f32 v34, v28, v27
    v_fmac_f32 v35, v29, v27
    v_lshlrev_b32 v28, 16, v22
    v_and_b32 v29, 0xffff0000, v22
    v_fmac_f32 v36, v28, v27
    v_fmac_f32 v37, v29, v27
    v_lshlrev_b32 v28, 16, v23
    v_and_b32 v29, 0xffff0000, v23
    v_fmac_f32 v38, v28, v27
    v_fmac_f32 v39, v29, v27
    v_lshlrev_b32 v6, 9, v1
    v_lshl_add_u32 v6, v2, 5, v6
    ds_write_b128 v6, v[32:35]
    ds_write_b128 v6, v[36:39] offset:16
    s_waitcnt lgkmcnt(0)
    s_barrier
    v_and_b32 v7, 127, v0
    v_lshlrev_b32 v7, 2, v7
    ds_read_b32 v8, v7 offset:0
    ds_read_b32 v9, v7 offset:512
    ds_read_b32 v10, v7 offset:1024
    ds_read_b32 v11, v7 offset:1536
    ds_read_b32 v12, v7 offset:2048
    ds_read_b32 v13, v7 offset:2560
    ds_read_b32 v14, v7 offset:3072
    ds_read_b32 v15, v7 offset:3584
    ds_read_b32 v16, v7 offset:4096
    ds_read_b32 v17, v7 offset:4608
    ds_read_b32 v18, v7 offset:5120
    ds_read_b32 v19, v7 offset:5632
    ds_read_b32 v20, v7 offset:6144
    ds_read_b32 v21, v7 offset:6656
    ds_read_b32 v22, v7 offset:7168
    ds_read_b32 v23, v7 offset:7680
    s_waitcnt lgkmcnt(0)
    v_add_f32 v8, v8, v9
    v_add_f32 v8, v8, v10
    v_add_f32 v8, v8, v11
    v_add_f32 v8, v8, v12
    v_add_f32 v8, v8, v13
    v_add_f32 v8, v8, v14
    v_add_f32 v8, v8, v15
    v_add_f32 v8, v8, v16
    v_add_f32 v8, v8, v17
    v_add_f32 v8, v8, v18
    v_add_f32 v8, v8, v19
    v_add_f32 v8, v8, v20
    v_add_f32 v8, v8, v21
    v_add_f32 v8, v8, v22
    v_add_f32 v8, v8, v23
    s_mul_i32 s9, s4, 12288
    s_lshl_b32 s10, s5, 9
    s_add_u32 s9, s9, s10
    s_add_u32 s9, s9, 65536
    buffer_store_dword v8, v7, s[52:55], s9 offen sc1
    s_waitcnt vmcnt(0)
    s_barrier
    v_lshrrev_b32 v1, 6, v0
    s_nop 0
    v_readfirstlane_b32 s4, v1
    s_nop 3
    s_cmp_lg_u32 s4, 0
    s_cbranch_scc1 DA_62
    s_mov_b64 exec, 1
    v_mov_b32 v1, 1
    buffer_atomic_add v1, off, s[60:63], 0 offset:128
    s_mov_b64 exec, -1
DA_62:
    s_mov_b32 s5, 3
W_nomod_60:
    s_cmp_ge_u32 s100, 144
    s_cbranch_scc1 W_g1_66
    s_cmp_ge_u32 s100, 80
    s_cbranch_scc1 W_a_65
    s_cmp_ge_u32 s100, 32
    s_cselect_b32 s101, 1, 0
    s_cmp_ge_u32 s100, 48
    s_cselect_b32 s101, 2, s101
    s_cmp_eq_u32 s101, 1
    s_cbranch_scc1 W_q_63
    s_cmp_eq_u32 s101, 2
    s_cselect_b32 s6, 48, 0
    s_sub_u32 s3, s100, s6
    s_mov_b32 s56, s22
    s_and_b32 s57, s23, 0xffff
    s_mov_b32 s58, 0x400000
    s_mov_b32 s59, 0x00020000
    s_mov_b32 s64, s24
    s_and_b32 s65, s25, 0xffff
    s_mov_b32 s66, 0x400000
    s_mov_b32 s67, 0x00020000
    v_and_b32 v1, 63, v0
    v_lshrrev_b32 v2, 4, v1
    v_and_b32 v3, 15, v1
    v_lshlrev_b32 v4, 13, v2
    v_lshl_add_u32 v4, v3, 4, v4
    v_lshrrev_b32 v5, 1, v2
    v_lshlrev_b32 v5, 3, v5
    v_lshrrev_b32 v6, 2, v3
    v_add_u32 v5, v5, v6
    v_lshlrev_b32 v5, 8, v5
    v_and_b32 v6, 1, v2
    v_lshl_add_u32 v5, v6, 5, v5
    v_and_b32 v6, 3, v3
    v_lshl_add_u32 v5, v6, 3, v5
    s_lshl_b32 s8, s4, 6
    v_add_u32 v5, s8, v5
    v_add_u32 v6, 0x10000, v5
    v_lshlrev_b32 v7, 4, v1
    s_lshl_b32 s7, s3, 8
    s_lshl_b32 s8, s4, 20
    s_add_u32 s7, s7, s8
    s_lshl_b32 s8, s4, 15
    s_mov_b32 m0, s8
    s_add_u32 s8, s8, 1024
    buffer_load_dwordx4 v4, s[56:59], s7 offen lds
    s_add_u32 s7, s7, 32768
    s_mov_b32 m0, s8
    s_add_u32 s8, s8, 1024
    buffer_load_dwordx4 v4, s[56:59], s7 offen lds
    s_add_u32 s7, s7, 32768
    s_mov_b32 m0, s8
    s_add_u32 s8, s8, 1024
    buffer_load_dwordx4 v4, s[56:59], s7 offen lds
    s_add_u32 s7, s7, 32768
    s_mov_b32 m0, s8
    s_add_u32 s8, s8, 1024
    buffer_load_dwordx4 v4, s[56:59], s7 offen lds
    s_add_u32 s7, s7, 32768
    s_mov_b32 m0, s8
    s_add_u32 s8, s8, 1024
    buffer_load_dwordx4 v4, s[56:59], s7 offen lds
    s_add_u32 s7, s7, 32768
    s_mov_b32 m0, s8
    s_add_u32 s8, s8, 1024
    buffer_load_dwordx4 v4, s[56:59], s7 offen lds
    s_add_u32 s7, s7, 32768
    s_mov_b32 m0, s8
    s_add_u32 s8, s8, 1024
    buffer_load_dwordx4 v4, s[56:59], s7 offen lds
    s_add_u32 s7, s7, 32768
    s_mov_b32 m0, s8
    s_add_u32 s8, s8, 1024
    buffer_load_dwordx4 v4, s[56:59], s7 offen lds
    s_add_u32 s7, s7, 32768
    s_mov_b32 m0, s8
    s_add_u32 s8, s8, 1024
    buffer_load_dwordx4 v4, s[56:59], s7 offen lds
    s_add_u32 s7, s7, 32768
    s_mov_b32 m0, s8
    s_add_u32 s8, s8, 1024
    buffer_load_dwordx4 v4, s[56:59], s7 offen lds
    s_add_u32 s7, s7, 32768
    s_mov_b32 m0, s8
    s_add_u32 s8, s8, 1024
    buffer_load_dwordx4 v4, s[56:59], s7 offen lds
    s_add_u32 s7, s7, 32768
    s_mov_b32 m0, s8
    s_add_u32 s8, s8, 1024
    buffer_load_dwordx4 v4, s[56:59], s7 offen lds
    s_add_u32 s7, s7, 32768
    s_mov_b32 m0, s8
    s_add_u32 s8, s8, 1024
    buffer_load_dwordx4 v4, s[56:59], s7 offen lds
    s_add_u32 s7, s7, 32768
    s_mov_b32 m0, s8
    s_add_u32 s8, s8, 1024
    buffer_load_dwordx4 v4, s[56:59], s7 offen lds
    s_add_u32 s7, s7, 32768
    s_mov_b32 m0, s8
    s_add_u32 s8, s8, 1024
    buffer_load_dwordx4 v4, s[56:59], s7 offen lds
    s_add_u32 s7, s7, 32768
    s_mov_b32 m0, s8
    s_add_u32 s8, s8, 1024
    buffer_load_dwordx4 v4, s[56:59], s7 offen lds
    s_add_u32 s7, s7, 32768
    s_mov_b32 m0, s8
    s_add_u32 s8, s8, 1024
    buffer_load_dwordx4 v4, s[56:59], s7 offen lds
    s_add_u32 s7, s7, 32768
    s_mov_b32 m0, s8
    s_add_u32 s8, s8, 1024
    buffer_load_dwordx4 v4, s[56:59], s7 offen lds
    s_add_u32 s7, s7, 32768
    s_mov_b32 m0, s8
    s_add_u32 s8, s8, 1024
    buffer_load_dwordx4 v4, s[56:59], s7 offen lds
    s_add_u32 s7, s7, 32768
    s_mov_b32 m0, s8
    s_add_u32 s8, s8, 1024
    buffer_load_dwordx4 v4, s[56:59], s7 offen lds
    s_add_u32 s7, s7, 32768
    s_mov_b32 m0, s8
    s_add_u32 s8, s8, 1024
    buffer_load_dwordx4 v4, s[56:59], s7 offen lds
    s_add_u32 s7, s7, 32768
    s_mov_b32 m0, s8
    s_add_u32 s8, s8, 1024
    buffer_load_dwordx4 v4, s[56:59], s7 offen lds
    s_add_u32 s7, s7, 32768
    s_mov_b32 m0, s8
    s_add_u32 s8, s8, 1024
    buffer_load_dwordx4 v4, s[56:59], s7 offen lds
    s_add_u32 s7, s7, 32768
    s_mov_b32 m0, s8
    s_add_u32 s8, s8, 1024
    buffer_load_dwordx4 v4, s[56:59], s7 offen lds
    s_add_u32 s7, s7, 32768
    s_mov_b32 m0, s8
    s_add_u32 s8, s8, 1024
    buffer_load_dwordx4 v4, s[56:59], s7 offen lds
    s_add_u32 s7, s7, 32768
    s_mov_b32 m0, s8
    s_add_u32 s8, s8, 1024
    buffer_load_dwordx4 v4, s[56:59], s7 offen lds
    s_add_u32 s7, s7, 32768
    s_mov_b32 m0, s8
    s_add_u32 s8, s8, 1024
    buffer_load_dwordx4 v4, s[56:59], s7 offen lds
    s_add_u32 s7, s7, 32768
    s_mov_b32 m0, s8
    s_add_u32 s8, s8, 1024
    buffer_load_dwordx4 v4, s[56:59], s7 offen lds
    s_add_u32 s7, s7, 32768
    s_mov_b32 m0, s8
    s_add_u32 s8, s8, 1024
    buffer_load_dwordx4 v4, s[56:59], s7 offen lds
    s_add_u32 s7, s7, 32768
    s_mov_b32 m0, s8
    s_add_u32 s8, s8, 1024
    buffer_load_dwordx4 v4, s[56:59], s7 offen lds
    s_add_u32 s7, s7, 32768
    s_mov_b32 m0, s8
    s_add_u32 s8, s8, 1024
    buffer_load_dwordx4 v4, s[56:59], s7 offen lds
    s_add_u32 s7, s7, 32768
    s_mov_b32 m0, s8
    s_add_u32 s8, s8, 1024
    buffer_load_dwordx4 v4, s[56:59], s7 offen lds
    s_add_u32 s7, s7, 32768
    s_waitcnt vmcnt(0)
    s_barrier
    ds_read_b64_tr_b16 a[0:1], v5 offset:0
    ds_read_b64_tr_b16 a[2:3], v5 offset:1024
    ds_read_b64_tr_b16 a[4:5], v5 offset:4096
    ds_read_b64_tr_b16 a[6:7], v5 offset:5120
    ds_read_b64_tr_b16 a[8:9], v5 offset:8192
    ds_read_b64_tr_b16 a[10:11], v5 offset:9216
    ds_read_b64_tr_b16 a[12:13], v5 offset:12288
    ds_read_b64_tr_b16 a[14:15], v5 offset:13312
    ds_read_b64_tr_b16 a[16:17], v5 offset:16384
    ds_read_b64_tr_b16 a[18:19], v5 offset:17408
    ds_read_b64_tr_b16 a[20:21], v5 offset:20480
    ds_read_b64_tr_b16 a[22:23], v5 offset:21504
    ds_read_b64_tr_b16 a[24:25], v5 offset:24576
    ds_read_b64_tr_b16 a[26:27], v5 offset:25600
    ds_read_b64_tr_b16 a[28:29], v5 offset:28672
    ds_read_b64_tr_b16 a[30:31], v5 offset:29696
    ds_read_b64_tr_b16 a[32:33], v5 offset:32768
    ds_read_b64_tr_b16 a[34:35], v5 offset:33792
    ds_read_b64_tr_b16 a[36:37], v5 offset:36864
    ds_read_b64_tr_b16 a[38:39], v5 offset:37888
    ds_read_b64_tr_b16 a[40:41], v5 offset:40960
    ds_read_b64_tr_b16 a[42:43], v5 offset:41984
    ds_read_b64_tr_b16 a[44:45], v5 offset:45056
    ds_read_b64_tr_b16 a[46:47], v5 offset:46080
    ds_read_b64_tr_b16 a[48:49], v5 offset:49152
    ds_read_b64_tr_b16 a[50:51], v5 offset:50176
    ds_read_b64_tr_b16 a[52:53], v5 offset:53248
    ds_read_b64_tr_b16 a[54:55], v5 offset:54272
    ds_read_b64_tr_b16 a[56:57], v5 offset:57344
    ds_read_b64_tr_b16 a[58:59], v5 offset:58368
    ds_read_b64_tr_b16 a[60:61], v5 offset:61440
    ds_read_b64_tr_b16 a[62:63], v5 offset:62464
    ds_read_b64_tr_b16 a[64:65], v6 offset:0
    ds_read_b64_tr_b16 a[66:67], v6 offset:1024
    ds_read_b64_tr_b16 a[68:69], v6 offset:4096
    ds_read_b64_tr_b16 a[70:71], v6 offset:5120
    ds_read_b64_tr_b16 a[72:73], v6 offset:8192
    ds_read_b64_tr_b16 a[74:75], v6 offset:9216
    ds_read_b64_tr_b16 a[76:77], v6 offset:12288
    ds_read_b64_tr_b16 a[78:79], v6 offset:13312
    ds_read_b64_tr_b16 a[80:81], v6 offset:16384
    ds_read_b64_tr_b16 a[82:83], v6 offset:17408
    ds_read_b64_tr_b16 a[84:85], v6 offset:20480
    ds_read_b64_tr_b16 a[86:87], v6 offset:21504
    ds_read_b64_tr_b16 a[88:89], v6 offset:24576
    ds_read_b64_tr_b16 a[90:91], v6 offset:25600
    ds_read_b64_tr_b16 a[92:93], v6 offset:28672
    ds_read_b64_tr_b16 a[94:95], v6 offset:29696
    ds_read_b64_tr_b16 a[96:97], v6 offset:32768
    ds_read_b64_tr_b16 a[98:99], v6 offset:33792
    ds_read_b64_tr_b16 a[100:101], v6 offset:36864
    ds_read_b64_tr_b16 a[102:103], v6 offset:37888
    ds_read_b64_tr_b16 a[104:105], v6 offset:40960
    ds_read_b64_tr_b16 a[106:107], v6 offset:41984
    ds_read_b64_tr_b16 a[108:109], v6 offset:45056
    ds_read_b64_tr_b16 a[110:111], v6 offset:46080
    ds_read_b64_tr_b16 a[112:113], v6 offset:49152
    ds_read_b64_tr_b16 a[114:115], v6 offset:50176
    ds_read_b64_tr_b16 a[116:117], v6 offset:53248
    ds_read_b64_tr_b16 a[118:119], v6 offset:54272
    ds_read_b64_tr_b16 a[120:121], v6 offset:57344
    ds_read_b64_tr_b16 a[122:123], v6 offset:58368
    ds_read_b64_tr_b16 a[124:125], v6 offset:61440
    ds_read_b64_tr_b16 a[126:127], v6 offset:62464
    s_waitcnt lgkmcnt(0)
    s_barrier
    s_lshl_b32 s7, s3, 8
    s_lshl_b32 s8, s4, 20
    s_add_u32 s7, s7, s8
    s_lshl_b32 s8, s4, 15
    s_mov_b32 m0, s8
    s_add_u32 s8, s8, 1024
    buffer_load_dwordx4 v4, s[64:67], s7 offen lds
    s_add_u32 s7, s7, 32768
    s_mov_b32 m0, s8
    s_add_u32 s8, s8, 1024
    buffer_load_dwordx4 v4, s[64:67], s7 offen lds
    s_add_u32 s7, s7, 32768
    s_mov_b32 m0, s8
    s_add_u32 s8, s8, 1024
    buffer_load_dwordx4 v4, s[64:67], s7 offen lds
    s_add_u32 s7, s7, 32768
    s_mov_b32 m0, s8
    s_add_u32 s8, s8, 1024
    buffer_load_dwordx4 v4, s[64:67], s7 offen lds
    s_add_u32 s7, s7, 32768
    s_mov_b32 m0, s8
    s_add_u32 s8, s8, 1024
    buffer_load_dwordx4 v4, s[64:67], s7 offen lds
    s_add_u32 s7, s7, 32768
    s_mov_b32 m0, s8
    s_add_u32 s8, s8, 1024
    buffer_load_dwordx4 v4, s[64:67], s7 offen lds
    s_add_u32 s7, s7, 32768
    s_mov_b32 m0, s8
    s_add_u32 s8, s8, 1024
    buffer_load_dwordx4 v4, s[64:67], s7 offen lds
    s_add_u32 s7, s7, 32768
    s_mov_b32 m0, s8
    s_add_u32 s8, s8, 1024
    buffer_load_dwordx4 v4, s[64:67], s7 offen lds
    s_add_u32 s7, s7, 32768
    s_mov_b32 m0, s8
    s_add_u32 s8, s8, 1024
    buffer_load_dwordx4 v4, s[64:67], s7 offen lds
    s_add_u32 s7, s7, 32768
    s_mov_b32 m0, s8
    s_add_u32 s8, s8, 1024
    buffer_load_dwordx4 v4, s[64:67], s7 offen lds
    s_add_u32 s7, s7, 32768
    s_mov_b32 m0, s8
    s_add_u32 s8, s8, 1024
    buffer_load_dwordx4 v4, s[64:67], s7 offen lds
    s_add_u32 s7, s7, 32768
    s_mov_b32 m0, s8
    s_add_u32 s8, s8, 1024
    buffer_load_dwordx4 v4, s[64:67], s7 offen lds
    s_add_u32 s7, s7, 32768
    s_mov_b32 m0, s8
    s_add_u32 s8, s8, 1024
    buffer_load_dwordx4 v4, s[64:67], s7 offen lds
    s_add_u32 s7, s7, 32768
    s_mov_b32 m0, s8
    s_add_u32 s8, s8, 1024
    buffer_load_dwordx4 v4, s[64:67], s7 offen lds
    s_add_u32 s7, s7, 32768
    s_mov_b32 m0, s8
    s_add_u32 s8, s8, 1024
    buffer_load_dwordx4 v4, s[64:67], s7 offen lds
    s_add_u32 s7, s7, 32768
    s_mov_b32 m0, s8
    s_add_u32 s8, s8, 1024
    buffer_load_dwordx4 v4, s[64:67], s7 offen lds
    s_add_u32 s7, s7, 32768
    s_mov_b32 m0, s8
    s_add_u32 s8, s8, 1024
    buffer_load_dwordx4 v4, s[64:67], s7 offen lds
    s_add_u32 s7, s7, 32768
    s_mov_b32 m0, s8
    s_add_u32 s8, s8, 1024
    buffer_load_dwordx4 v4, s[64:67], s7 offen lds
    s_add_u32 s7, s7, 32768
    s_mov_b32 m0, s8
    s_add_u32 s8, s8, 1024
    buffer_load_dwordx4 v4, s[64:67], s7 offen lds
    s_add_u32 s7, s7, 32768
    s_mov_b32 m0, s8
    s_add_u32 s8, s8, 1024
    buffer_load_dwordx4 v4, s[64:67], s7 offen lds
    s_add_u32 s7, s7, 32768
    s_mov_b32 m0, s8
    s_add_u32 s8, s8, 1024
    buffer_load_dwordx4 v4, s[64:67], s7 offen lds
    s_add_u32 s7, s7, 32768
    s_mov_b32 m0, s8
    s_add_u32 s8, s8, 1024
    buffer_load_dwordx4 v4, s[64:67], s7 offen lds
    s_add_u32 s7, s7, 32768
    s_mov_b32 m0, s8
    s_add_u32 s8, s8, 1024
    buffer_load_dwordx4 v4, s[64:67], s7 offen lds
    s_add_u32 s7, s7, 32768
    s_mov_b32 m0, s8
    s_add_u32 s8, s8, 1024
    buffer_load_dwordx4 v4, s[64:67], s7 offen lds
    s_add_u32 s7, s7, 32768
    s_mov_b32 m0, s8
    s_add_u32 s8, s8, 1024
    buffer_load_dwordx4 v4, s[64:67], s7 offen lds
    s_add_u32 s7, s7, 32768
    s_mov_b32 m0, s8
    s_add_u32 s8, s8, 1024
    buffer_load_dwordx4 v4, s[64:67], s7 offen lds
    s_add_u32 s7, s7, 32768
    s_mov_b32 m0, s8
    s_add_u32 s8, s8, 1024
    buffer_load_dwordx4 v4, s[64:67], s7 offen lds
    s_add_u32 s7, s7, 32768
    s_mov_b32 m0, s8
    s_add_u32 s8, s8, 1024
    buffer_load_dwordx4 v4, s[64:67], s7 offen lds
    s_add_u32 s7, s7, 32768
    s_mov_b32 m0, s8
    s_add_u32 s8, s8, 1024
    buffer_load_dwordx4 v4, s[64:67], s7 offen lds
    s_add_u32 s7, s7, 32768
    s_mov_b32 m0, s8
    s_add_u32 s8, s8, 1024
    buffer_load_dwordx4 v4, s[64:67], s7 offen lds
    s_add_u32 s7, s7, 32768
    s_mov_b32 m0, s8
    s_add_u32 s8, s8, 1024
    buffer_load_dwordx4 v4, s[64:67], s7 offen lds
    s_add_u32 s7, s7, 32768
    s_mov_b32 m0, s8
    s_add_u32 s8, s8, 1024
    buffer_load_dwordx4 v4, s[64:67], s7 offen lds
    s_add_u32 s7, s7, 32768
    s_waitcnt vmcnt(0)
    s_barrier
    ds_read_b64_tr_b16 a[128:129], v5 offset:0
    ds_read_b64_tr_b16 a[130:131], v5 offset:1024
    ds_read_b64_tr_b16 a[132:133], v5 offset:4096
    ds_read_b64_tr_b16 a[134:135], v5 offset:5120
    ds_read_b64_tr_b16 a[136:137], v5 offset:8192
    ds_read_b64_tr_b16 a[138:139], v5 offset:9216
    ds_read_b64_tr_b16 a[140:141], v5 offset:12288
    ds_read_b64_tr_b16 a[142:143], v5 offset:13312
    ds_read_b64_tr_b16 a[144:145], v5 offset:16384
    ds_read_b64_tr_b16 a[146:147], v5 offset:17408
    ds_read_b64_tr_b16 a[148:149], v5 offset:20480
    ds_read_b64_tr_b16 a[150:151], v5 offset:21504
    ds_read_b64_tr_b16 a[152:153], v5 offset:24576
    ds_read_b64_tr_b16 a[154:155], v5 offset:25600
    ds_read_b64_tr_b16 a[156:157], v5 offset:28672
    ds_read_b64_tr_b16 a[158:159], v5 offset:29696
    ds_read_b64_tr_b16 a[160:161], v5 offset:32768
    ds_read_b64_tr_b16 a[162:163], v5 offset:33792
    ds_read_b64_tr_b16 a[164:165], v5 offset:36864
    ds_read_b64_tr_b16 a[166:167], v5 offset:37888
    ds_read_b64_tr_b16 a[168:169], v5 offset:40960
    ds_read_b64_tr_b16 a[170:171], v5 offset:41984
    ds_read_b64_tr_b16 a[172:173], v5 offset:45056
    ds_read_b64_tr_b16 a[174:175], v5 offset:46080
    ds_read_b64_tr_b16 a[176:177], v5 offset:49152
    ds_read_b64_tr_b16 a[178:179], v5 offset:50176
    ds_read_b64_tr_b16 a[180:181], v5 offset:53248
    ds_read_b64_tr_b16 a[182:183], v5 offset:54272
    ds_read_b64_tr_b16 a[184:185], v5 offset:57344
    ds_read_b64_tr_b16 a[186:187], v5 offset:58368
    ds_read_b64_tr_b16 a[188:189], v5 offset:61440
    ds_read_b64_tr_b16 a[190:191], v5 offset:62464
    ds_read_b64_tr_b16 a[192:193], v6 offset:0
    ds_read_b64_tr_b16 a[194:195], v6 offset:1024
    ds_read_b64_tr_b16 a[196:197], v6 offset:4096
    ds_read_b64_tr_b16 a[198:199], v6 offset:5120
    ds_read_b64_tr_b16 a[200:201], v6 offset:8192
    ds_read_b64_tr_b16 a[202:203], v6 offset:9216
    ds_read_b64_tr_b16 a[204:205], v6 offset:12288
    ds_read_b64_tr_b16 a[206:207], v6 offset:13312
    ds_read_b64_tr_b16 a[208:209], v6 offset:16384
    ds_read_b64_tr_b16 a[210:211], v6 offset:17408
    ds_read_b64_tr_b16 a[212:213], v6 offset:20480
    ds_read_b64_tr_b16 a[214:215], v6 offset:21504
    ds_read_b64_tr_b16 a[216:217], v6 offset:24576
    ds_read_b64_tr_b16 a[218:219], v6 offset:25600
    ds_read_b64_tr_b16 a[220:221], v6 offset:28672
    ds_read_b64_tr_b16 a[222:223], v6 offset:29696
    ds_read_b64_tr_b16 a[224:225], v6 offset:32768
    ds_read_b64_tr_b16 a[226:227], v6 offset:33792
    ds_read_b64_tr_b16 a[228:229], v6 offset:36864
    ds_read_b64_tr_b16 a[230:231], v6 offset:37888
    ds_read_b64_tr_b16 a[232:233], v6 offset:40960
    ds_read_b64_tr_b16 a[234:235], v6 offset:41984
    ds_read_b64_tr_b16 a[236:237], v6 offset:45056
    ds_read_b64_tr_b16 a[238:239], v6 offset:46080
    ds_read_b64_tr_b16 a[240:241], v6 offset:49152
    ds_read_b64_tr_b16 a[242:243], v6 offset:50176
    ds_read_b64_tr_b16 a[244:245], v6 offset:53248
    ds_read_b64_tr_b16 a[246:247], v6 offset:54272
    ds_read_b64_tr_b16 a[248:249], v6 offset:57344
    ds_read_b64_tr_b16 a[250:251], v6 offset:58368
    ds_read_b64_tr_b16 a[252:253], v6 offset:61440
    ds_read_b64_tr_b16 a[254:255], v6 offset:62464
    s_waitcnt lgkmcnt(0)
    s_barrier
    v_and_b32 v8, 1, v2
    v_lshrrev_b32 v9, 1, v2
    v_lshlrev_b32 v10, 8, v9
    v_lshl_add_u32 v10, v3, 4, v10
    s_lshl_b32 s8, s4, 10
    v_lshl_add_u32 v11, v8, 12, v10
    v_add_u32 v11, s8, v11
    s_lshl_b32 s8, s4, 11
    v_lshl_add_u32 v12, v8, 10, v10
    v_add_u32 v12, s8, v12
    s_lshl_b32 s10, s4, 13
    s_lshl_b32 s9, s3, 13
    s_add_u32 s8, s9, 33554432
    s_add_u32 s9, s9, 16777216
    s_mov_b32 s7, 9
    s_cmp_lg_u32 s4, 0
    s_cbranch_scc1 WDW_72
DW_73:
    buffer_load_dword v13, off, s[60:63], 0 offset:132 sc1
    s_add_u32 s79, s79, 1
    s_cmp_gt_u32 s79, 2097152
    s_cbranch_scc1 mega_kernel_exit
    s_waitcnt vmcnt(0)
    v_cmp_gt_u32 vcc, 64, v13
    s_nop 0
    s_cbranch_vccz DWok_74
    s_sleep 10
    s_branch DW_73
DWok_74:
WDW_72:
    s_barrier
    s_lshl_b32 s69, s3, 7
    s_cmp_eq_u32 s101, 2
    s_cbranch_scc1 W_pm_64
    s_add_u32 s69, s69, 0
    s_mov_b32 s14, 0
    s_mov_b32 s15, 0
    s_min_u32 s12, s14, 63
    s_lshl_b32 s12, s12, 15
    s_add_u32 s12, s12, s10
    s_add_u32 s12, s12, 1048576
    s_lshl_b32 s13, s15, 15
    s_add_u32 s13, s13, s10
    s_mov_b32 m0, s13
    s_add_u32 s13, s13, 4096
    buffer_load_dwordx4 v7, s[52:55], s12 offen offset:0 sc1 lds
    buffer_load_dwordx4 v7, s[52:55], s12 offen offset:1024 sc1 lds
    buffer_load_dwordx4 v7, s[52:55], s12 offen offset:2048 sc1 lds
    buffer_load_dwordx4 v7, s[52:55], s12 offen offset:3072 sc1 lds
    s_mov_b32 m0, s13
    s_add_u32 s13, s13, 4096
    s_add_u32 s12, s12, 4096
    buffer_load_dwordx4 v7, s[52:55], s12 offen offset:0 sc1 lds
    buffer_load_dwordx4 v7, s[52:55], s12 offen offset:1024 sc1 lds
    buffer_load_dwordx4 v7, s[52:55], s12 offen offset:2048 sc1 lds
    buffer_load_dwordx4 v7, s[52:55], s12 offen offset:3072 sc1 lds
    s_cmp_lt_u32 s14, 24
    s_cselect_b32 s12, 2, 1
    s_add_u32 s14, s14, s12
    s_add_u32 s15, s15, 1
    s_and_b32 s15, s15, 3
    s_min_u32 s12, s14, 63
    s_lshl_b32 s12, s12, 15
    s_add_u32 s12, s12, s10
    s_add_u32 s12, s12, 1048576
    s_lshl_b32 s13, s15, 15
    s_add_u32 s13, s13, s10
    s_mov_b32 m0, s13
    s_add_u32 s13, s13, 4096
    buffer_load_dwordx4 v7, s[52:55], s12 offen offset:0 sc1 lds
    buffer_load_dwordx4 v7, s[52:55], s12 offen offset:1024 sc1 lds
    buffer_load_dwordx4 v7, s[52:55], s12 offen offset:2048 sc1 lds
    buffer_load_dwordx4 v7, s[52:55], s12 offen offset:3072 sc1 lds
    s_mov_b32 m0, s13
    s_add_u32 s13, s13, 4096
    s_add_u32 s12, s12, 4096
    buffer_load_dwordx4 v7, s[52:55], s12 offen offset:0 sc1 lds
    buffer_load_dwordx4 v7, s[52:55], s12 offen offset:1024 sc1 lds
    buffer_load_dwordx4 v7, s[52:55], s12 offen offset:2048 sc1 lds
    buffer_load_dwordx4 v7, s[52:55], s12 offen offset:3072 sc1 lds
    s_cmp_lt_u32 s14, 24
    s_cselect_b32 s12, 2, 1
    s_add_u32 s14, s14, s12
    s_add_u32 s15, s15, 1
    s_and_b32 s15, s15, 3
    s_min_u32 s12, s14, 63
    s_lshl_b32 s12, s12, 15
    s_add_u32 s12, s12, s10
    s_add_u32 s12, s12, 1048576
    s_lshl_b32 s13, s15, 15
    s_add_u32 s13, s13, s10
    s_mov_b32 m0, s13
    s_add_u32 s13, s13, 4096
    buffer_load_dwordx4 v7, s[52:55], s12 offen offset:0 sc1 lds
    buffer_load_dwordx4 v7, s[52:55], s12 offen offset:1024 sc1 lds
    buffer_load_dwordx4 v7, s[52:55], s12 offen offset:2048 sc1 lds
    buffer_load_dwordx4 v7, s[52:55], s12 offen offset:3072 sc1 lds
    s_mov_b32 m0, s13
    s_add_u32 s13, s13, 4096
    s_add_u32 s12, s12, 4096
    buffer_load_dwordx4 v7, s[52:55], s12 offen offset:0 sc1 lds
    buffer_load_dwordx4 v7, s[52:55], s12 offen offset:1024 sc1 lds
    buffer_load_dwordx4 v7, s[52:55], s12 offen offset:2048 sc1 lds
    buffer_load_dwordx4 v7, s[52:55], s12 offen offset:3072 sc1 lds
    s_cmp_lt_u32 s14, 24
    s_cselect_b32 s12, 2, 1
    s_add_u32 s14, s14, s12
    s_add_u32 s15, s15, 1
    s_and_b32 s15, s15, 3
    s_mov_b32 s66, 0
    s_mov_b32 s65, 0
    s_mov_b32 s67, 0
P2_loop_75:
    s_waitcnt vmcnt(12)
    s_barrier
    s_cmp_lg_u32 s4, 0
    s_cbranch_scc1 FS_76
    s_mov_b64 exec, 1
    v_mov_b32 v13, s65
    buffer_store_dword v13, off, s[52:55], s69 sc1
    s_mov_b64 exec, -1
FS_76:
    s_min_u32 s12, s14, 63
    s_lshl_b32 s12, s12, 15
    s_add_u32 s12, s12, s10
    s_add_u32 s12, s12, 1048576
    s_lshl_b32 s13, s15, 15
    s_add_u32 s13, s13, s10
    s_mov_b32 m0, s13
    s_add_u32 s13, s13, 4096
    buffer_load_dwordx4 v7, s[52:55], s12 offen offset:0 sc1 lds
    buffer_load_dwordx4 v7, s[52:55], s12 offen offset:1024 sc1 lds
    buffer_load_dwordx4 v7, s[52:55], s12 offen offset:2048 sc1 lds
    buffer_load_dwordx4 v7, s[52:55], s12 offen offset:3072 sc1 lds
    s_mov_b32 m0, s13
    s_add_u32 s13, s13, 4096
    s_add_u32 s12, s12, 4096
    buffer_load_dwordx4 v7, s[52:55], s12 offen offset:0 sc1 lds
    buffer_load_dwordx4 v7, s[52:55], s12 offen offset:1024 sc1 lds
    buffer_load_dwordx4 v7, s[52:55], s12 offen offset:2048 sc1 lds
    buffer_load_dwordx4 v7, s[52:55], s12 offen offset:3072 sc1 lds
    s_cmp_lt_u32 s14, 24
    s_cselect_b32 s12, 2, 1
    s_add_u32 s14, s14, s12
    s_add_u32 s15, s15, 1
    s_and_b32 s15, s15, 3
    s_lshl_b32 s12, s67, 15
    v_add_u32 v13, s12, v7
    ds_read_b128 v[32:35], v13 offset:0
    ds_read_b128 v[36:39], v13 offset:1024
    ds_read_b128 v[40:43], v13 offset:2048
    ds_read_b128 v[44:47], v13 offset:3072
    ds_read_b128 v[48:51], v13 offset:4096
    ds_read_b128 v[52:55], v13 offset:5120
    ds_read_b128 v[56:59], v13 offset:6144
    ds_read_b128 v[60:63], v13 offset:7168
    s_waitcnt lgkmcnt(7)
    v_mfma_f32_32x32x16_bf16 v[16:31], a[0:3], v[32:35], 0
    v_mfma_f32_32x32x16_bf16 v[96:111], v[32:35], a[128:131], 0
    ds_read_b128 v[32:35], v13 offset:8192
    s_waitcnt lgkmcnt(7)
    v_mfma_f32_32x32x16_bf16 v[16:31], a[4:7], v[36:39], v[16:31]
    v_mfma_f32_32x32x16_bf16 v[96:111], v[36:39], a[132:135], v[96:111]
    ds_read_b128 v[36:39], v13 offset:9216
    s_waitcnt lgkmcnt(7)
    v_mfma_f32_32x32x16_bf16 v[16:31], a[8:11], v[40:43], v[16:31]
    v_mfma_f32_32x32x16_bf16 v[96:111], v[40:43], a[136:139], v[96:111]
    ds_read_b128 v[40:43], v13 offset:10240
    s_waitcnt lgkmcnt(7)
    v_mfma_f32_32x32x16_bf16 v[16:31], a[12:15], v[44:47], v[16:31]
    v_mfma_f32_32x32x16_bf16 v[96:111], v[44:47], a[140:143], v[96:111]
    ds_read_b128 v[44:47], v13 offset:11264
    s_waitcnt lgkmcnt(7)
    v_mfma_f32_32x32x16_bf16 v[16:31], a[16:19], v[48:51], v[16:31]
    v_mfma_f32_32x32x16_bf16 v[96:111], v[48:51], a[144:147], v[96:111]
    ds_read_b128 v[48:51], v13 offset:12288
    s_waitcnt lgkmcnt(7)
    v_mfma_f32_32x32x16_bf16 v[16:31], a[20:23], v[52:55], v[16:31]
    v_mfma_f32_32x32x16_bf16 v[96:111], v[52:55], a[148:151], v[96:111]
    ds_read_b128 v[52:55], v13 offset:13312
    s_waitcnt lgkmcnt(7)
    v_mfma_f32_32x32x16_bf16 v[16:31], a[24:27], v[56:59], v[16:31]
    v_mfma_f32_32x32x16_bf16 v[96:111], v[56:59], a[152:155], v[96:111]
    ds_read_b128 v[56:59], v13 offset:14336
    s_waitcnt lgkmcnt(7)
    v_mfma_f32_32x32x16_bf16 v[16:31], a[28:31], v[60:63], v[16:31]
    v_mfma_f32_32x32x16_bf16 v[96:111], v[60:63], a[156:159], v[96:111]
    ds_read_b128 v[60:63], v13 offset:15360
    s_waitcnt lgkmcnt(7)
    v_mfma_f32_32x32x16_bf16 v[16:31], a[32:35], v[32:35], v[16:31]
    v_mfma_f32_32x32x16_bf16 v[96:111], v[32:35], a[160:163], v[96:111]
    ds_read_b128 v[32:35], v13 offset:16384
    s_waitcnt lgkmcnt(7)
    v_mfma_f32_32x32x16_bf16 v[16:31], a[36:39], v[36:39], v[16:31]
    v_mfma_f32_32x32x16_bf16 v[96:111], v[36:39], a[164:167], v[96:111]
    ds_read_b128 v[36:39], v13 offset:17408
    s_waitcnt lgkmcnt(7)
    v_mfma_f32_32x32x16_bf16 v[16:31], a[40:43], v[40:43], v[16:31]
    v_mfma_f32_32x32x16_bf16 v[96:111], v[40:43], a[168:171], v[96:111]
    ds_read_b128 v[40:43], v13 offset:18432
    s_waitcnt lgkmcnt(7)
    v_mfma_f32_32x32x16_bf16 v[16:31], a[44:47], v[44:47], v[16:31]
    v_mfma_f32_32x32x16_bf16 v[96:111], v[44:47], a[172:175], v[96:111]
    ds_read_b128 v[44:47], v13 offset:19456
    s_waitcnt lgkmcnt(7)
    v_mfma_f32_32x32x16_bf16 v[16:31], a[48:51], v[48:51], v[16:31]
    v_mfma_f32_32x32x16_bf16 v[96:111], v[48:51], a[176:179], v[96:111]
    ds_read_b128 v[48:51], v13 offset:20480
    s_waitcnt lgkmcnt(7)
    v_mfma_f32_32x32x16_bf16 v[16:31], a[52:55], v[52:55], v[16:31]
    v_mfma_f32_32x32x16_bf16 v[96:111], v[52:55], a[180:183], v[96:111]
    ds_read_b128 v[52:55], v13 offset:21504
    s_waitcnt lgkmcnt(7)
    v_mfma_f32_32x32x16_bf16 v[16:31], a[56:59], v[56:59], v[16:31]
    v_mfma_f32_32x32x16_bf16 v[96:111], v[56:59], a[184:187], v[96:111]
    ds_read_b128 v[56:59], v13 offset:22528
    s_waitcnt lgkmcnt(7)
    v_mfma_f32_32x32x16_bf16 v[16:31], a[60:63], v[60:63], v[16:31]
    v_mfma_f32_32x32x16_bf16 v[96:111], v[60:63], a[188:191], v[96:111]
    ds_read_b128 v[60:63], v13 offset:23552
    s_waitcnt lgkmcnt(7)
    v_mfma_f32_32x32x16_bf16 v[16:31], a[64:67], v[32:35], v[16:31]
    v_mfma_f32_32x32x16_bf16 v[96:111], v[32:35], a[192:195], v[96:111]
    ds_read_b128 v[32:35], v13 offset:24576
    s_waitcnt lgkmcnt(7)
    v_mfma_f32_32x32x16_bf16 v[16:31], a[68:71], v[36:39], v[16:31]
    v_mfma_f32_32x32x16_bf16 v[96:111], v[36:39], a[196:199], v[96:111]
    ds_read_b128 v[36:39], v13 offset:25600
    s_waitcnt lgkmcnt(7)
    v_mfma_f32_32x32x16_bf16 v[16:31], a[72:75], v[40:43], v[16:31]
    v_mfma_f32_32x32x16_bf16 v[96:111], v[40:43], a[200:203], v[96:111]
    ds_read_b128 v[40:43], v13 offset:26624
    s_waitcnt lgkmcnt(7)
    v_mfma_f32_32x32x16_bf16 v[16:31], a[76:79], v[44:47], v[16:31]
    v_mfma_f32_32x32x16_bf16 v[96:111], v[44:47], a[204:207], v[96:111]
    ds_read_b128 v[44:47], v13 offset:27648
    s_waitcnt lgkmcnt(7)
    v_mfma_f32_32x32x16_bf16 v[16:31], a[80:83], v[48:51], v[16:31]
    v_mfma_f32_32x32x16_bf16 v[96:111], v[48:51], a[208:211], v[96:111]
    ds_read_b128 v[48:51], v13 offset:28672
    s_waitcnt lgkmcnt(7)
    v_mfma_f32_32x32x16_bf16 v[16:31], a[84:87], v[52:55], v[16:31]
    v_mfma_f32_32x32x16_bf16 v[96:111], v[52:55], a[212:215], v[96:111]
    ds_read_b128 v[52:55], v13 offset:29696
    s_waitcnt lgkmcnt(7)
    v_mfma_f32_32x32x16_bf16 v[16:31], a[88:91], v[56:59], v[16:31]
    v_mfma_f32_32x32x16_bf16 v[96:111], v[56:59], a[216:219], v[96:111]
    ds_read_b128 v[56:59], v13 offset:30720
    s_waitcnt lgkmcnt(7)
    v_mfma_f32_32x32x16_bf16 v[16:31], a[92:95], v[60:63], v[16:31]
    v_mfma_f32_32x32x16_bf16 v[96:111], v[60:63], a[220:223], v[96:111]
    ds_read_b128 v[60:63], v13 offset:31744
    s_waitcnt lgkmcnt(7)
    v_mfma_f32_32x32x16_bf16 v[16:31], a[96:99], v[32:35], v[16:31]
    v_mfma_f32_32x32x16_bf16 v[96:111], v[32:35], a[224:227], v[96:111]
    s_waitcnt lgkmcnt(6)
    v_mfma_f32_32x32x16_bf16 v[16:31], a[100:103], v[36:39], v[16:31]
    v_mfma_f32_32x32x16_bf16 v[96:111], v[36:39], a[228:231], v[96:111]
    s_waitcnt lgkmcnt(5)
    v_mfma_f32_32x32x16_bf16 v[16:31], a[104:107], v[40:43], v[16:31]
    v_mfma_f32_32x32x16_bf16 v[96:111], v[40:43], a[232:235], v[96:111]
    s_waitcnt lgkmcnt(4)
    v_mfma_f32_32x32x16_bf16 v[16:31], a[108:111], v[44:47], v[16:31]
    v_mfma_f32_32x32x16_bf16 v[96:111], v[44:47], a[236:239], v[96:111]
    s_waitcnt lgkmcnt(3)
    v_mfma_f32_32x32x16_bf16 v[16:31], a[112:115], v[48:51], v[16:31]
    v_mfma_f32_32x32x16_bf16 v[96:111], v[48:51], a[240:243], v[96:111]
    s_waitcnt lgkmcnt(2)
    v_mfma_f32_32x32x16_bf16 v[16:31], a[116:119], v[52:55], v[16:31]
    v_mfma_f32_32x32x16_bf16 v[96:111], v[52:55], a[244:247], v[96:111]
    s_waitcnt lgkmcnt(1)
    v_mfma_f32_32x32x16_bf16 v[16:31], a[120:123], v[56:59], v[16:31]
    v_mfma_f32_32x32x16_bf16 v[96:111], v[56:59], a[248:251], v[96:111]
    s_waitcnt lgkmcnt(0)
    v_mfma_f32_32x32x16_bf16 v[16:31], a[124:127], v[60:63], v[16:31]
    v_mfma_f32_32x32x16_bf16 v[96:111], v[60:63], a[252:255], v[96:111]
    s_lshl_b32 s12, s66, 18
    s_add_u32 s13, s12, s8
    s_add_u32 s12, s12, s9
    s_nop 7
    v_cvt_pk_bf16_f32 v64, v16, v17
    v_cvt_pk_bf16_f32 v65, v18, v19
    v_cvt_pk_bf16_f32 v66, v20, v21
    v_cvt_pk_bf16_f32 v67, v22, v23
    buffer_store_dwordx4 v[64:67], v11, s[52:55], s12 offen offset:0 sc1
    v_cvt_pk_bf16_f32 v68, v24, v25
    v_cvt_pk_bf16_f32 v69, v26, v27
    v_cvt_pk_bf16_f32 v70, v28, v29
    v_cvt_pk_bf16_f32 v71, v30, v31
    buffer_store_dwordx4 v[68:71], v11, s[52:55], s12 offen offset:512 sc1
    v_cvt_pk_bf16_f32 v72, v96, v97
    v_cvt_pk_bf16_f32 v73, v98, v99
    v_cvt_pk_bf16_f32 v74, v104, v105
    v_cvt_pk_bf16_f32 v75, v106, v107
    buffer_store_dwordx4 v[72:75], v12, s[52:55], s13 offen offset:0 sc1
    v_cvt_pk_bf16_f32 v76, v100, v101
    v_cvt_pk_bf16_f32 v77, v102, v103
    v_cvt_pk_bf16_f32 v78, v108, v109
    v_cvt_pk_bf16_f32 v79, v110, v111
    buffer_store_dwordx4 v[76:79], v12, s[52:55], s13 offen offset:512 sc1
    s_mov_b32 s65, s66
    s_cmp_lt_u32 s66, 24
    s_cselect_b32 s12, 2, 1
    s_add_u32 s66, s66, s12
    s_add_u32 s67, s67, 1
    s_and_b32 s67, s67, 3
    s_cmp_lt_u32 s66, 64
    s_cbranch_scc1 P2_loop_75
    s_waitcnt vmcnt(0)
    s_barrier
    s_mov_b32 s66, 64
    s_cmp_lg_u32 s4, 0
    s_cbranch_scc1 FS_77
    s_mov_b64 exec, 1
    v_mov_b32 v13, s66
    buffer_store_dword v13, off, s[52:55], s69 sc1
    s_mov_b64 exec, -1
FS_77:
    s_branch W_late_68
W_pm_64:
    s_add_u32 s72, s69, 8256
    s_add_u32 s69, s69, 8192
    s_mov_b32 s14, 1
    s_mov_b32 s15, 0
    s_min_u32 s12, s14, 63
    s_lshl_b32 s12, s12, 15
    s_add_u32 s12, s12, s10
    s_add_u32 s12, s12, 1048576
    s_lshl_b32 s13, s15, 15
    s_add_u32 s13, s13, s10
    s_mov_b32 m0, s13
    s_add_u32 s13, s13, 4096
    buffer_load_dwordx4 v7, s[52:55], s12 offen offset:0 sc1 lds
    buffer_load_dwordx4 v7, s[52:55], s12 offen offset:1024 sc1 lds
    buffer_load_dwordx4 v7, s[52:55], s12 offen offset:2048 sc1 lds
    buffer_load_dwordx4 v7, s[52:55], s12 offen offset:3072 sc1 lds
    s_mov_b32 m0, s13
    s_add_u32 s13, s13, 4096
    s_add_u32 s12, s12, 4096
    buffer_load_dwordx4 v7, s[52:55], s12 offen offset:0 sc1 lds
    buffer_load_dwordx4 v7, s[52:55], s12 offen offset:1024 sc1 lds
    buffer_load_dwordx4 v7, s[52:55], s12 offen offset:2048 sc1 lds
    buffer_load_dwordx4 v7, s[52:55], s12 offen offset:3072 sc1 lds
    s_cmp_lt_u32 s14, 24
    s_cselect_b32 s12, 2, 1
    s_add_u32 s14, s14, s12
    s_add_u32 s15, s15, 1
    s_and_b32 s15, s15, 3
    s_min_u32 s12, s14, 63
    s_lshl_b32 s12, s12, 15
    s_add_u32 s12, s12, s10
    s_add_u32 s12, s12, 1048576
    s_lshl_b32 s13, s15, 15
    s_add_u32 s13, s13, s10
    s_mov_b32 m0, s13
    s_add_u32 s13, s13, 4096
    buffer_load_dwordx4 v7, s[52:55], s12 offen offset:0 sc1 lds
    buffer_load_dwordx4 v7, s[52:55], s12 offen offset:1024 sc1 lds
    buffer_load_dwordx4 v7, s[52:55], s12 offen offset:2048 sc1 lds
    buffer_load_dwordx4 v7, s[52:55], s12 offen offset:3072 sc1 lds
    s_mov_b32 m0, s13
    s_add_u32 s13, s13, 4096
    s_add_u32 s12, s12, 4096
    buffer_load_dwordx4 v7, s[52:55], s12 offen offset:0 sc1 lds
    buffer_load_dwordx4 v7, s[52:55], s12 offen offset:1024 sc1 lds
    buffer_load_dwordx4 v7, s[52:55], s12 offen offset:2048 sc1 lds
    buffer_load_dwordx4 v7, s[52:55], s12 offen offset:3072 sc1 lds
    s_cmp_lt_u32 s14, 24
    s_cselect_b32 s12, 2, 1
    s_add_u32 s14, s14, s12
    s_add_u32 s15, s15, 1
    s_and_b32 s15, s15, 3
    s_min_u32 s12, s14, 63
    s_lshl_b32 s12, s12, 15
    s_add_u32 s12, s12, s10
    s_add_u32 s12, s12, 1048576
    s_lshl_b32 s13, s15, 15
    s_add_u32 s13, s13, s10
    s_mov_b32 m0, s13
    s_add_u32 s13, s13, 4096
    buffer_load_dwordx4 v7, s[52:55], s12 offen offset:0 sc1 lds
    buffer_load_dwordx4 v7, s[52:55], s12 offen offset:1024 sc1 lds
    buffer_load_dwordx4 v7, s[52:55], s12 offen offset:2048 sc1 lds
    buffer_load_dwordx4 v7, s[52:55], s12 offen offset:3072 sc1 lds
    s_mov_b32 m0, s13
    s_add_u32 s13, s13, 4096
    s_add_u32 s12, s12, 4096
    buffer_load_dwordx4 v7, s[52:55], s12 offen offset:0 sc1 lds
    buffer_load_dwordx4 v7, s[52:55], s12 offen offset:1024 sc1 lds
    buffer_load_dwordx4 v7, s[52:55], s12 offen offset:2048 sc1 lds
    buffer_load_dwordx4 v7, s[52:55], s12 offen offset:3072 sc1 lds
    s_cmp_lt_u32 s14, 24
    s_cselect_b32 s12, 2, 1
    s_add_u32 s14, s14, s12
    s_add_u32 s15, s15, 1
    s_and_b32 s15, s15, 3
    s_mov_b32 s66, 1
    s_mov_b32 s65, 1
    s_mov_b32 s67, 0
P2_loop_78:
    s_waitcnt vmcnt(12)
    s_barrier
    s_cmp_lg_u32 s4, 0
    s_cbranch_scc1 FS_79
    s_mov_b64 exec, 1
    v_mov_b32 v13, s65
    buffer_store_dword v13, off, s[52:55], s72 sc1
    s_mov_b64 exec, -1
FS_79:
    s_min_u32 s12, s14, 63
    s_lshl_b32 s12, s12, 15
    s_add_u32 s12, s12, s10
    s_add_u32 s12, s12, 1048576
    s_lshl_b32 s13, s15, 15
    s_add_u32 s13, s13, s10
    s_mov_b32 m0, s13
    s_add_u32 s13, s13, 4096
    buffer_load_dwordx4 v7, s[52:55], s12 offen offset:0 sc1 lds
    buffer_load_dwordx4 v7, s[52:55], s12 offen offset:1024 sc1 lds
    buffer_load_dwordx4 v7, s[52:55], s12 offen offset:2048 sc1 lds
    buffer_load_dwordx4 v7, s[52:55], s12 offen offset:3072 sc1 lds
    s_mov_b32 m0, s13
    s_add_u32 s13, s13, 4096
    s_add_u32 s12, s12, 4096
    buffer_load_dwordx4 v7, s[52:55], s12 offen offset:0 sc1 lds
    buffer_load_dwordx4 v7, s[52:55], s12 offen offset:1024 sc1 lds
    buffer_load_dwordx4 v7, s[52:55], s12 offen offset:2048 sc1 lds
    buffer_load_dwordx4 v7, s[52:55], s12 offen offset:3072 sc1 lds
    s_cmp_lt_u32 s14, 24
    s_cselect_b32 s12, 2, 1
    s_add_u32 s14, s14, s12
    s_add_u32 s15, s15, 1
    s_and_b32 s15, s15, 3
    s_lshl_b32 s12, s67, 15
    v_add_u32 v13, s12, v7
    ds_read_b128 v[32:35], v13 offset:0
    ds_read_b128 v[36:39], v13 offset:1024
    ds_read_b128 v[40:43], v13 offset:2048
    ds_read_b128 v[44:47], v13 offset:3072
    ds_read_b128 v[48:51], v13 offset:4096
    ds_read_b128 v[52:55], v13 offset:5120
    ds_read_b128 v[56:59], v13 offset:6144
    ds_read_b128 v[60:63], v13 offset:7168
    s_waitcnt lgkmcnt(7)
    v_mfma_f32_32x32x16_bf16 v[16:31], a[0:3], v[32:35], 0
    v_mfma_f32_32x32x16_bf16 v[96:111], v[32:35], a[128:131], 0
    ds_read_b128 v[32:35], v13 offset:8192
    s_waitcnt lgkmcnt(7)
    v_mfma_f32_32x32x16_bf16 v[16:31], a[4:7], v[36:39], v[16:31]
    v_mfma_f32_32x32x16_bf16 v[96:111], v[36:39], a[132:135], v[96:111]
    ds_read_b128 v[36:39], v13 offset:9216
    s_waitcnt lgkmcnt(7)
    v_mfma_f32_32x32x16_bf16 v[16:31], a[8:11], v[40:43], v[16:31]
    v_mfma_f32_32x32x16_bf16 v[96:111], v[40:43], a[136:139], v[96:111]
    ds_read_b128 v[40:43], v13 offset:10240
    s_waitcnt lgkmcnt(7)
    v_mfma_f32_32x32x16_bf16 v[16:31], a[12:15], v[44:47], v[16:31]
    v_mfma_f32_32x32x16_bf16 v[96:111], v[44:47], a[140:143], v[96:111]
    ds_read_b128 v[44:47], v13 offset:11264
    s_waitcnt lgkmcnt(7)
    v_mfma_f32_32x32x16_bf16 v[16:31], a[16:19], v[48:51], v[16:31]
    v_mfma_f32_32x32x16_bf16 v[96:111], v[48:51], a[144:147], v[96:111]
    ds_read_b128 v[48:51], v13 offset:12288
    s_waitcnt lgkmcnt(7)
    v_mfma_f32_32x32x16_bf16 v[16:31], a[20:23], v[52:55], v[16:31]
    v_mfma_f32_32x32x16_bf16 v[96:111], v[52:55], a[148:151], v[96:111]
    ds_read_b128 v[52:55], v13 offset:13312
    s_waitcnt lgkmcnt(7)
    v_mfma_f32_32x32x16_bf16 v[16:31], a[24:27], v[56:59], v[16:31]
    v_mfma_f32_32x32x16_bf16 v[96:111], v[56:59], a[152:155], v[96:111]
    ds_read_b128 v[56:59], v13 offset:14336
    s_waitcnt lgkmcnt(7)
    v_mfma_f32_32x32x16_bf16 v[16:31], a[28:31], v[60:63], v[16:31]
    v_mfma_f32_32x32x16_bf16 v[96:111], v[60:63], a[156:159], v[96:111]
    ds_read_b128 v[60:63], v13 offset:15360
    s_waitcnt lgkmcnt(7)
    v_mfma_f32_32x32x16_bf16 v[16:31], a[32:35], v[32:35], v[16:31]
    v_mfma_f32_32x32x16_bf16 v[96:111], v[32:35], a[160:163], v[96:111]
    ds_read_b128 v[32:35], v13 offset:16384
    s_waitcnt lgkmcnt(7)
    v_mfma_f32_32x32x16_bf16 v[16:31], a[36:39], v[36:39], v[16:31]
    v_mfma_f32_32x32x16_bf16 v[96:111], v[36:39], a[164:167], v[96:111]
    ds_read_b128 v[36:39], v13 offset:17408
    s_waitcnt lgkmcnt(7)
    v_mfma_f32_32x32x16_bf16 v[16:31], a[40:43], v[40:43], v[16:31]
    v_mfma_f32_32x32x16_bf16 v[96:111], v[40:43], a[168:171], v[96:111]
    ds_read_b128 v[40:43], v13 offset:18432
    s_waitcnt lgkmcnt(7)
    v_mfma_f32_32x32x16_bf16 v[16:31], a[44:47], v[44:47], v[16:31]
    v_mfma_f32_32x32x16_bf16 v[96:111], v[44:47], a[172:175], v[96:111]
    ds_read_b128 v[44:47], v13 offset:19456
    s_waitcnt lgkmcnt(7)
    v_mfma_f32_32x32x16_bf16 v[16:31], a[48:51], v[48:51], v[16:31]
    v_mfma_f32_32x32x16_bf16 v[96:111], v[48:51], a[176:179], v[96:111]
    ds_read_b128 v[48:51], v13 offset:20480
    s_waitcnt lgkmcnt(7)
    v_mfma_f32_32x32x16_bf16 v[16:31], a[52:55], v[52:55], v[16:31]
    v_mfma_f32_32x32x16_bf16 v[96:111], v[52:55], a[180:183], v[96:111]
    ds_read_b128 v[52:55], v13 offset:21504
    s_waitcnt lgkmcnt(7)
    v_mfma_f32_32x32x16_bf16 v[16:31], a[56:59], v[56:59], v[16:31]
    v_mfma_f32_32x32x16_bf16 v[96:111], v[56:59], a[184:187], v[96:111]
    ds_read_b128 v[56:59], v13 offset:22528
    s_waitcnt lgkmcnt(7)
    v_mfma_f32_32x32x16_bf16 v[16:31], a[60:63], v[60:63], v[16:31]
    v_mfma_f32_32x32x16_bf16 v[96:111], v[60:63], a[188:191], v[96:111]
    ds_read_b128 v[60:63], v13 offset:23552
    s_waitcnt lgkmcnt(7)
    v_mfma_f32_32x32x16_bf16 v[16:31], a[64:67], v[32:35], v[16:31]
    v_mfma_f32_32x32x16_bf16 v[96:111], v[32:35], a[192:195], v[96:111]
    ds_read_b128 v[32:35], v13 offset:24576
    s_waitcnt lgkmcnt(7)
    v_mfma_f32_32x32x16_bf16 v[16:31], a[68:71], v[36:39], v[16:31]
    v_mfma_f32_32x32x16_bf16 v[96:111], v[36:39], a[196:199], v[96:111]
    ds_read_b128 v[36:39], v13 offset:25600
    s_waitcnt lgkmcnt(7)
    v_mfma_f32_32x32x16_bf16 v[16:31], a[72:75], v[40:43], v[16:31]
    v_mfma_f32_32x32x16_bf16 v[96:111], v[40:43], a[200:203], v[96:111]
    ds_read_b128 v[40:43], v13 offset:26624
    s_waitcnt lgkmcnt(7)
    v_mfma_f32_32x32x16_bf16 v[16:31], a[76:79], v[44:47], v[16:31]
    v_mfma_f32_32x32x16_bf16 v[96:111], v[44:47], a[204:207], v[96:111]
    ds_read_b128 v[44:47], v13 offset:27648
    s_waitcnt lgkmcnt(7)
    v_mfma_f32_32x32x16_bf16 v[16:31], a[80:83], v[48:51], v[16:31]
    v_mfma_f32_32x32x16_bf16 v[96:111], v[48:51], a[208:211], v[96:111]
    ds_read_b128 v[48:51], v13 offset:28672
    s_waitcnt lgkmcnt(7)
    v_mfma_f32_32x32x16_bf16 v[16:31], a[84:87], v[52:55], v[16:31]
    v_mfma_f32_32x32x16_bf16 v[96:111], v[52:55], a[212:215], v[96:111]
    ds_read_b128 v[52:55], v13 offset:29696
    s_waitcnt lgkmcnt(7)
    v_mfma_f32_32x32x16_bf16 v[16:31], a[88:91], v[56:59], v[16:31]
    v_mfma_f32_32x32x16_bf16 v[96:111], v[56:59], a[216:219], v[96:111]
    ds_read_b128 v[56:59], v13 offset:30720
    s_waitcnt lgkmcnt(7)
    v_mfma_f32_32x32x16_bf16 v[16:31], a[92:95], v[60:63], v[16:31]
    v_mfma_f32_32x32x16_bf16 v[96:111], v[60:63], a[220:223], v[96:111]
    ds_read_b128 v[60:63], v13 offset:31744
    s_waitcnt lgkmcnt(7)
    v_mfma_f32_32x32x16_bf16 v[16:31], a[96:99], v[32:35], v[16:31]
    v_mfma_f32_32x32x16_bf16 v[96:111], v[32:35], a[224:227], v[96:111]
    s_waitcnt lgkmcnt(6)
    v_mfma_f32_32x32x16_bf16 v[16:31], a[100:103], v[36:39], v[16:31]
    v_mfma_f32_32x32x16_bf16 v[96:111], v[36:39], a[228:231], v[96:111]
    s_waitcnt lgkmcnt(5)
    v_mfma_f32_32x32x16_bf16 v[16:31], a[104:107], v[40:43], v[16:31]
    v_mfma_f32_32x32x16_bf16 v[96:111], v[40:43], a[232:235], v[96:111]
    s_waitcnt lgkmcnt(4)
    v_mfma_f32_32x32x16_bf16 v[16:31], a[108:111], v[44:47], v[16:31]
    v_mfma_f32_32x32x16_bf16 v[96:111], v[44:47], a[236:239], v[96:111]
    s_waitcnt lgkmcnt(3)
    v_mfma_f32_32x32x16_bf16 v[16:31], a[112:115], v[48:51], v[16:31]
    v_mfma_f32_32x32x16_bf16 v[96:111], v[48:51], a[240:243], v[96:111]
    s_waitcnt lgkmcnt(2)
    v_mfma_f32_32x32x16_bf16 v[16:31], a[116:119], v[52:55], v[16:31]
    v_mfma_f32_32x32x16_bf16 v[96:111], v[52:55], a[244:247], v[96:111]
    s_waitcnt lgkmcnt(1)
    v_mfma_f32_32x32x16_bf16 v[16:31], a[120:123], v[56:59], v[16:31]
    v_mfma_f32_32x32x16_bf16 v[96:111], v[56:59], a[248:251], v[96:111]
    s_waitcnt lgkmcnt(0)
    v_mfma_f32_32x32x16_bf16 v[16:31], a[124:127], v[60:63], v[16:31]
    v_mfma_f32_32x32x16_bf16 v[96:111], v[60:63], a[252:255], v[96:111]
    s_lshl_b32 s12, s66, 18
    s_add_u32 s13, s12, s8
    s_add_u32 s12, s12, s9
    s_nop 7
    v_cvt_pk_bf16_f32 v64, v16, v17
    v_cvt_pk_bf16_f32 v65, v18, v19
    v_cvt_pk_bf16_f32 v66, v20, v21
    v_cvt_pk_bf16_f32 v67, v22, v23
    buffer_store_dwordx4 v[64:67], v11, s[52:55], s12 offen offset:0 sc1
    v_cvt_pk_bf16_f32 v68, v24, v25
    v_cvt_pk_bf16_f32 v69, v26, v27
    v_cvt_pk_bf16_f32 v70, v28, v29
    v_cvt_pk_bf16_f32 v71, v30, v31
    buffer_store_dwordx4 v[68:71], v11, s[52:55], s12 offen offset:512 sc1
    v_cvt_pk_bf16_f32 v72, v96, v97
    v_cvt_pk_bf16_f32 v73, v98, v99
    v_cvt_pk_bf16_f32 v74, v104, v105
    v_cvt_pk_bf16_f32 v75, v106, v107
    buffer_store_dwordx4 v[72:75], v12, s[52:55], s13 offen offset:0 sc1
    v_cvt_pk_bf16_f32 v76, v100, v101
    v_cvt_pk_bf16_f32 v77, v102, v103
    v_cvt_pk_bf16_f32 v78, v108, v109
    v_cvt_pk_bf16_f32 v79, v110, v111
    buffer_store_dwordx4 v[76:79], v12, s[52:55], s13 offen offset:512 sc1
    s_mov_b32 s65, s66
    s_cmp_lt_u32 s66, 24
    s_cselect_b32 s12, 2, 1
    s_add_u32 s66, s66, s12
    s_add_u32 s67, s67, 1
    s_and_b32 s67, s67, 3
    s_cmp_lt_u32 s66, 24
    s_cbranch_scc1 P2_loop_78
    s_waitcnt vmcnt(0)
    s_barrier
    s_mov_b32 s66, 64
    s_cmp_lg_u32 s4, 0
    s_cbranch_scc1 FS_80
    s_mov_b64 exec, 1
    v_mov_b32 v13, s66
    buffer_store_dword v13, off, s[52:55], s72 sc1
    s_mov_b64 exec, -1
FS_80:
    s_cmp_lg_u32 s4, 0
    s_cbranch_scc1 WDW_81
DW_82:
    buffer_load_dword v13, off, s[60:63], 0 offset:8 sc1
    s_add_u32 s79, s79, 1
    s_cmp_gt_u32 s79, 2097152
    s_cbranch_scc1 mega_kernel_exit
    s_waitcnt vmcnt(0)
    v_cmp_gt_u32 vcc, 32, v13
    s_nop 0
    s_cbranch_vccz DWok_83
    s_sleep 8
    s_branch DW_82
DWok_83:
WDW_81:
    s_barrier
    v_and_b32 v13, 7, v1
    v_lshlrev_b32 v13, 2, v13
    v_lshl_add_u32 v13, v9, 7, v13
    v_bfe_u32 v82, v1, 3, 2
    s_mul_i32 s12, s4, 8224
    v_add_u32 v14, s12, v7
    s_add_u32 s68, s10, 9437184
    s_add_u32 s9, s9, 50331648
    s_add_u32 s8, s8, 50331648
    s_mov_b32 s70, 0x05040100
    s_mov_b32 s71, 0x07060302
    s_mov_b32 s66, 0
    s_mov_b32 s73, 1
    s_lshl_b32 s12, s4, 2
    v_mov_b32 v83, s12
    v_mov_b32 v92, 0
    v_mov_b32 v15, 0xff81ff81
PM_loop_84:
    s_lshr_b32 s67, s66, 2
    s_and_b32 s65, s66, 3
    s_cmp_lt_u32 s4, s65
    s_cbranch_scc1 PM_skip_85
    s_lshl_b32 s12, s67, 15
    s_add_u32 s12, s12, s68
    s_add_u32 s13, s12, 4096
    buffer_load_dwordx4 v[32:35], v7, s[52:55], s12 offen offset:0 sc1
    buffer_load_dwordx4 v[36:39], v7, s[52:55], s12 offen offset:1024 sc1
    buffer_load_dwordx4 v[40:43], v7, s[52:55], s12 offen offset:2048 sc1
    buffer_load_dwordx4 v[44:47], v7, s[52:55], s12 offen offset:3072 sc1
    buffer_load_dwordx4 v[48:51], v7, s[52:55], s13 offen offset:0 sc1
    buffer_load_dwordx4 v[52:55], v7, s[52:55], s13 offen offset:1024 sc1
    buffer_load_dwordx4 v[56:59], v7, s[52:55], s13 offen offset:2048 sc1
    buffer_load_dwordx4 v[60:63], v7, s[52:55], s13 offen offset:3072 sc1
    s_waitcnt vmcnt(0)
    ds_write_b128 v14, v[32:35] offset:0
    ds_write_b128 v14, v[36:39] offset:1024
    ds_write_b128 v14, v[40:43] offset:2048
    ds_write_b128 v14, v[44:47] offset:3072
    ds_write_b128 v14, v[48:51] offset:4096
    ds_write_b128 v14, v[52:55] offset:5120
    ds_write_b128 v14, v[56:59] offset:6144
    ds_write_b128 v14, v[60:63] offset:7168
    v_maximum3_f32 v81, v32, v33, v34
    v_maximum3_f32 v81, v81, v35, v36
    v_maximum3_f32 v81, v81, v37, v38
    v_maximum3_f32 v81, v81, v39, v40
    v_maximum3_f32 v81, v81, v41, v42
    v_maximum3_f32 v81, v81, v43, v44
    v_maximum3_f32 v81, v81, v45, v46
    v_maximum3_f32 v81, v81, v47, v48
    v_maximum3_f32 v81, v81, v49, v50
    v_maximum3_f32 v81, v81, v51, v52
    v_maximum3_f32 v81, v81, v53, v54
    v_maximum3_f32 v81, v81, v55, v56
    v_maximum3_f32 v81, v81, v57, v58
    v_maximum3_f32 v81, v81, v59, v60
    v_maximum3_f32 v81, v81, v61, v62
    v_cmp_u_f32 vcc, v81, v63
    s_nop 0
    s_cbranch_vccz PM_fast_86
    s_and_b32 s12, s73, 7
    s_cbranch_scc1 PM_fast_86
    v_cmp_eq_u32 vcc, v15, v32
    v_cmp_eq_u32 s[14:15], v15, v33
    s_nop 0
    s_or_b64 vcc, vcc, s[14:15]
    v_cmp_eq_u32 s[14:15], v15, v34
    s_nop 0
    s_or_b64 vcc, vcc, s[14:15]
    v_cmp_eq_u32 s[14:15], v15, v35
    s_nop 0
    s_or_b64 vcc, vcc, s[14:15]
    v_cmp_eq_u32 s[14:15], v15, v36
    s_nop 0
    s_or_b64 vcc, vcc, s[14:15]
    v_cmp_eq_u32 s[14:15], v15, v37
    s_nop 0
    s_or_b64 vcc, vcc, s[14:15]
    v_cmp_eq_u32 s[14:15], v15, v38
    s_nop 0
    s_or_b64 vcc, vcc, s[14:15]
    v_cmp_eq_u32 s[14:15], v15, v39
    s_nop 0
    s_or_b64 vcc, vcc, s[14:15]
    v_cmp_eq_u32 s[14:15], v15, v40
    s_nop 0
    s_or_b64 vcc, vcc, s[14:15]
    v_cmp_eq_u32 s[14:15], v15, v41
    s_nop 0
    s_or_b64 vcc, vcc, s[14:15]
    v_cmp_eq_u32 s[14:15], v15, v42
    s_nop 0
    s_or_b64 vcc, vcc, s[14:15]
    v_cmp_eq_u32 s[14:15], v15, v43
    s_nop 0
    s_or_b64 vcc, vcc, s[14:15]
    v_cmp_eq_u32 s[14:15], v15, v44
    s_nop 0
    s_or_b64 vcc, vcc, s[14:15]
    v_cmp_eq_u32 s[14:15], v15, v45
    s_nop 0
    s_or_b64 vcc, vcc, s[14:15]
    v_cmp_eq_u32 s[14:15], v15, v46
    s_nop 0
    s_or_b64 vcc, vcc, s[14:15]
    v_cmp_eq_u32 s[14:15], v15, v47
    s_nop 0
    s_or_b64 vcc, vcc, s[14:15]
    v_cmp_eq_u32 s[14:15], v15, v48
    s_nop 0
    s_or_b64 vcc, vcc, s[14:15]
    v_cmp_eq_u32 s[14:15], v15, v49
    s_nop 0
    s_or_b64 vcc, vcc, s[14:15]
    v_cmp_eq_u32 s[14:15], v15, v50
    s_nop 0
    s_or_b64 vcc, vcc, s[14:15]
    v_cmp_eq_u32 s[14:15], v15, v51
    s_nop 0
    s_or_b64 vcc, vcc, s[14:15]
    v_cmp_eq_u32 s[14:15], v15, v52
    s_nop 0
    s_or_b64 vcc, vcc, s[14:15]
    v_cmp_eq_u32 s[14:15], v15, v53
    s_nop 0
    s_or_b64 vcc, vcc, s[14:15]
    v_cmp_eq_u32 s[14:15], v15, v54
    s_nop 0
    s_or_b64 vcc, vcc, s[14:15]
    v_cmp_eq_u32 s[14:15], v15, v55
    s_nop 0
    s_or_b64 vcc, vcc, s[14:15]
    v_cmp_eq_u32 s[14:15], v15, v56
    s_nop 0
    s_or_b64 vcc, vcc, s[14:15]
    v_cmp_eq_u32 s[14:15], v15, v57
    s_nop 0
    s_or_b64 vcc, vcc, s[14:15]
    v_cmp_eq_u32 s[14:15], v15, v58
    s_nop 0
    s_or_b64 vcc, vcc, s[14:15]
    v_cmp_eq_u32 s[14:15], v15, v59
    s_nop 0
    s_or_b64 vcc, vcc, s[14:15]
    v_cmp_eq_u32 s[14:15], v15, v60
    s_nop 0
    s_or_b64 vcc, vcc, s[14:15]
    v_cmp_eq_u32 s[14:15], v15, v61
    s_nop 0
    s_or_b64 vcc, vcc, s[14:15]
    v_cmp_eq_u32 s[14:15], v15, v62
    s_nop 0
    s_or_b64 vcc, vcc, s[14:15]
    v_cmp_eq_u32 s[14:15], v15, v63
    s_nop 0
    s_or_b64 vcc, vcc, s[14:15]
PM_fast_86:
    s_cmp_eq_u64 vcc, 0
    s_cselect_b32 s12, 1, 0
    v_mov_b32 v81, s12
    ds_write_b32 v83, v81 offset:40960
PM_skip_85:
    s_add_u32 s73, s73, 1
    s_add_u32 s79, s79, 1
    s_cmp_gt_u32 s79, 2097152
    s_cbranch_scc1 mega_kernel_exit
    s_waitcnt lgkmcnt(0)
    s_barrier
    ds_read_b128 v[84:87], v92 offset:40960
    s_waitcnt lgkmcnt(0)
    v_mul_u32_u24 v85, v85, v84
    v_mul_u32_u24 v86, v86, v85
    v_mul_u32_u24 v87, v87, v86
    v_add3_u32 v84, v84, v85, v86
    v_add_u32 v84, v84, v87
    s_nop 0
    v_readfirstlane_b32 s64, v84
    s_barrier
    s_and_b32 s12, s64, 6
    s_cmp_ge_u32 s64, 3
    s_cselect_b32 s64, 3, s12
    s_cmp_eq_u32 s67, 15
    s_cselect_b32 s64, s64, s12
    s_cmp_gt_u32 s64, s65
    s_cbranch_scc1 PM_go_87
    s_sleep 2
    s_branch PM_loop_84
PM_go_87:
    s_sub_u32 s12, s64, 1
    v_min_u32 v80, s12, v82
    v_mul_u32_u24 v80, 8224, v80
    v_add_u32 v80, v80, v13
    ds_read2_b32 v[32:33], v80 offset0:0 offset1:8
    ds_read2_b32 v[34:35], v80 offset0:16 offset1:24
    ds_read2_b32 v[36:37], v80 offset0:64 offset1:72
    ds_read2_b32 v[38:39], v80 offset0:80 offset1:88
    ds_read2_b32 v[40:41], v80 offset0:128 offset1:136
    ds_read2_b32 v[42:43], v80 offset0:144 offset1:152
    ds_read2_b32 v[44:45], v80 offset0:192 offset1:200
    ds_read2_b32 v[46:47], v80 offset0:208 offset1:216
    v_add_u32 v80, 0x400, v80
    ds_read2_b32 v[48:49], v80 offset0:0 offset1:8
    ds_read2_b32 v[50:51], v80 offset0:16 offset1:24
    ds_read2_b32 v[52:53], v80 offset0:64 offset1:72
    ds_read2_b32 v[54:55], v80 offset0:80 offset1:88
    s_waitcnt lgkmcnt(10)
    v_perm_b32 v84, v33, v32, s70
    v_perm_b32 v85, v35, v34, s70
    v_perm_b32 v86, v33, v32, s71
    v_perm_b32 v87, v35, v34, s71
    s_nop 1
    v_mfma_f32_32x32x16_bf16 v[16:31], a[0:3], v[84:87], 0
    ds_read2_b32 v[56:57], v80 offset0:128 offset1:136
    ds_read2_b32 v[58:59], v80 offset0:144 offset1:152
    s_waitcnt lgkmcnt(10)
    v_perm_b32 v88, v37, v36, s70
    v_perm_b32 v89, v39, v38, s70
    v_perm_b32 v90, v37, v36, s71
    v_perm_b32 v91, v39, v38, s71
    v_mfma_f32_32x32x16_bf16 v[96:111], v[84:87], a[128:131], 0
    s_nop 0
    v_mfma_f32_32x32x16_bf16 v[16:31], a[4:7], v[88:91], v[16:31]
    ds_read2_b32 v[60:61], v80 offset0:192 offset1:200
    ds_read2_b32 v[62:63], v80 offset0:208 offset1:216
    v_add_u32 v80, 0x400, v80
    s_waitcnt lgkmcnt(10)
    v_perm_b32 v84, v41, v40, s70
    v_perm_b32 v85, v43, v42, s70
    v_perm_b32 v86, v41, v40, s71
    v_perm_b32 v87, v43, v42, s71
    v_mfma_f32_32x32x16_bf16 v[96:111], v[88:91], a[132:135], v[96:111]
    s_nop 0
    v_mfma_f32_32x32x16_bf16 v[16:31], a[8:11], v[84:87], v[16:31]
    ds_read2_b32 v[32:33], v80 offset0:0 offset1:8
    ds_read2_b32 v[34:35], v80 offset0:16 offset1:24
    s_waitcnt lgkmcnt(10)
    v_perm_b32 v88, v45, v44, s70
    v_perm_b32 v89, v47, v46, s70
    v_perm_b32 v90, v45, v44, s71
    v_perm_b32 v91, v47, v46, s71
    v_mfma_f32_32x32x16_bf16 v[96:111], v[84:87], a[136:139], v[96:111]
    s_nop 0
    v_mfma_f32_32x32x16_bf16 v[16:31], a[12:15], v[88:91], v[16:31]
    ds_read2_b32 v[36:37], v80 offset0:64 offset1:72
    ds_read2_b32 v[38:39], v80 offset0:80 offset1:88
    s_waitcnt lgkmcnt(10)
    v_perm_b32 v84, v49, v48, s70
    v_perm_b32 v85, v51, v50, s70
    v_perm_b32 v86, v49, v48, s71
    v_perm_b32 v87, v51, v50, s71
    v_mfma_f32_32x32x16_bf16 v[96:111], v[88:91], a[140:143], v[96:111]
    s_nop 0
    v_mfma_f32_32x32x16_bf16 v[16:31], a[16:19], v[84:87], v[16:31]
    ds_read2_b32 v[40:41], v80 offset0:128 offset1:136
    ds_read2_b32 v[42:43], v80 offset0:144 offset1:152
    s_waitcnt lgkmcnt(10)
    v_perm_b32 v88, v53, v52, s70
    v_perm_b32 v89, v55, v54, s70
    v_perm_b32 v90, v53, v52, s71
    v_perm_b32 v91, v55, v54, s71
    v_mfma_f32_32x32x16_bf16 v[96:111], v[84:87], a[144:147], v[96:111]
    s_nop 0
    v_mfma_f32_32x32x16_bf16 v[16:31], a[20:23], v[88:91], v[16:31]
    ds_read2_b32 v[44:45], v80 offset0:192 offset1:200
    ds_read2_b32 v[46:47], v80 offset0:208 offset1:216
    v_add_u32 v80, 0x400, v80
    s_waitcnt lgkmcnt(10)
    v_perm_b32 v84, v57, v56, s70
    v_perm_b32 v85, v59, v58, s70
    v_perm_b32 v86, v57, v56, s71
    v_perm_b32 v87, v59, v58, s71
    v_mfma_f32_32x32x16_bf16 v[96:111], v[88:91], a[148:151], v[96:111]
    s_nop 0
    v_mfma_f32_32x32x16_bf16 v[16:31], a[24:27], v[84:87], v[16:31]
    ds_read2_b32 v[48:49], v80 offset0:0 offset1:8
    ds_read2_b32 v[50:51], v80 offset0:16 offset1:24
    s_waitcnt lgkmcnt(10)
    v_perm_b32 v88, v61, v60, s70
    v_perm_b32 v89, v63, v62, s70
    v_perm_b32 v90, v61, v60, s71
    v_perm_b32 v91, v63, v62, s71
    v_mfma_f32_32x32x16_bf16 v[96:111], v[84:87], a[152:155], v[96:111]
    s_nop 0
    v_mfma_f32_32x32x16_bf16 v[16:31], a[28:31], v[88:91], v[16:31]
    ds_read2_b32 v[52:53], v80 offset0:64 offset1:72
    ds_read2_b32 v[54:55], v80 offset0:80 offset1:88
    s_waitcnt lgkmcnt(10)
    v_perm_b32 v84, v33, v32, s70
    v_perm_b32 v85, v35, v34, s70
    v_perm_b32 v86, v33, v32, s71
    v_perm_b32 v87, v35, v34, s71
    v_mfma_f32_32x32x16_bf16 v[96:111], v[88:91], a[156:159], v[96:111]
    s_nop 0
    v_mfma_f32_32x32x16_bf16 v[16:31], a[32:35], v[84:87], v[16:31]
    ds_read2_b32 v[56:57], v80 offset0:128 offset1:136
    ds_read2_b32 v[58:59], v80 offset0:144 offset1:152
    s_waitcnt lgkmcnt(10)
    v_perm_b32 v88, v37, v36, s70
    v_perm_b32 v89, v39, v38, s70
    v_perm_b32 v90, v37, v36, s71
    v_perm_b32 v91, v39, v38, s71
    v_mfma_f32_32x32x16_bf16 v[96:111], v[84:87], a[160:163], v[96:111]
    s_nop 0
    v_mfma_f32_32x32x16_bf16 v[16:31], a[36:39], v[88:91], v[16:31]
    ds_read2_b32 v[60:61], v80 offset0:192 offset1:200
    ds_read2_b32 v[62:63], v80 offset0:208 offset1:216
    v_add_u32 v80, 0x400, v80
    s_waitcnt lgkmcnt(10)
    v_perm_b32 v84, v41, v40, s70
    v_perm_b32 v85, v43, v42, s70
    v_perm_b32 v86, v41, v40, s71
    v_perm_b32 v87, v43, v42, s71
    v_mfma_f32_32x32x16_bf16 v[96:111], v[88:91], a[164:167], v[96:111]
    s_nop 0
    v_mfma_f32_32x32x16_bf16 v[16:31], a[40:43], v[84:87], v[16:31]
    ds_read2_b32 v[32:33], v80 offset0:0 offset1:8
    ds_read2_b32 v[34:35], v80 offset0:16 offset1:24
    s_waitcnt lgkmcnt(10)
    v_perm_b32 v88, v45, v44, s70
    v_perm_b32 v89, v47, v46, s70
    v_perm_b32 v90, v45, v44, s71
    v_perm_b32 v91, v47, v46, s71
    v_mfma_f32_32x32x16_bf16 v[96:111], v[84:87], a[168:171], v[96:111]
    s_nop 0
    v_mfma_f32_32x32x16_bf16 v[16:31], a[44:47], v[88:91], v[16:31]
    ds_read2_b32 v[36:37], v80 offset0:64 offset1:72
    ds_read2_b32 v[38:39], v80 offset0:80 offset1:88
    s_waitcnt lgkmcnt(10)
    v_perm_b32 v84, v49, v48, s70
    v_perm_b32 v85, v51, v50, s70
    v_perm_b32 v86, v49, v48, s71
    v_perm_b32 v87, v51, v50, s71
    v_mfma_f32_32x32x16_bf16 v[96:111], v[88:91], a[172:175], v[96:111]
    s_nop 0
    v_mfma_f32_32x32x16_bf16 v[16:31], a[48:51], v[84:87], v[16:31]
    ds_read2_b32 v[40:41], v80 offset0:128 offset1:136
    ds_read2_b32 v[42:43], v80 offset0:144 offset1:152
    s_waitcnt lgkmcnt(10)
    v_perm_b32 v88, v53, v52, s70
    v_perm_b32 v89, v55, v54, s70
    v_perm_b32 v90, v53, v52, s71
    v_perm_b32 v91, v55, v54, s71
    v_mfma_f32_32x32x16_bf16 v[96:111], v[84:87], a[176:179], v[96:111]
    s_nop 0
    v_mfma_f32_32x32x16_bf16 v[16:31], a[52:55], v[88:91], v[16:31]
    ds_read2_b32 v[44:45], v80 offset0:192 offset1:200
    ds_read2_b32 v[46:47], v80 offset0:208 offset1:216
    v_add_u32 v80, 0x400, v80
    s_waitcnt lgkmcnt(10)
    v_perm_b32 v84, v57, v56, s70
    v_perm_b32 v85, v59, v58, s70
    v_perm_b32 v86, v57, v56, s71
    v_perm_b32 v87, v59, v58, s71
    v_mfma_f32_32x32x16_bf16 v[96:111], v[88:91], a[180:183], v[96:111]
    s_nop 0
    v_mfma_f32_32x32x16_bf16 v[16:31], a[56:59], v[84:87], v[16:31]
    ds_read2_b32 v[48:49], v80 offset0:0 offset1:8
    ds_read2_b32 v[50:51], v80 offset0:16 offset1:24
    s_waitcnt lgkmcnt(10)
    v_perm_b32 v88, v61, v60, s70
    v_perm_b32 v89, v63, v62, s70
    v_perm_b32 v90, v61, v60, s71
    v_perm_b32 v91, v63, v62, s71
    v_mfma_f32_32x32x16_bf16 v[96:111], v[84:87], a[184:187], v[96:111]
    s_nop 0
    v_mfma_f32_32x32x16_bf16 v[16:31], a[60:63], v[88:91], v[16:31]
    ds_read2_b32 v[52:53], v80 offset0:64 offset1:72
    ds_read2_b32 v[54:55], v80 offset0:80 offset1:88
    s_waitcnt lgkmcnt(10)
    v_perm_b32 v84, v33, v32, s70
    v_perm_b32 v85, v35, v34, s70
    v_perm_b32 v86, v33, v32, s71
    v_perm_b32 v87, v35, v34, s71
    v_mfma_f32_32x32x16_bf16 v[96:111], v[88:91], a[188:191], v[96:111]
    s_nop 0
    v_mfma_f32_32x32x16_bf16 v[16:31], a[64:67], v[84:87], v[16:31]
    ds_read2_b32 v[56:57], v80 offset0:128 offset1:136
    ds_read2_b32 v[58:59], v80 offset0:144 offset1:152
    s_waitcnt lgkmcnt(10)
    v_perm_b32 v88, v37, v36, s70
    v_perm_b32 v89, v39, v38, s70
    v_perm_b32 v90, v37, v36, s71
    v_perm_b32 v91, v39, v38, s71
    v_mfma_f32_32x32x16_bf16 v[96:111], v[84:87], a[192:195], v[96:111]
    s_nop 0
    v_mfma_f32_32x32x16_bf16 v[16:31], a[68:71], v[88:91], v[16:31]
    ds_read2_b32 v[60:61], v80 offset0:192 offset1:200
    ds_read2_b32 v[62:63], v80 offset0:208 offset1:216
    v_add_u32 v80, 0x400, v80
    s_waitcnt lgkmcnt(10)
    v_perm_b32 v84, v41, v40, s70
    v_perm_b32 v85, v43, v42, s70
    v_perm_b32 v86, v41, v40, s71
    v_perm_b32 v87, v43, v42, s71
    v_mfma_f32_32x32x16_bf16 v[96:111], v[88:91], a[196:199], v[96:111]
    s_nop 0
    v_mfma_f32_32x32x16_bf16 v[16:31], a[72:75], v[84:87], v[16:31]
    ds_read2_b32 v[32:33], v80 offset0:0 offset1:8
    ds_read2_b32 v[34:35], v80 offset0:16 offset1:24
    s_waitcnt lgkmcnt(10)
    v_perm_b32 v88, v45, v44, s70
    v_perm_b32 v89, v47, v46, s70
    v_perm_b32 v90, v45, v44, s71
    v_perm_b32 v91, v47, v46, s71
    v_mfma_f32_32x32x16_bf16 v[96:111], v[84:87], a[200:203], v[96:111]
    s_nop 0
    v_mfma_f32_32x32x16_bf16 v[16:31], a[76:79], v[88:91], v[16:31]
    ds_read2_b32 v[36:37], v80 offset0:64 offset1:72
    ds_read2_b32 v[38:39], v80 offset0:80 offset1:88
    s_waitcnt lgkmcnt(10)
    v_perm_b32 v84, v49, v48, s70
    v_perm_b32 v85, v51, v50, s70
    v_perm_b32 v86, v49, v48, s71
    v_perm_b32 v87, v51, v50, s71
    v_mfma_f32_32x32x16_bf16 v[96:111], v[88:91], a[204:207], v[96:111]
    s_nop 0
    v_mfma_f32_32x32x16_bf16 v[16:31], a[80:83], v[84:87], v[16:31]
    ds_read2_b32 v[40:41], v80 offset0:128 offset1:136
    ds_read2_b32 v[42:43], v80 offset0:144 offset1:152
    s_waitcnt lgkmcnt(10)
    v_perm_b32 v88, v53, v52, s70
    v_perm_b32 v89, v55, v54, s70
    v_perm_b32 v90, v53, v52, s71
    v_perm_b32 v91, v55, v54, s71
    v_mfma_f32_32x32x16_bf16 v[96:111], v[84:87], a[208:211], v[96:111]
    s_nop 0
    v_mfma_f32_32x32x16_bf16 v[16:31], a[84:87], v[88:91], v[16:31]
    ds_read2_b32 v[44:45], v80 offset0:192 offset1:200
    ds_read2_b32 v[46:47], v80 offset0:208 offset1:216
    v_add_u32 v80, 0x400, v80
    s_waitcnt lgkmcnt(10)
    v_perm_b32 v84, v57, v56, s70
    v_perm_b32 v85, v59, v58, s70
    v_perm_b32 v86, v57, v56, s71
    v_perm_b32 v87, v59, v58, s71
    v_mfma_f32_32x32x16_bf16 v[96:111], v[88:91], a[212:215], v[96:111]
    s_nop 0
    v_mfma_f32_32x32x16_bf16 v[16:31], a[88:91], v[84:87], v[16:31]
    ds_read2_b32 v[48:49], v80 offset0:0 offset1:8
    ds_read2_b32 v[50:51], v80 offset0:16 offset1:24
    s_waitcnt lgkmcnt(10)
    v_perm_b32 v88, v61, v60, s70
    v_perm_b32 v89, v63, v62, s70
    v_perm_b32 v90, v61, v60, s71
    v_perm_b32 v91, v63, v62, s71
    v_mfma_f32_32x32x16_bf16 v[96:111], v[84:87], a[216:219], v[96:111]
    s_nop 0
    v_mfma_f32_32x32x16_bf16 v[16:31], a[92:95], v[88:91], v[16:31]
    ds_read2_b32 v[52:53], v80 offset0:64 offset1:72
    ds_read2_b32 v[54:55], v80 offset0:80 offset1:88
    s_waitcnt lgkmcnt(10)
    v_perm_b32 v84, v33, v32, s70
    v_perm_b32 v85, v35, v34, s70
    v_perm_b32 v86, v33, v32, s71
    v_perm_b32 v87, v35, v34, s71
    v_mfma_f32_32x32x16_bf16 v[96:111], v[88:91], a[220:223], v[96:111]
    s_nop 0
    v_mfma_f32_32x32x16_bf16 v[16:31], a[96:99], v[84:87], v[16:31]
    ds_read2_b32 v[56:57], v80 offset0:128 offset1:136
    ds_read2_b32 v[58:59], v80 offset0:144 offset1:152
    s_waitcnt lgkmcnt(10)
    v_perm_b32 v88, v37, v36, s70
    v_perm_b32 v89, v39, v38, s70
    v_perm_b32 v90, v37, v36, s71
    v_perm_b32 v91, v39, v38, s71
    v_mfma_f32_32x32x16_bf16 v[96:111], v[84:87], a[224:227], v[96:111]
    s_nop 0
    v_mfma_f32_32x32x16_bf16 v[16:31], a[100:103], v[88:91], v[16:31]
    ds_read2_b32 v[60:61], v80 offset0:192 offset1:200
    ds_read2_b32 v[62:63], v80 offset0:208 offset1:216
    v_add_u32 v80, 0x400, v80
    s_waitcnt lgkmcnt(10)
    v_perm_b32 v84, v41, v40, s70
    v_perm_b32 v85, v43, v42, s70
    v_perm_b32 v86, v41, v40, s71
    v_perm_b32 v87, v43, v42, s71
    v_mfma_f32_32x32x16_bf16 v[96:111], v[88:91], a[228:231], v[96:111]
    s_nop 0
    v_mfma_f32_32x32x16_bf16 v[16:31], a[104:107], v[84:87], v[16:31]
    s_waitcnt lgkmcnt(8)
    v_perm_b32 v88, v45, v44, s70
    v_perm_b32 v89, v47, v46, s70
    v_perm_b32 v90, v45, v44, s71
    v_perm_b32 v91, v47, v46, s71
    v_mfma_f32_32x32x16_bf16 v[96:111], v[84:87], a[232:235], v[96:111]
    s_nop 0
    v_mfma_f32_32x32x16_bf16 v[16:31], a[108:111], v[88:91], v[16:31]
    s_waitcnt lgkmcnt(6)
    v_perm_b32 v84, v49, v48, s70
    v_perm_b32 v85, v51, v50, s70
    v_perm_b32 v86, v49, v48, s71
    v_perm_b32 v87, v51, v50, s71
    v_mfma_f32_32x32x16_bf16 v[96:111], v[88:91], a[236:239], v[96:111]
    s_nop 0
    v_mfma_f32_32x32x16_bf16 v[16:31], a[112:115], v[84:87], v[16:31]
    s_waitcnt lgkmcnt(4)
    v_perm_b32 v88, v53, v52, s70
    v_perm_b32 v89, v55, v54, s70
    v_perm_b32 v90, v53, v52, s71
    v_perm_b32 v91, v55, v54, s71
    v_mfma_f32_32x32x16_bf16 v[96:111], v[84:87], a[240:243], v[96:111]
    s_nop 0
    v_mfma_f32_32x32x16_bf16 v[16:31], a[116:119], v[88:91], v[16:31]
    s_waitcnt lgkmcnt(2)
    v_perm_b32 v84, v57, v56, s70
    v_perm_b32 v85, v59, v58, s70
    v_perm_b32 v86, v57, v56, s71
    v_perm_b32 v87, v59, v58, s71
    v_mfma_f32_32x32x16_bf16 v[96:111], v[88:91], a[244:247], v[96:111]
    s_nop 0
    v_mfma_f32_32x32x16_bf16 v[16:31], a[120:123], v[84:87], v[16:31]
    s_waitcnt lgkmcnt(0)
    v_perm_b32 v88, v61, v60, s70
    v_perm_b32 v89, v63, v62, s70
    v_perm_b32 v90, v61, v60, s71
    v_perm_b32 v91, v63, v62, s71
    v_mfma_f32_32x32x16_bf16 v[96:111], v[84:87], a[248:251], v[96:111]
    s_nop 0
    v_mfma_f32_32x32x16_bf16 v[16:31], a[124:127], v[88:91], v[16:31]
    v_mfma_f32_32x32x16_bf16 v[96:111], v[88:91], a[252:255], v[96:111]
    s_lshl_b32 s12, s67, 18
    s_add_u32 s13, s12, s8
    s_add_u32 s12, s12, s9
    s_nop 7
    v_cvt_pk_bf16_f32 v64, v16, v17
    v_cvt_pk_bf16_f32 v65, v18, v19
    v_cvt_pk_bf16_f32 v66, v20, v21
    v_cvt_pk_bf16_f32 v67, v22, v23
    buffer_store_dwordx4 v[64:67], v11, s[52:55], s12 offen offset:0 sc1
    v_cvt_pk_bf16_f32 v68, v24, v25
    v_cvt_pk_bf16_f32 v69, v26, v27
    v_cvt_pk_bf16_f32 v70, v28, v29
    v_cvt_pk_bf16_f32 v71, v30, v31
    buffer_store_dwordx4 v[68:71], v11, s[52:55], s12 offen offset:512 sc1
    v_cvt_pk_bf16_f32 v72, v96, v97
    v_cvt_pk_bf16_f32 v73, v98, v99
    v_cvt_pk_bf16_f32 v74, v104, v105
    v_cvt_pk_bf16_f32 v75, v106, v107
    buffer_store_dwordx4 v[72:75], v12, s[52:55], s13 offen offset:0 sc1
    v_cvt_pk_bf16_f32 v76, v100, v101
    v_cvt_pk_bf16_f32 v77, v102, v103
    v_cvt_pk_bf16_f32 v78, v108, v109
    v_cvt_pk_bf16_f32 v79, v110, v111
    buffer_store_dwordx4 v[76:79], v12, s[52:55], s13 offen offset:512 sc1
    s_lshl_b32 s66, s67, 2
    s_add_u32 s66, s66, s64
    s_waitcnt vmcnt(0)
    s_barrier
    s_cmp_lg_u32 s4, 0
    s_cbranch_scc1 FS_88
    s_mov_b64 exec, 1
    v_mov_b32 v81, s66
    buffer_store_dword v81, off, s[52:55], s69 sc1
    s_mov_b64 exec, -1
FS_88:
    s_cmp_lt_u32 s66, 63
    s_cbranch_scc1 PM_loop_84
    s_branch mega_kernel_exit
W_q_63:
    s_sub_u32 s3, s100, 32
    s_mov_b32 s56, s20
    s_and_b32 s57, s21, 0xffff
    s_mov_b32 s58, 0x400000
    s_mov_b32 s59, 0x00020000
    s_mov_b32 s64, s20
    s_and_b32 s65, s21, 0xffff
    s_mov_b32 s66, 0x400000
    s_mov_b32 s67, 0x00020000
    v_and_b32 v1, 63, v0
    v_lshrrev_b32 v2, 4, v1
    v_and_b32 v3, 15, v1
    v_lshlrev_b32 v4, 13, v2
    v_lshl_add_u32 v4, v3, 4, v4
    v_lshrrev_b32 v5, 1, v2
    v_lshlrev_b32 v5, 3, v5
    v_lshrrev_b32 v6, 2, v3
    v_add_u32 v5, v5, v6
    v_lshlrev_b32 v5, 8, v5
    v_and_b32 v6, 1, v2
    v_lshl_add_u32 v5, v6, 5, v5
    v_and_b32 v6, 3, v3
    v_lshl_add_u32 v5, v6, 3, v5
    s_lshl_b32 s8, s4, 6
    v_add_u32 v5, s8, v5
    v_add_u32 v6, 0x10000, v5
    v_lshlrev_b32 v7, 4, v1
    s_lshl_b32 s7, s3, 9
    s_lshl_b32 s8, s4, 20
    s_add_u32 s7, s7, s8
    s_lshl_b32 s8, s4, 15
    s_mov_b32 m0, s8
    s_add_u32 s8, s8, 1024
    buffer_load_dwordx4 v4, s[56:59], s7 offen lds
    s_add_u32 s7, s7, 32768
    s_mov_b32 m0, s8
    s_add_u32 s8, s8, 1024
    buffer_load_dwordx4 v4, s[56:59], s7 offen lds
    s_add_u32 s7, s7, 32768
    s_mov_b32 m0, s8
    s_add_u32 s8, s8, 1024
    buffer_load_dwordx4 v4, s[56:59], s7 offen lds
    s_add_u32 s7, s7, 32768
    s_mov_b32 m0, s8
    s_add_u32 s8, s8, 1024
    buffer_load_dwordx4 v4, s[56:59], s7 offen lds
    s_add_u32 s7, s7, 32768
    s_mov_b32 m0, s8
    s_add_u32 s8, s8, 1024
    buffer_load_dwordx4 v4, s[56:59], s7 offen lds
    s_add_u32 s7, s7, 32768
    s_mov_b32 m0, s8
    s_add_u32 s8, s8, 1024
    buffer_load_dwordx4 v4, s[56:59], s7 offen lds
    s_add_u32 s7, s7, 32768
    s_mov_b32 m0, s8
    s_add_u32 s8, s8, 1024
    buffer_load_dwordx4 v4, s[56:59], s7 offen lds
    s_add_u32 s7, s7, 32768
    s_mov_b32 m0, s8
    s_add_u32 s8, s8, 1024
    buffer_load_dwordx4 v4, s[56:59], s7 offen lds
    s_add_u32 s7, s7, 32768
    s_mov_b32 m0, s8
    s_add_u32 s8, s8, 1024
    buffer_load_dwordx4 v4, s[56:59], s7 offen lds
    s_add_u32 s7, s7, 32768
    s_mov_b32 m0, s8
    s_add_u32 s8, s8, 1024
    buffer_load_dwordx4 v4, s[56:59], s7 offen lds
    s_add_u32 s7, s7, 32768
    s_mov_b32 m0, s8
    s_add_u32 s8, s8, 1024
    buffer_load_dwordx4 v4, s[56:59], s7 offen lds
    s_add_u32 s7, s7, 32768
    s_mov_b32 m0, s8
    s_add_u32 s8, s8, 1024
    buffer_load_dwordx4 v4, s[56:59], s7 offen lds
    s_add_u32 s7, s7, 32768
    s_mov_b32 m0, s8
    s_add_u32 s8, s8, 1024
    buffer_load_dwordx4 v4, s[56:59], s7 offen lds
    s_add_u32 s7, s7, 32768
    s_mov_b32 m0, s8
    s_add_u32 s8, s8, 1024
    buffer_load_dwordx4 v4, s[56:59], s7 offen lds
    s_add_u32 s7, s7, 32768
    s_mov_b32 m0, s8
    s_add_u32 s8, s8, 1024
    buffer_load_dwordx4 v4, s[56:59], s7 offen lds
    s_add_u32 s7, s7, 32768
    s_mov_b32 m0, s8
    s_add_u32 s8, s8, 1024
    buffer_load_dwordx4 v4, s[56:59], s7 offen lds
    s_add_u32 s7, s7, 32768
    s_mov_b32 m0, s8
    s_add_u32 s8, s8, 1024
    buffer_load_dwordx4 v4, s[56:59], s7 offen lds
    s_add_u32 s7, s7, 32768
    s_mov_b32 m0, s8
    s_add_u32 s8, s8, 1024
    buffer_load_dwordx4 v4, s[56:59], s7 offen lds
    s_add_u32 s7, s7, 32768
    s_mov_b32 m0, s8
    s_add_u32 s8, s8, 1024
    buffer_load_dwordx4 v4, s[56:59], s7 offen lds
    s_add_u32 s7, s7, 32768
    s_mov_b32 m0, s8
    s_add_u32 s8, s8, 1024
    buffer_load_dwordx4 v4, s[56:59], s7 offen lds
    s_add_u32 s7, s7, 32768
    s_mov_b32 m0, s8
    s_add_u32 s8, s8, 1024
    buffer_load_dwordx4 v4, s[56:59], s7 offen lds
    s_add_u32 s7, s7, 32768
    s_mov_b32 m0, s8
    s_add_u32 s8, s8, 1024
    buffer_load_dwordx4 v4, s[56:59], s7 offen lds
    s_add_u32 s7, s7, 32768
    s_mov_b32 m0, s8
    s_add_u32 s8, s8, 1024
    buffer_load_dwordx4 v4, s[56:59], s7 offen lds
    s_add_u32 s7, s7, 32768
    s_mov_b32 m0, s8
    s_add_u32 s8, s8, 1024
    buffer_load_dwordx4 v4, s[56:59], s7 offen lds
    s_add_u32 s7, s7, 32768
    s_mov_b32 m0, s8
    s_add_u32 s8, s8, 1024
    buffer_load_dwordx4 v4, s[56:59], s7 offen lds
    s_add_u32 s7, s7, 32768
    s_mov_b32 m0, s8
    s_add_u32 s8, s8, 1024
    buffer_load_dwordx4 v4, s[56:59], s7 offen lds
    s_add_u32 s7, s7, 32768
    s_mov_b32 m0, s8
    s_add_u32 s8, s8, 1024
    buffer_load_dwordx4 v4, s[56:59], s7 offen lds
    s_add_u32 s7, s7, 32768
    s_mov_b32 m0, s8
    s_add_u32 s8, s8, 1024
    buffer_load_dwordx4 v4, s[56:59], s7 offen lds
    s_add_u32 s7, s7, 32768
    s_mov_b32 m0, s8
    s_add_u32 s8, s8, 1024
    buffer_load_dwordx4 v4, s[56:59], s7 offen lds
    s_add_u32 s7, s7, 32768
    s_mov_b32 m0, s8
    s_add_u32 s8, s8, 1024
    buffer_load_dwordx4 v4, s[56:59], s7 offen lds
    s_add_u32 s7, s7, 32768
    s_mov_b32 m0, s8
    s_add_u32 s8, s8, 1024
    buffer_load_dwordx4 v4, s[56:59], s7 offen lds
    s_add_u32 s7, s7, 32768
    s_mov_b32 m0, s8
    s_add_u32 s8, s8, 1024
    buffer_load_dwordx4 v4, s[56:59], s7 offen lds
    s_add_u32 s7, s7, 32768
    s_waitcnt vmcnt(0)
    s_barrier
    ds_read_b64_tr_b16 a[0:1], v5 offset:0
    ds_read_b64_tr_b16 a[2:3], v5 offset:1024
    ds_read_b64_tr_b16 a[4:5], v5 offset:4096
    ds_read_b64_tr_b16 a[6:7], v5 offset:5120
    ds_read_b64_tr_b16 a[8:9], v5 offset:8192
    ds_read_b64_tr_b16 a[10:11], v5 offset:9216
    ds_read_b64_tr_b16 a[12:13], v5 offset:12288
    ds_read_b64_tr_b16 a[14:15], v5 offset:13312
    ds_read_b64_tr_b16 a[16:17], v5 offset:16384
    ds_read_b64_tr_b16 a[18:19], v5 offset:17408
    ds_read_b64_tr_b16 a[20:21], v5 offset:20480
    ds_read_b64_tr_b16 a[22:23], v5 offset:21504
    ds_read_b64_tr_b16 a[24:25], v5 offset:24576
    ds_read_b64_tr_b16 a[26:27], v5 offset:25600
    ds_read_b64_tr_b16 a[28:29], v5 offset:28672
    ds_read_b64_tr_b16 a[30:31], v5 offset:29696
    ds_read_b64_tr_b16 a[32:33], v5 offset:32768
    ds_read_b64_tr_b16 a[34:35], v5 offset:33792
    ds_read_b64_tr_b16 a[36:37], v5 offset:36864
    ds_read_b64_tr_b16 a[38:39], v5 offset:37888
    ds_read_b64_tr_b16 a[40:41], v5 offset:40960
    ds_read_b64_tr_b16 a[42:43], v5 offset:41984
    ds_read_b64_tr_b16 a[44:45], v5 offset:45056
    ds_read_b64_tr_b16 a[46:47], v5 offset:46080
    ds_read_b64_tr_b16 a[48:49], v5 offset:49152
    ds_read_b64_tr_b16 a[50:51], v5 offset:50176
    ds_read_b64_tr_b16 a[52:53], v5 offset:53248
    ds_read_b64_tr_b16 a[54:55], v5 offset:54272
    ds_read_b64_tr_b16 a[56:57], v5 offset:57344
    ds_read_b64_tr_b16 a[58:59], v5 offset:58368
    ds_read_b64_tr_b16 a[60:61], v5 offset:61440
    ds_read_b64_tr_b16 a[62:63], v5 offset:62464
    ds_read_b64_tr_b16 a[64:65], v6 offset:0
    ds_read_b64_tr_b16 a[66:67], v6 offset:1024
    ds_read_b64_tr_b16 a[68:69], v6 offset:4096
    ds_read_b64_tr_b16 a[70:71], v6 offset:5120
    ds_read_b64_tr_b16 a[72:73], v6 offset:8192
    ds_read_b64_tr_b16 a[74:75], v6 offset:9216
    ds_read_b64_tr_b16 a[76:77], v6 offset:12288
    ds_read_b64_tr_b16 a[78:79], v6 offset:13312
    ds_read_b64_tr_b16 a[80:81], v6 offset:16384
    ds_read_b64_tr_b16 a[82:83], v6 offset:17408
    ds_read_b64_tr_b16 a[84:85], v6 offset:20480
    ds_read_b64_tr_b16 a[86:87], v6 offset:21504
    ds_read_b64_tr_b16 a[88:89], v6 offset:24576
    ds_read_b64_tr_b16 a[90:91], v6 offset:25600
    ds_read_b64_tr_b16 a[92:93], v6 offset:28672
    ds_read_b64_tr_b16 a[94:95], v6 offset:29696
    ds_read_b64_tr_b16 a[96:97], v6 offset:32768
    ds_read_b64_tr_b16 a[98:99], v6 offset:33792
    ds_read_b64_tr_b16 a[100:101], v6 offset:36864
    ds_read_b64_tr_b16 a[102:103], v6 offset:37888
    ds_read_b64_tr_b16 a[104:105], v6 offset:40960
    ds_read_b64_tr_b16 a[106:107], v6 offset:41984
    ds_read_b64_tr_b16 a[108:109], v6 offset:45056
    ds_read_b64_tr_b16 a[110:111], v6 offset:46080
    ds_read_b64_tr_b16 a[112:113], v6 offset:49152
    ds_read_b64_tr_b16 a[114:115], v6 offset:50176
    ds_read_b64_tr_b16 a[116:117], v6 offset:53248
    ds_read_b64_tr_b16 a[118:119], v6 offset:54272
    ds_read_b64_tr_b16 a[120:121], v6 offset:57344
    ds_read_b64_tr_b16 a[122:123], v6 offset:58368
    ds_read_b64_tr_b16 a[124:125], v6 offset:61440
    ds_read_b64_tr_b16 a[126:127], v6 offset:62464
    s_waitcnt lgkmcnt(0)
    s_barrier
    s_lshl_b32 s7, s3, 9
    s_add_u32 s7, s7, 256
    s_lshl_b32 s8, s4, 20
    s_add_u32 s7, s7, s8
    s_lshl_b32 s8, s4, 15
    s_mov_b32 m0, s8
    s_add_u32 s8, s8, 1024
    buffer_load_dwordx4 v4, s[64:67], s7 offen lds
    s_add_u32 s7, s7, 32768
    s_mov_b32 m0, s8
    s_add_u32 s8, s8, 1024
    buffer_load_dwordx4 v4, s[64:67], s7 offen lds
    s_add_u32 s7, s7, 32768
    s_mov_b32 m0, s8
    s_add_u32 s8, s8, 1024
    buffer_load_dwordx4 v4, s[64:67], s7 offen lds
    s_add_u32 s7, s7, 32768
    s_mov_b32 m0, s8
    s_add_u32 s8, s8, 1024
    buffer_load_dwordx4 v4, s[64:67], s7 offen lds
    s_add_u32 s7, s7, 32768
    s_mov_b32 m0, s8
    s_add_u32 s8, s8, 1024
    buffer_load_dwordx4 v4, s[64:67], s7 offen lds
    s_add_u32 s7, s7, 32768
    s_mov_b32 m0, s8
    s_add_u32 s8, s8, 1024
    buffer_load_dwordx4 v4, s[64:67], s7 offen lds
    s_add_u32 s7, s7, 32768
    s_mov_b32 m0, s8
    s_add_u32 s8, s8, 1024
    buffer_load_dwordx4 v4, s[64:67], s7 offen lds
    s_add_u32 s7, s7, 32768
    s_mov_b32 m0, s8
    s_add_u32 s8, s8, 1024
    buffer_load_dwordx4 v4, s[64:67], s7 offen lds
    s_add_u32 s7, s7, 32768
    s_mov_b32 m0, s8
    s_add_u32 s8, s8, 1024
    buffer_load_dwordx4 v4, s[64:67], s7 offen lds
    s_add_u32 s7, s7, 32768
    s_mov_b32 m0, s8
    s_add_u32 s8, s8, 1024
    buffer_load_dwordx4 v4, s[64:67], s7 offen lds
    s_add_u32 s7, s7, 32768
    s_mov_b32 m0, s8
    s_add_u32 s8, s8, 1024
    buffer_load_dwordx4 v4, s[64:67], s7 offen lds
    s_add_u32 s7, s7, 32768
    s_mov_b32 m0, s8
    s_add_u32 s8, s8, 1024
    buffer_load_dwordx4 v4, s[64:67], s7 offen lds
    s_add_u32 s7, s7, 32768
    s_mov_b32 m0, s8
    s_add_u32 s8, s8, 1024
    buffer_load_dwordx4 v4, s[64:67], s7 offen lds
    s_add_u32 s7, s7, 32768
    s_mov_b32 m0, s8
    s_add_u32 s8, s8, 1024
    buffer_load_dwordx4 v4, s[64:67], s7 offen lds
    s_add_u32 s7, s7, 32768
    s_mov_b32 m0, s8
    s_add_u32 s8, s8, 1024
    buffer_load_dwordx4 v4, s[64:67], s7 offen lds
    s_add_u32 s7, s7, 32768
    s_mov_b32 m0, s8
    s_add_u32 s8, s8, 1024
    buffer_load_dwordx4 v4, s[64:67], s7 offen lds
    s_add_u32 s7, s7, 32768
    s_mov_b32 m0, s8
    s_add_u32 s8, s8, 1024
    buffer_load_dwordx4 v4, s[64:67], s7 offen lds
    s_add_u32 s7, s7, 32768
    s_mov_b32 m0, s8
    s_add_u32 s8, s8, 1024
    buffer_load_dwordx4 v4, s[64:67], s7 offen lds
    s_add_u32 s7, s7, 32768
    s_mov_b32 m0, s8
    s_add_u32 s8, s8, 1024
    buffer_load_dwordx4 v4, s[64:67], s7 offen lds
    s_add_u32 s7, s7, 32768
    s_mov_b32 m0, s8
    s_add_u32 s8, s8, 1024
    buffer_load_dwordx4 v4, s[64:67], s7 offen lds
    s_add_u32 s7, s7, 32768
    s_mov_b32 m0, s8
    s_add_u32 s8, s8, 1024
    buffer_load_dwordx4 v4, s[64:67], s7 offen lds
    s_add_u32 s7, s7, 32768
    s_mov_b32 m0, s8
    s_add_u32 s8, s8, 1024
    buffer_load_dwordx4 v4, s[64:67], s7 offen lds
    s_add_u32 s7, s7, 32768
    s_mov_b32 m0, s8
    s_add_u32 s8, s8, 1024
    buffer_load_dwordx4 v4, s[64:67], s7 offen lds
    s_add_u32 s7, s7, 32768
    s_mov_b32 m0, s8
    s_add_u32 s8, s8, 1024
    buffer_load_dwordx4 v4, s[64:67], s7 offen lds
    s_add_u32 s7, s7, 32768
    s_mov_b32 m0, s8
    s_add_u32 s8, s8, 1024
    buffer_load_dwordx4 v4, s[64:67], s7 offen lds
    s_add_u32 s7, s7, 32768
    s_mov_b32 m0, s8
    s_add_u32 s8, s8, 1024
    buffer_load_dwordx4 v4, s[64:67], s7 offen lds
    s_add_u32 s7, s7, 32768
    s_mov_b32 m0, s8
    s_add_u32 s8, s8, 1024
    buffer_load_dwordx4 v4, s[64:67], s7 offen lds
    s_add_u32 s7, s7, 32768
    s_mov_b32 m0, s8
    s_add_u32 s8, s8, 1024
    buffer_load_dwordx4 v4, s[64:67], s7 offen lds
    s_add_u32 s7, s7, 32768
    s_mov_b32 m0, s8
    s_add_u32 s8, s8, 1024
    buffer_load_dwordx4 v4, s[64:67], s7 offen lds
    s_add_u32 s7, s7, 32768
    s_mov_b32 m0, s8
    s_add_u32 s8, s8, 1024
    buffer_load_dwordx4 v4, s[64:67], s7 offen lds
    s_add_u32 s7, s7, 32768
    s_mov_b32 m0, s8
    s_add_u32 s8, s8, 1024
    buffer_load_dwordx4 v4, s[64:67], s7 offen lds
    s_add_u32 s7, s7, 32768
    s_mov_b32 m0, s8
    s_add_u32 s8, s8, 1024
    buffer_load_dwordx4 v4, s[64:67], s7 offen lds
    s_add_u32 s7, s7, 32768
    s_waitcnt vmcnt(0)
    s_barrier
    ds_read_b64_tr_b16 a[128:129], v5 offset:0
    ds_read_b64_tr_b16 a[130:131], v5 offset:1024
    ds_read_b64_tr_b16 a[132:133], v5 offset:4096
    ds_read_b64_tr_b16 a[134:135], v5 offset:5120
    ds_read_b64_tr_b16 a[136:137], v5 offset:8192
    ds_read_b64_tr_b16 a[138:139], v5 offset:9216
    ds_read_b64_tr_b16 a[140:141], v5 offset:12288
    ds_read_b64_tr_b16 a[142:143], v5 offset:13312
    ds_read_b64_tr_b16 a[144:145], v5 offset:16384
    ds_read_b64_tr_b16 a[146:147], v5 offset:17408
    ds_read_b64_tr_b16 a[148:149], v5 offset:20480
    ds_read_b64_tr_b16 a[150:151], v5 offset:21504
    ds_read_b64_tr_b16 a[152:153], v5 offset:24576
    ds_read_b64_tr_b16 a[154:155], v5 offset:25600
    ds_read_b64_tr_b16 a[156:157], v5 offset:28672
    ds_read_b64_tr_b16 a[158:159], v5 offset:29696
    ds_read_b64_tr_b16 a[160:161], v5 offset:32768
    ds_read_b64_tr_b16 a[162:163], v5 offset:33792
    ds_read_b64_tr_b16 a[164:165], v5 offset:36864
    ds_read_b64_tr_b16 a[166:167], v5 offset:37888
    ds_read_b64_tr_b16 a[168:169], v5 offset:40960
    ds_read_b64_tr_b16 a[170:171], v5 offset:41984
    ds_read_b64_tr_b16 a[172:173], v5 offset:45056
    ds_read_b64_tr_b16 a[174:175], v5 offset:46080
    ds_read_b64_tr_b16 a[176:177], v5 offset:49152
    ds_read_b64_tr_b16 a[178:179], v5 offset:50176
    ds_read_b64_tr_b16 a[180:181], v5 offset:53248
    ds_read_b64_tr_b16 a[182:183], v5 offset:54272
    ds_read_b64_tr_b16 a[184:185], v5 offset:57344
    ds_read_b64_tr_b16 a[186:187], v5 offset:58368
    ds_read_b64_tr_b16 a[188:189], v5 offset:61440
    ds_read_b64_tr_b16 a[190:191], v5 offset:62464
    ds_read_b64_tr_b16 a[192:193], v6 offset:0
    ds_read_b64_tr_b16 a[194:195], v6 offset:1024
    ds_read_b64_tr_b16 a[196:197], v6 offset:4096
    ds_read_b64_tr_b16 a[198:199], v6 offset:5120
    ds_read_b64_tr_b16 a[200:201], v6 offset:8192
    ds_read_b64_tr_b16 a[202:203], v6 offset:9216
    ds_read_b64_tr_b16 a[204:205], v6 offset:12288
    ds_read_b64_tr_b16 a[206:207], v6 offset:13312
    ds_read_b64_tr_b16 a[208:209], v6 offset:16384
    ds_read_b64_tr_b16 a[210:211], v6 offset:17408
    ds_read_b64_tr_b16 a[212:213], v6 offset:20480
    ds_read_b64_tr_b16 a[214:215], v6 offset:21504
    ds_read_b64_tr_b16 a[216:217], v6 offset:24576
    ds_read_b64_tr_b16 a[218:219], v6 offset:25600
    ds_read_b64_tr_b16 a[220:221], v6 offset:28672
    ds_read_b64_tr_b16 a[222:223], v6 offset:29696
    ds_read_b64_tr_b16 a[224:225], v6 offset:32768
    ds_read_b64_tr_b16 a[226:227], v6 offset:33792
    ds_read_b64_tr_b16 a[228:229], v6 offset:36864
    ds_read_b64_tr_b16 a[230:231], v6 offset:37888
    ds_read_b64_tr_b16 a[232:233], v6 offset:40960
    ds_read_b64_tr_b16 a[234:235], v6 offset:41984
    ds_read_b64_tr_b16 a[236:237], v6 offset:45056
    ds_read_b64_tr_b16 a[238:239], v6 offset:46080
    ds_read_b64_tr_b16 a[240:241], v6 offset:49152
    ds_read_b64_tr_b16 a[242:243], v6 offset:50176
    ds_read_b64_tr_b16 a[244:245], v6 offset:53248
    ds_read_b64_tr_b16 a[246:247], v6 offset:54272
    ds_read_b64_tr_b16 a[248:249], v6 offset:57344
    ds_read_b64_tr_b16 a[250:251], v6 offset:58368
    ds_read_b64_tr_b16 a[252:253], v6 offset:61440
    ds_read_b64_tr_b16 a[254:255], v6 offset:62464
    s_waitcnt lgkmcnt(0)
    s_barrier
    v_and_b32 v8, 1, v2
    v_lshrrev_b32 v9, 1, v2
    v_lshlrev_b32 v10, 8, v9
    v_lshl_add_u32 v10, v3, 4, v10
    s_lshl_b32 s8, s4, 10
    v_lshl_add_u32 v11, v8, 12, v10
    v_add_u32 v11, s8, v11
    s_lshl_b32 s8, s4, 11
    v_lshl_add_u32 v12, v8, 10, v10
    v_add_u32 v12, s8, v12
    s_lshl_b32 s10, s4, 13
    s_lshl_b32 s9, s3, 14
    s_add_u32 s9, s9, 50331648
    s_add_u32 s8, s9, 8192
    s_cmp_lg_u32 s4, 0
    s_cbranch_scc1 WDW_89
DW_90:
    buffer_load_dword v13, off, s[60:63], 0 offset:132 sc1
    s_add_u32 s79, s79, 1
    s_cmp_gt_u32 s79, 2097152
    s_cbranch_scc1 mega_kernel_exit
    s_waitcnt vmcnt(0)
    v_cmp_gt_u32 vcc, 64, v13
    s_nop 0
    s_cbranch_vccz DWok_91
    s_sleep 10
    s_branch DW_90
DWok_91:
WDW_89:
    s_barrier
    s_lshl_b32 s69, s3, 7
    s_add_u32 s69, s69, 4096
    s_mov_b32 s14, 0
    s_mov_b32 s15, 0
    s_min_u32 s12, s14, 63
    s_lshl_b32 s12, s12, 15
    s_add_u32 s12, s12, s10
    s_add_u32 s12, s12, 1048576
    s_lshl_b32 s13, s15, 15
    s_add_u32 s13, s13, s10
    s_mov_b32 m0, s13
    s_add_u32 s13, s13, 4096
    buffer_load_dwordx4 v7, s[52:55], s12 offen offset:0 sc1 lds
    buffer_load_dwordx4 v7, s[52:55], s12 offen offset:1024 sc1 lds
    buffer_load_dwordx4 v7, s[52:55], s12 offen offset:2048 sc1 lds
    buffer_load_dwordx4 v7, s[52:55], s12 offen offset:3072 sc1 lds
    s_mov_b32 m0, s13
    s_add_u32 s13, s13, 4096
    s_add_u32 s12, s12, 4096
    buffer_load_dwordx4 v7, s[52:55], s12 offen offset:0 sc1 lds
    buffer_load_dwordx4 v7, s[52:55], s12 offen offset:1024 sc1 lds
    buffer_load_dwordx4 v7, s[52:55], s12 offen offset:2048 sc1 lds
    buffer_load_dwordx4 v7, s[52:55], s12 offen offset:3072 sc1 lds
    s_cmp_lt_u32 s14, 0
    s_cselect_b32 s12, 2, 1
    s_add_u32 s14, s14, s12
    s_add_u32 s15, s15, 1
    s_and_b32 s15, s15, 3
    s_min_u32 s12, s14, 63
    s_lshl_b32 s12, s12, 15
    s_add_u32 s12, s12, s10
    s_add_u32 s12, s12, 1048576
    s_lshl_b32 s13, s15, 15
    s_add_u32 s13, s13, s10
    s_mov_b32 m0, s13
    s_add_u32 s13, s13, 4096
    buffer_load_dwordx4 v7, s[52:55], s12 offen offset:0 sc1 lds
    buffer_load_dwordx4 v7, s[52:55], s12 offen offset:1024 sc1 lds
    buffer_load_dwordx4 v7, s[52:55], s12 offen offset:2048 sc1 lds
    buffer_load_dwordx4 v7, s[52:55], s12 offen offset:3072 sc1 lds
    s_mov_b32 m0, s13
    s_add_u32 s13, s13, 4096
    s_add_u32 s12, s12, 4096
    buffer_load_dwordx4 v7, s[52:55], s12 offen offset:0 sc1 lds
    buffer_load_dwordx4 v7, s[52:55], s12 offen offset:1024 sc1 lds
    buffer_load_dwordx4 v7, s[52:55], s12 offen offset:2048 sc1 lds
    buffer_load_dwordx4 v7, s[52:55], s12 offen offset:3072 sc1 lds
    s_cmp_lt_u32 s14, 0
    s_cselect_b32 s12, 2, 1
    s_add_u32 s14, s14, s12
    s_add_u32 s15, s15, 1
    s_and_b32 s15, s15, 3
    s_min_u32 s12, s14, 63
    s_lshl_b32 s12, s12, 15
    s_add_u32 s12, s12, s10
    s_add_u32 s12, s12, 1048576
    s_lshl_b32 s13, s15, 15
    s_add_u32 s13, s13, s10
    s_mov_b32 m0, s13
    s_add_u32 s13, s13, 4096
    buffer_load_dwordx4 v7, s[52:55], s12 offen offset:0 sc1 lds
    buffer_load_dwordx4 v7, s[52:55], s12 offen offset:1024 sc1 lds
    buffer_load_dwordx4 v7, s[52:55], s12 offen offset:2048 sc1 lds
    buffer_load_dwordx4 v7, s[52:55], s12 offen offset:3072 sc1 lds
    s_mov_b32 m0, s13
    s_add_u32 s13, s13, 4096
    s_add_u32 s12, s12, 4096
    buffer_load_dwordx4 v7, s[52:55], s12 offen offset:0 sc1 lds
    buffer_load_dwordx4 v7, s[52:55], s12 offen offset:1024 sc1 lds
    buffer_load_dwordx4 v7, s[52:55], s12 offen offset:2048 sc1 lds
    buffer_load_dwordx4 v7, s[52:55], s12 offen offset:3072 sc1 lds
    s_cmp_lt_u32 s14, 0
    s_cselect_b32 s12, 2, 1
    s_add_u32 s14, s14, s12
    s_add_u32 s15, s15, 1
    s_and_b32 s15, s15, 3
    s_mov_b32 s66, 0
    s_mov_b32 s65, 0
    s_mov_b32 s67, 0
P2_loop_92:
    s_waitcnt vmcnt(12)
    s_barrier
    s_cmp_lg_u32 s4, 0
    s_cbranch_scc1 FS_93
    s_mov_b64 exec, 1
    v_mov_b32 v13, s65
    buffer_store_dword v13, off, s[52:55], s69 sc1
    s_mov_b64 exec, -1
FS_93:
    s_min_u32 s12, s14, 63
    s_lshl_b32 s12, s12, 15
    s_add_u32 s12, s12, s10
    s_add_u32 s12, s12, 1048576
    s_lshl_b32 s13, s15, 15
    s_add_u32 s13, s13, s10
    s_mov_b32 m0, s13
    s_add_u32 s13, s13, 4096
    buffer_load_dwordx4 v7, s[52:55], s12 offen offset:0 sc1 lds
    buffer_load_dwordx4 v7, s[52:55], s12 offen offset:1024 sc1 lds
    buffer_load_dwordx4 v7, s[52:55], s12 offen offset:2048 sc1 lds
    buffer_load_dwordx4 v7, s[52:55], s12 offen offset:3072 sc1 lds
    s_mov_b32 m0, s13
    s_add_u32 s13, s13, 4096
    s_add_u32 s12, s12, 4096
    buffer_load_dwordx4 v7, s[52:55], s12 offen offset:0 sc1 lds
    buffer_load_dwordx4 v7, s[52:55], s12 offen offset:1024 sc1 lds
    buffer_load_dwordx4 v7, s[52:55], s12 offen offset:2048 sc1 lds
    buffer_load_dwordx4 v7, s[52:55], s12 offen offset:3072 sc1 lds
    s_cmp_lt_u32 s14, 0
    s_cselect_b32 s12, 2, 1
    s_add_u32 s14, s14, s12
    s_add_u32 s15, s15, 1
    s_and_b32 s15, s15, 3
    s_lshl_b32 s12, s67, 15
    v_add_u32 v13, s12, v7
    ds_read_b128 v[32:35], v13 offset:0
    ds_read_b128 v[36:39], v13 offset:1024
    ds_read_b128 v[40:43], v13 offset:2048
    ds_read_b128 v[44:47], v13 offset:3072
    ds_read_b128 v[48:51], v13 offset:4096
    ds_read_b128 v[52:55], v13 offset:5120
    ds_read_b128 v[56:59], v13 offset:6144
    ds_read_b128 v[60:63], v13 offset:7168
    s_waitcnt lgkmcnt(7)
    v_mfma_f32_32x32x16_bf16 v[16:31], a[0:3], v[32:35], 0
    v_mfma_f32_32x32x16_bf16 v[96:111], a[128:131], v[32:35], 0
    ds_read_b128 v[32:35], v13 offset:8192
    s_waitcnt lgkmcnt(7)
    v_mfma_f32_32x32x16_bf16 v[16:31], a[4:7], v[36:39], v[16:31]
    v_mfma_f32_32x32x16_bf16 v[96:111], a[132:135], v[36:39], v[96:111]
    ds_read_b128 v[36:39], v13 offset:9216
    s_waitcnt lgkmcnt(7)
    v_mfma_f32_32x32x16_bf16 v[16:31], a[8:11], v[40:43], v[16:31]
    v_mfma_f32_32x32x16_bf16 v[96:111], a[136:139], v[40:43], v[96:111]
    ds_read_b128 v[40:43], v13 offset:10240
    s_waitcnt lgkmcnt(7)
    v_mfma_f32_32x32x16_bf16 v[16:31], a[12:15], v[44:47], v[16:31]
    v_mfma_f32_32x32x16_bf16 v[96:111], a[140:143], v[44:47], v[96:111]
    ds_read_b128 v[44:47], v13 offset:11264
    s_waitcnt lgkmcnt(7)
    v_mfma_f32_32x32x16_bf16 v[16:31], a[16:19], v[48:51], v[16:31]
    v_mfma_f32_32x32x16_bf16 v[96:111], a[144:147], v[48:51], v[96:111]
    ds_read_b128 v[48:51], v13 offset:12288
    s_waitcnt lgkmcnt(7)
    v_mfma_f32_32x32x16_bf16 v[16:31], a[20:23], v[52:55], v[16:31]
    v_mfma_f32_32x32x16_bf16 v[96:111], a[148:151], v[52:55], v[96:111]
    ds_read_b128 v[52:55], v13 offset:13312
    s_waitcnt lgkmcnt(7)
    v_mfma_f32_32x32x16_bf16 v[16:31], a[24:27], v[56:59], v[16:31]
    v_mfma_f32_32x32x16_bf16 v[96:111], a[152:155], v[56:59], v[96:111]
    ds_read_b128 v[56:59], v13 offset:14336
    s_waitcnt lgkmcnt(7)
    v_mfma_f32_32x32x16_bf16 v[16:31], a[28:31], v[60:63], v[16:31]
    v_mfma_f32_32x32x16_bf16 v[96:111], a[156:159], v[60:63], v[96:111]
    ds_read_b128 v[60:63], v13 offset:15360
    s_waitcnt lgkmcnt(7)
    v_mfma_f32_32x32x16_bf16 v[16:31], a[32:35], v[32:35], v[16:31]
    v_mfma_f32_32x32x16_bf16 v[96:111], a[160:163], v[32:35], v[96:111]
    ds_read_b128 v[32:35], v13 offset:16384
    s_waitcnt lgkmcnt(7)
    v_mfma_f32_32x32x16_bf16 v[16:31], a[36:39], v[36:39], v[16:31]
    v_mfma_f32_32x32x16_bf16 v[96:111], a[164:167], v[36:39], v[96:111]
    ds_read_b128 v[36:39], v13 offset:17408
    s_waitcnt lgkmcnt(7)
    v_mfma_f32_32x32x16_bf16 v[16:31], a[40:43], v[40:43], v[16:31]
    v_mfma_f32_32x32x16_bf16 v[96:111], a[168:171], v[40:43], v[96:111]
    ds_read_b128 v[40:43], v13 offset:18432
    s_waitcnt lgkmcnt(7)
    v_mfma_f32_32x32x16_bf16 v[16:31], a[44:47], v[44:47], v[16:31]
    v_mfma_f32_32x32x16_bf16 v[96:111], a[172:175], v[44:47], v[96:111]
    ds_read_b128 v[44:47], v13 offset:19456
    s_waitcnt lgkmcnt(7)
    v_mfma_f32_32x32x16_bf16 v[16:31], a[48:51], v[48:51], v[16:31]
    v_mfma_f32_32x32x16_bf16 v[96:111], a[176:179], v[48:51], v[96:111]
    ds_read_b128 v[48:51], v13 offset:20480
    s_waitcnt lgkmcnt(7)
    v_mfma_f32_32x32x16_bf16 v[16:31], a[52:55], v[52:55], v[16:31]
    v_mfma_f32_32x32x16_bf16 v[96:111], a[180:183], v[52:55], v[96:111]
    ds_read_b128 v[52:55], v13 offset:21504
    s_waitcnt lgkmcnt(7)
    v_mfma_f32_32x32x16_bf16 v[16:31], a[56:59], v[56:59], v[16:31]
    v_mfma_f32_32x32x16_bf16 v[96:111], a[184:187], v[56:59], v[96:111]
    ds_read_b128 v[56:59], v13 offset:22528
    s_waitcnt lgkmcnt(7)
    v_mfma_f32_32x32x16_bf16 v[16:31], a[60:63], v[60:63], v[16:31]
    v_mfma_f32_32x32x16_bf16 v[96:111], a[188:191], v[60:63], v[96:111]
    ds_read_b128 v[60:63], v13 offset:23552
    s_waitcnt lgkmcnt(7)
    v_mfma_f32_32x32x16_bf16 v[16:31], a[64:67], v[32:35], v[16:31]
    v_mfma_f32_32x32x16_bf16 v[96:111], a[192:195], v[32:35], v[96:111]
    ds_read_b128 v[32:35], v13 offset:24576
    s_waitcnt lgkmcnt(7)
    v_mfma_f32_32x32x16_bf16 v[16:31], a[68:71], v[36:39], v[16:31]
    v_mfma_f32_32x32x16_bf16 v[96:111], a[196:199], v[36:39], v[96:111]
    ds_read_b128 v[36:39], v13 offset:25600
    s_waitcnt lgkmcnt(7)
    v_mfma_f32_32x32x16_bf16 v[16:31], a[72:75], v[40:43], v[16:31]
    v_mfma_f32_32x32x16_bf16 v[96:111], a[200:203], v[40:43], v[96:111]
    ds_read_b128 v[40:43], v13 offset:26624
    s_waitcnt lgkmcnt(7)
    v_mfma_f32_32x32x16_bf16 v[16:31], a[76:79], v[44:47], v[16:31]
    v_mfma_f32_32x32x16_bf16 v[96:111], a[204:207], v[44:47], v[96:111]
    ds_read_b128 v[44:47], v13 offset:27648
    s_waitcnt lgkmcnt(7)
    v_mfma_f32_32x32x16_bf16 v[16:31], a[80:83], v[48:51], v[16:31]
    v_mfma_f32_32x32x16_bf16 v[96:111], a[208:211], v[48:51], v[96:111]
    ds_read_b128 v[48:51], v13 offset:28672
    s_waitcnt lgkmcnt(7)
    v_mfma_f32_32x32x16_bf16 v[16:31], a[84:87], v[52:55], v[16:31]
    v_mfma_f32_32x32x16_bf16 v[96:111], a[212:215], v[52:55], v[96:111]
    ds_read_b128 v[52:55], v13 offset:29696
    s_waitcnt lgkmcnt(7)
    v_mfma_f32_32x32x16_bf16 v[16:31], a[88:91], v[56:59], v[16:31]
    v_mfma_f32_32x32x16_bf16 v[96:111], a[216:219], v[56:59], v[96:111]
    ds_read_b128 v[56:59], v13 offset:30720
    s_waitcnt lgkmcnt(7)
    v_mfma_f32_32x32x16_bf16 v[16:31], a[92:95], v[60:63], v[16:31]
    v_mfma_f32_32x32x16_bf16 v[96:111], a[220:223], v[60:63], v[96:111]
    ds_read_b128 v[60:63], v13 offset:31744
    s_waitcnt lgkmcnt(7)
    v_mfma_f32_32x32x16_bf16 v[16:31], a[96:99], v[32:35], v[16:31]
    v_mfma_f32_32x32x16_bf16 v[96:111], a[224:227], v[32:35], v[96:111]
    s_waitcnt lgkmcnt(6)
    v_mfma_f32_32x32x16_bf16 v[16:31], a[100:103], v[36:39], v[16:31]
    v_mfma_f32_32x32x16_bf16 v[96:111], a[228:231], v[36:39], v[96:111]
    s_waitcnt lgkmcnt(5)
    v_mfma_f32_32x32x16_bf16 v[16:31], a[104:107], v[40:43], v[16:31]
    v_mfma_f32_32x32x16_bf16 v[96:111], a[232:235], v[40:43], v[96:111]
    s_waitcnt lgkmcnt(4)
    v_mfma_f32_32x32x16_bf16 v[16:31], a[108:111], v[44:47], v[16:31]
    v_mfma_f32_32x32x16_bf16 v[96:111], a[236:239], v[44:47], v[96:111]
    s_waitcnt lgkmcnt(3)
    v_mfma_f32_32x32x16_bf16 v[16:31], a[112:115], v[48:51], v[16:31]
    v_mfma_f32_32x32x16_bf16 v[96:111], a[240:243], v[48:51], v[96:111]
    s_waitcnt lgkmcnt(2)
    v_mfma_f32_32x32x16_bf16 v[16:31], a[116:119], v[52:55], v[16:31]
    v_mfma_f32_32x32x16_bf16 v[96:111], a[244:247], v[52:55], v[96:111]
    s_waitcnt lgkmcnt(1)
    v_mfma_f32_32x32x16_bf16 v[16:31], a[120:123], v[56:59], v[16:31]
    v_mfma_f32_32x32x16_bf16 v[96:111], a[248:251], v[56:59], v[96:111]
    s_waitcnt lgkmcnt(0)
    v_mfma_f32_32x32x16_bf16 v[16:31], a[124:127], v[60:63], v[16:31]
    v_mfma_f32_32x32x16_bf16 v[96:111], a[252:255], v[60:63], v[96:111]
    s_lshl_b32 s12, s66, 18
    s_add_u32 s13, s12, s8
    s_add_u32 s12, s12, s9
    s_nop 7
    v_cvt_pk_bf16_f32 v64, v16, v17
    v_cvt_pk_bf16_f32 v65, v18, v19
    v_cvt_pk_bf16_f32 v66, v20, v21
    v_cvt_pk_bf16_f32 v67, v22, v23
    buffer_store_dwordx4 v[64:67], v11, s[52:55], s12 offen offset:0 sc1
    v_cvt_pk_bf16_f32 v68, v24, v25
    v_cvt_pk_bf16_f32 v69, v26, v27
    v_cvt_pk_bf16_f32 v70, v28, v29
    v_cvt_pk_bf16_f32 v71, v30, v31
    buffer_store_dwordx4 v[68:71], v11, s[52:55], s12 offen offset:512 sc1
    v_cvt_pk_bf16_f32 v72, v96, v97
    v_cvt_pk_bf16_f32 v73, v98, v99
    v_cvt_pk_bf16_f32 v74, v100, v101
    v_cvt_pk_bf16_f32 v75, v102, v103
    buffer_store_dwordx4 v[72:75], v11, s[52:55], s13 offen offset:0 sc1
    v_cvt_pk_bf16_f32 v76, v104, v105
    v_cvt_pk_bf16_f32 v77, v106, v107
    v_cvt_pk_bf16_f32 v78, v108, v109
    v_cvt_pk_bf16_f32 v79, v110, v111
    buffer_store_dwordx4 v[76:79], v11, s[52:55], s13 offen offset:512 sc1
    s_mov_b32 s65, s66
    s_cmp_lt_u32 s66, 0
    s_cselect_b32 s12, 2, 1
    s_add_u32 s66, s66, s12
    s_add_u32 s67, s67, 1
    s_and_b32 s67, s67, 3
    s_cmp_lt_u32 s66, 64
    s_cbranch_scc1 P2_loop_92
    s_waitcnt vmcnt(0)
    s_barrier
    s_mov_b32 s66, 64
    s_cmp_lg_u32 s4, 0
    s_cbranch_scc1 FS_94
    s_mov_b64 exec, 1
    v_mov_b32 v13, s66
    buffer_store_dword v13, off, s[52:55], s69 sc1
    s_mov_b64 exec, -1
FS_94:
W_late_68:
    s_barrier
    s_cmp_lg_u32 s4, 0
    s_cbranch_scc1 GTsk_97
    s_mov_b64 exec, 1
    s_getreg_b32 s6, hwreg(HW_REG_XCC_ID, 0, 3)
GT_95:
    s_lshl_b32 s7, s6, 2
    v_mov_b32 v1, 1
    buffer_atomic_add v1, off, s[60:63], s7 offset:32 sc0
    s_waitcnt vmcnt(0)
    v_readfirstlane_b32 s8, v1
    s_nop 0
    s_cmp_lt_u32 s8, 16
    s_cbranch_scc1 GTok_96
    s_add_u32 s6, s6, 7
    s_and_b32 s6, s6, 7
    s_branch GT_95
GTok_96:
    s_lshl_b32 s8, s8, 3
    s_add_u32 s8, s8, s6
    v_mov_b32 v1, s8
    v_mov_b32 v2, 0
    ds_write_b32 v2, v1
    s_waitcnt lgkmcnt(0)
    s_mov_b64 exec, -1
GTsk_97:
    s_barrier
    v_mov_b32 v2, 0
    ds_read_b32 v1, v2
    s_waitcnt lgkmcnt(0)
    v_readfirstlane_b32 s101, v1
    s_barrier
    s_branch W_pre_70
W_a_65:
    s_sub_u32 s3, s100, 80
    s_mov_b32 s56, s16
    s_and_b32 s57, s17, 0xffff
    s_mov_b32 s58, 0x200000
    s_mov_b32 s59, 0x00020000
    v_lshrrev_b32 v1, 6, v0
    s_nop 0
    v_readfirstlane_b32 s4, v1
    s_nop 3
    v_and_b32 v1, 63, v0
    v_and_b32 v2, 31, v1
    v_lshrrev_b32 v3, 5, v1
    v_lshlrev_b32 v4, 10, v2
    v_lshl_add_u32 v4, v3, 4, v4
    s_lshl_b32 s5, s3, 15
    s_lshl_b32 s6, s4, 8
    s_add_u32 s5, s5, s6
    buffer_load_dwordx4 v[64:67], v4, s[56:59], s5 offen offset:0
    buffer_load_dwordx4 v[68:71], v4, s[56:59], s5 offen offset:32
    buffer_load_dwordx4 v[72:75], v4, s[56:59], s5 offen offset:64
    buffer_load_dwordx4 v[76:79], v4, s[56:59], s5 offen offset:96
    buffer_load_dwordx4 v[80:83], v4, s[56:59], s5 offen offset:128
    buffer_load_dwordx4 v[84:87], v4, s[56:59], s5 offen offset:160
    buffer_load_dwordx4 v[88:91], v4, s[56:59], s5 offen offset:192
    buffer_load_dwordx4 v[92:95], v4, s[56:59], s5 offen offset:224
    s_cmp_lg_u32 s4, 0
    s_cbranch_scc1 WDW_98
DW_99:
    buffer_load_dword v6, off, s[60:63], 0 offset:128 sc1
    s_add_u32 s79, s79, 1
    s_cmp_gt_u32 s79, 2097152
    s_cbranch_scc1 mega_kernel_exit
    s_waitcnt vmcnt(0)
    v_cmp_gt_u32 vcc, 0xc0, v6
    s_nop 0
    s_cbranch_vccz DWok_100
    s_sleep 3
    s_branch DW_99
DWok_100:
WDW_98:
    s_barrier
    s_mov_b32 s7, 5
    v_lshlrev_b32 v5, 4, v0
    s_mov_b32 s9, 65536
    buffer_load_dwordx4 v[16:19], v5, s[52:55], s9 offen sc1
    s_mov_b32 s9, 77824
    buffer_load_dwordx4 v[20:23], v5, s[52:55], s9 offen sc1
    s_mov_b32 s9, 90112
    buffer_load_dwordx4 v[24:27], v5, s[52:55], s9 offen sc1
    s_mov_b32 s9, 102400
    buffer_load_dwordx4 v[28:31], v5, s[52:55], s9 offen sc1
    s_mov_b32 s9, 114688
    buffer_load_dwordx4 v[32:35], v5, s[52:55], s9 offen sc1
    s_mov_b32 s9, 126976
    buffer_load_dwordx4 v[36:39], v5, s[52:55], s9 offen sc1
    s_mov_b32 s9, 139264
    buffer_load_dwordx4 v[40:43], v5, s[52:55], s9 offen sc1
    s_mov_b32 s9, 151552
    buffer_load_dwordx4 v[44:47], v5, s[52:55], s9 offen sc1
    s_waitcnt vmcnt(0)
    v_add_f32 v8, v16, v20
    v_add_f32 v8, v8, v24
    v_add_f32 v8, v8, v28
    v_add_f32 v8, v8, v32
    v_add_f32 v8, v8, v36
    v_add_f32 v8, v8, v40
    v_add_f32 v8, v8, v44
    v_add_f32 v9, v17, v21
    v_add_f32 v9, v9, v25
    v_add_f32 v9, v9, v29
    v_add_f32 v9, v9, v33
    v_add_f32 v9, v9, v37
    v_add_f32 v9, v9, v41
    v_add_f32 v9, v9, v45
    v_add_f32 v10, v18, v22
    v_add_f32 v10, v10, v26
    v_add_f32 v10, v10, v30
    v_add_f32 v10, v10, v34
    v_add_f32 v10, v10, v38
    v_add_f32 v10, v10, v42
    v_add_f32 v10, v10, v46
    v_add_f32 v11, v19, v23
    v_add_f32 v11, v11, v27
    v_add_f32 v11, v11, v31
    v_add_f32 v11, v11, v35
    v_add_f32 v11, v11, v39
    v_add_f32 v11, v11, v43
    v_add_f32 v11, v11, v47
    v_cvt_pk_bf16_f32 v8, v8, v8
    v_lshlrev_b32 v8, 16, v8
    v_cvt_pk_bf16_f32 v9, v9, v9
    v_lshlrev_b32 v9, 16, v9
    v_cvt_pk_bf16_f32 v10, v10, v10
    v_lshlrev_b32 v10, 16, v10
    v_cvt_pk_bf16_f32 v11, v11, v11
    v_lshlrev_b32 v11, 16, v11
    s_cmp_lt_u32 s4, 2
    s_cbranch_scc1 L1_noadd_101
    v_add_f32 v8, 1.0, v8
    v_cvt_pk_bf16_f32 v8, v8, v8
    v_lshlrev_b32 v8, 16, v8
    v_add_f32 v9, 1.0, v9
    v_cvt_pk_bf16_f32 v9, v9, v9
    v_lshlrev_b32 v9, 16, v9
    v_add_f32 v10, 1.0, v10
    v_cvt_pk_bf16_f32 v10, v10, v10
    v_lshlrev_b32 v10, 16, v10
    v_add_f32 v11, 1.0, v11
    v_cvt_pk_bf16_f32 v11, v11, v11
    v_lshlrev_b32 v11, 16, v11
L1_noadd_101:
    ds_write_b128 v5, v[8:11]
    s_cmp_eq_u32 s3, s3
    s_cbranch_scc1 L1_nomodf_102
    s_mov_b32 s10, 196608
    buffer_store_dwordx4 v[8:11], v5, s[52:55], s10 offen sc1
    s_mov_b32 s9, 69632
    buffer_load_dwordx4 v[16:19], v5, s[52:55], s9 offen sc1
    s_mov_b32 s9, 81920
    buffer_load_dwordx4 v[20:23], v5, s[52:55], s9 offen sc1
    s_mov_b32 s9, 94208
    buffer_load_dwordx4 v[24:27], v5, s[52:55], s9 offen sc1
    s_mov_b32 s9, 106496
    buffer_load_dwordx4 v[28:31], v5, s[52:55], s9 offen sc1
    s_mov_b32 s9, 118784
    buffer_load_dwordx4 v[32:35], v5, s[52:55], s9 offen sc1
    s_mov_b32 s9, 131072
    buffer_load_dwordx4 v[36:39], v5, s[52:55], s9 offen sc1
    s_mov_b32 s9, 143360
    buffer_load_dwordx4 v[40:43], v5, s[52:55], s9 offen sc1
    s_mov_b32 s9, 155648
    buffer_load_dwordx4 v[44:47], v5, s[52:55], s9 offen sc1
    s_waitcnt vmcnt(0)
    v_add_f32 v12, v16, v20
    v_add_f32 v12, v12, v24
    v_add_f32 v12, v12, v28
    v_add_f32 v12, v12, v32
    v_add_f32 v12, v12, v36
    v_add_f32 v12, v12, v40
    v_add_f32 v12, v12, v44
    v_add_f32 v13, v17, v21
    v_add_f32 v13, v13, v25
    v_add_f32 v13, v13, v29
    v_add_f32 v13, v13, v33
    v_add_f32 v13, v13, v37
    v_add_f32 v13, v13, v41
    v_add_f32 v13, v13, v45
    v_add_f32 v14, v18, v22
    v_add_f32 v14, v14, v26
    v_add_f32 v14, v14, v30
    v_add_f32 v14, v14, v34
    v_add_f32 v14, v14, v38
    v_add_f32 v14, v14, v42
    v_add_f32 v14, v14, v46
    v_add_f32 v15, v19, v23
    v_add_f32 v15, v15, v27
    v_add_f32 v15, v15, v31
    v_add_f32 v15, v15, v35
    v_add_f32 v15, v15, v39
    v_add_f32 v15, v15, v43
    v_add_f32 v15, v15, v47
    v_cvt_pk_bf16_f32 v12, v12, v12
    v_lshlrev_b32 v12, 16, v12
    v_cvt_pk_bf16_f32 v13, v13, v13
    v_lshlrev_b32 v13, 16, v13
    v_cvt_pk_bf16_f32 v14, v14, v14
    v_lshlrev_b32 v14, 16, v14
    v_cvt_pk_bf16_f32 v15, v15, v15
    v_lshlrev_b32 v15, 16, v15
    s_mov_b32 s10, 200704
    buffer_store_dwordx4 v[12:15], v5, s[52:55], s10 offen sc1
    s_mov_b32 s9, 73728
    buffer_load_dwordx4 v[16:19], v5, s[52:55], s9 offen sc1
    s_mov_b32 s9, 86016
    buffer_load_dwordx4 v[20:23], v5, s[52:55], s9 offen sc1
    s_mov_b32 s9, 98304
    buffer_load_dwordx4 v[24:27], v5, s[52:55], s9 offen sc1
    s_mov_b32 s9, 110592
    buffer_load_dwordx4 v[28:31], v5, s[52:55], s9 offen sc1
    s_mov_b32 s9, 122880
    buffer_load_dwordx4 v[32:35], v5, s[52:55], s9 offen sc1
    s_mov_b32 s9, 135168
    buffer_load_dwordx4 v[36:39], v5, s[52:55], s9 offen sc1
    s_mov_b32 s9, 147456
    buffer_load_dwordx4 v[40:43], v5, s[52:55], s9 offen sc1
    s_mov_b32 s9, 159744
    buffer_load_dwordx4 v[44:47], v5, s[52:55], s9 offen sc1
    s_waitcnt vmcnt(0)
    v_add_f32 v48, v16, v20
    v_add_f32 v48, v48, v24
    v_add_f32 v48, v48, v28
    v_add_f32 v48, v48, v32
    v_add_f32 v48, v48, v36
    v_add_f32 v48, v48, v40
    v_add_f32 v48, v48, v44
    v_add_f32 v49, v17, v21
    v_add_f32 v49, v49, v25
    v_add_f32 v49, v49, v29
    v_add_f32 v49, v49, v33
    v_add_f32 v49, v49, v37
    v_add_f32 v49, v49, v41
    v_add_f32 v49, v49, v45
    v_add_f32 v50, v18, v22
    v_add_f32 v50, v50, v26
    v_add_f32 v50, v50, v30
    v_add_f32 v50, v50, v34
    v_add_f32 v50, v50, v38
    v_add_f32 v50, v50, v42
    v_add_f32 v50, v50, v46
    v_add_f32 v51, v19, v23
    v_add_f32 v51, v51, v27
    v_add_f32 v51, v51, v31
    v_add_f32 v51, v51, v35
    v_add_f32 v51, v51, v39
    v_add_f32 v51, v51, v43
    v_add_f32 v51, v51, v47
    v_cvt_pk_bf16_f32 v48, v48, v48
    v_lshlrev_b32 v48, 16, v48
    v_cvt_pk_bf16_f32 v49, v49, v49
    v_lshlrev_b32 v49, 16, v49
    v_cvt_pk_bf16_f32 v50, v50, v50
    v_lshlrev_b32 v50, 16, v50
    v_cvt_pk_bf16_f32 v51, v51, v51
    v_lshlrev_b32 v51, 16, v51
    s_cmp_ge_u32 s4, 2
    s_cbranch_scc1 L1_noadd2_103
    v_add_f32 v48, 1.0, v48
    v_cvt_pk_bf16_f32 v48, v48, v48
    v_lshlrev_b32 v48, 16, v48
    v_add_f32 v49, 1.0, v49
    v_cvt_pk_bf16_f32 v49, v49, v49
    v_lshlrev_b32 v49, 16, v49
    v_add_f32 v50, 1.0, v50
    v_cvt_pk_bf16_f32 v50, v50, v50
    v_lshlrev_b32 v50, 16, v50
    v_add_f32 v51, 1.0, v51
    v_cvt_pk_bf16_f32 v51, v51, v51
    v_lshlrev_b32 v51, 16, v51
L1_noadd2_103:
    s_mov_b32 s10, 204800
    buffer_store_dwordx4 v[48:51], v5, s[52:55], s10 offen sc1
L1_nomodf_102:
    s_waitcnt vmcnt(0)
    v_lshlrev_b32 v128, 16, v64
    v_and_b32 v129, 0xffff0000, v64
    v_lshlrev_b32 v130, 16, v65
    v_and_b32 v131, 0xffff0000, v65
    v_lshlrev_b32 v132, 16, v66
    v_and_b32 v133, 0xffff0000, v66
    v_lshlrev_b32 v134, 16, v67
    v_and_b32 v135, 0xffff0000, v67
    v_lshlrev_b32 v136, 16, v68
    v_and_b32 v137, 0xffff0000, v68
    v_lshlrev_b32 v138, 16, v69
    v_and_b32 v139, 0xffff0000, v69
    v_lshlrev_b32 v140, 16, v70
    v_and_b32 v141, 0xffff0000, v70
    v_lshlrev_b32 v142, 16, v71
    v_and_b32 v143, 0xffff0000, v71
    v_lshlrev_b32 v144, 16, v72
    v_and_b32 v145, 0xffff0000, v72
    v_lshlrev_b32 v146, 16, v73
    v_and_b32 v147, 0xffff0000, v73
    v_lshlrev_b32 v148, 16, v74
    v_and_b32 v149, 0xffff0000, v74
    v_lshlrev_b32 v150, 16, v75
    v_and_b32 v151, 0xffff0000, v75
    v_lshlrev_b32 v152, 16, v76
    v_and_b32 v153, 0xffff0000, v76
    v_lshlrev_b32 v154, 16, v77
    v_and_b32 v155, 0xffff0000, v77
    v_lshlrev_b32 v156, 16, v78
    v_and_b32 v157, 0xffff0000, v78
    v_lshlrev_b32 v158, 16, v79
    v_and_b32 v159, 0xffff0000, v79
    v_lshlrev_b32 v160, 16, v80
    v_and_b32 v161, 0xffff0000, v80
    v_lshlrev_b32 v162, 16, v81
    v_and_b32 v163, 0xffff0000, v81
    v_lshlrev_b32 v164, 16, v82
    v_and_b32 v165, 0xffff0000, v82
    v_lshlrev_b32 v166, 16, v83
    v_and_b32 v167, 0xffff0000, v83
    v_lshlrev_b32 v168, 16, v84
    v_and_b32 v169, 0xffff0000, v84
    v_lshlrev_b32 v170, 16, v85
    v_and_b32 v171, 0xffff0000, v85
    v_lshlrev_b32 v172, 16, v86
    v_and_b32 v173, 0xffff0000, v86
    v_lshlrev_b32 v174, 16, v87
    v_and_b32 v175, 0xffff0000, v87
    v_lshlrev_b32 v176, 16, v88
    v_and_b32 v177, 0xffff0000, v88
    v_lshlrev_b32 v178, 16, v89
    v_and_b32 v179, 0xffff0000, v89
    v_lshlrev_b32 v180, 16, v90
    v_and_b32 v181, 0xffff0000, v90
    v_lshlrev_b32 v182, 16, v91
    v_and_b32 v183, 0xffff0000, v91
    v_lshlrev_b32 v184, 16, v92
    v_and_b32 v185, 0xffff0000, v92
    v_lshlrev_b32 v186, 16, v93
    v_and_b32 v187, 0xffff0000, v93
    v_lshlrev_b32 v188, 16, v94
    v_and_b32 v189, 0xffff0000, v94
    v_lshlrev_b32 v190, 16, v95
    v_and_b32 v191, 0xffff0000, v95
    v_add_f32 v6, v128, v129
    v_mul_f32 v7, v128, v128
    v_fmac_f32 v7, v129, v129
    v_add_f32 v6, v6, v130
    v_fmac_f32 v7, v130, v130
    v_add_f32 v6, v6, v131
    v_fmac_f32 v7, v131, v131
    v_add_f32 v6, v6, v132
    v_fmac_f32 v7, v132, v132
    v_add_f32 v6, v6, v133
    v_fmac_f32 v7, v133, v133
    v_add_f32 v6, v6, v134
    v_fmac_f32 v7, v134, v134
    v_add_f32 v6, v6, v135
    v_fmac_f32 v7, v135, v135
    v_add_f32 v6, v6, v136
    v_fmac_f32 v7, v136, v136
    v_add_f32 v6, v6, v137
    v_fmac_f32 v7, v137, v137
    v_add_f32 v6, v6, v138
    v_fmac_f32 v7, v138, v138
    v_add_f32 v6, v6, v139
    v_fmac_f32 v7, v139, v139
    v_add_f32 v6, v6, v140
    v_fmac_f32 v7, v140, v140
    v_add_f32 v6, v6, v141
    v_fmac_f32 v7, v141, v141
    v_add_f32 v6, v6, v142
    v_fmac_f32 v7, v142, v142
    v_add_f32 v6, v6, v143
    v_fmac_f32 v7, v143, v143
    v_add_f32 v6, v6, v144
    v_fmac_f32 v7, v144, v144
    v_add_f32 v6, v6, v145
    v_fmac_f32 v7, v145, v145
    v_add_f32 v6, v6, v146
    v_fmac_f32 v7, v146, v146
    v_add_f32 v6, v6, v147
    v_fmac_f32 v7, v147, v147
    v_add_f32 v6, v6, v148
    v_fmac_f32 v7, v148, v148
    v_add_f32 v6, v6, v149
    v_fmac_f32 v7, v149, v149
    v_add_f32 v6, v6, v150
    v_fmac_f32 v7, v150, v150
    v_add_f32 v6, v6, v151
    v_fmac_f32 v7, v151, v151
    v_add_f32 v6, v6, v152
    v_fmac_f32 v7, v152, v152
    v_add_f32 v6, v6, v153
    v_fmac_f32 v7, v153, v153
    v_add_f32 v6, v6, v154
    v_fmac_f32 v7, v154, v154
    v_add_f32 v6, v6, v155
    v_fmac_f32 v7, v155, v155
    v_add_f32 v6, v6, v156
    v_fmac_f32 v7, v156, v156
    v_add_f32 v6, v6, v157
    v_fmac_f32 v7, v157, v157
    v_add_f32 v6, v6, v158
    v_fmac_f32 v7, v158, v158
    v_add_f32 v6, v6, v159
    v_fmac_f32 v7, v159, v159
    v_add_f32 v6, v6, v160
    v_fmac_f32 v7, v160, v160
    v_add_f32 v6, v6, v161
    v_fmac_f32 v7, v161, v161
    v_add_f32 v6, v6, v162
    v_fmac_f32 v7, v162, v162
    v_add_f32 v6, v6, v163
    v_fmac_f32 v7, v163, v163
    v_add_f32 v6, v6, v164
    v_fmac_f32 v7, v164, v164
    v_add_f32 v6, v6, v165
    v_fmac_f32 v7, v165, v165
    v_add_f32 v6, v6, v166
    v_fmac_f32 v7, v166, v166
    v_add_f32 v6, v6, v167
    v_fmac_f32 v7, v167, v167
    v_add_f32 v6, v6, v168
    v_fmac_f32 v7, v168, v168
    v_add_f32 v6, v6, v169
    v_fmac_f32 v7, v169, v169
    v_add_f32 v6, v6, v170
    v_fmac_f32 v7, v170, v170
    v_add_f32 v6, v6, v171
    v_fmac_f32 v7, v171, v171
    v_add_f32 v6, v6, v172
    v_fmac_f32 v7, v172, v172
    v_add_f32 v6, v6, v173
    v_fmac_f32 v7, v173, v173
    v_add_f32 v6, v6, v174
    v_fmac_f32 v7, v174, v174
    v_add_f32 v6, v6, v175
    v_fmac_f32 v7, v175, v175
    v_add_f32 v6, v6, v176
    v_fmac_f32 v7, v176, v176
    v_add_f32 v6, v6, v177
    v_fmac_f32 v7, v177, v177
    v_add_f32 v6, v6, v178
    v_fmac_f32 v7, v178, v178
    v_add_f32 v6, v6, v179
    v_fmac_f32 v7, v179, v179
    v_add_f32 v6, v6, v180
    v_fmac_f32 v7, v180, v180
    v_add_f32 v6, v6, v181
    v_fmac_f32 v7, v181, v181
    v_add_f32 v6, v6, v182
    v_fmac_f32 v7, v182, v182
    v_add_f32 v6, v6, v183
    v_fmac_f32 v7, v183, v183
    v_add_f32 v6, v6, v184
    v_fmac_f32 v7, v184, v184
    v_add_f32 v6, v6, v185
    v_fmac_f32 v7, v185, v185
    v_add_f32 v6, v6, v186
    v_fmac_f32 v7, v186, v186
    v_add_f32 v6, v6, v187
    v_fmac_f32 v7, v187, v187
    v_add_f32 v6, v6, v188
    v_fmac_f32 v7, v188, v188
    v_add_f32 v6, v6, v189
    v_fmac_f32 v7, v189, v189
    v_add_f32 v6, v6, v190
    v_fmac_f32 v7, v190, v190
    v_add_f32 v6, v6, v191
    v_fmac_f32 v7, v191, v191
    v_mov_b32 v12, v6
    s_nop 1
    v_permlane32_swap_b32 v6, v12
    v_add_f32 v6, v6, v12
    v_mov_b32 v12, v7
    s_nop 1
    v_permlane32_swap_b32 v7, v12
    v_add_f32 v7, v7, v12
    s_lshl_b32 s6, s4, 8
    v_lshlrev_b32 v12, 3, v2
    v_add_u32 v13, s6, v12
    ds_write_b64 v13, v[6:7] offset:4096
    s_waitcnt lgkmcnt(0)
    s_barrier
    ds_read_b64 v[16:17], v12 offset:4096
    ds_read_b64 v[18:19], v12 offset:4352
    ds_read_b64 v[20:21], v12 offset:4608
    ds_read_b64 v[22:23], v12 offset:4864
    s_waitcnt lgkmcnt(0)
    v_add_f32 v16, v16, v18
    v_add_f32 v17, v17, v19
    v_add_f32 v20, v20, v22
    v_add_f32 v21, v21, v23
    v_add_f32 v16, v16, v20
    v_add_f32 v17, v17, v21
    s_mov_b32 s7, 0x3b000000
    v_mul_f32 v16, s7, v16
    v_mul_f32 v17, s7, v17
    v_fma_f32 v17, -v16, v16, v17
    v_max_f32 v17, 0, v17
    v_add_f32 v17, 0x3727c5ac, v17
    v_rsq_f32 v17, v17
    s_nop 0
    v_mul_f32 v18, v16, v17
    s_lshl_b32 s6, s4, 9
    v_lshlrev_b32 v12, 5, v3
    v_add_u32 v12, s6, v12
    v_lshlrev_b32 v13, 4, v1
    s_lshl_b32 s5, s3, 15
    s_lshl_b32 s6, s4, 13
    s_add_u32 s5, s5, s6
    s_add_u32 s5, s5, 1048576
    ds_read_b128 v[24:27], v12 offset:0
    ds_read_b128 v[28:31], v12 offset:16
    ds_read_b128 v[32:35], v12 offset:2048
    ds_read_b128 v[36:39], v12 offset:2064
    v_fma_f32 v128, v128, v17, -v18
    v_fma_f32 v129, v129, v17, -v18
    v_fma_f32 v130, v130, v17, -v18
    v_fma_f32 v131, v131, v17, -v18
    v_fma_f32 v132, v132, v17, -v18
    v_fma_f32 v133, v133, v17, -v18
    v_fma_f32 v134, v134, v17, -v18
    v_fma_f32 v135, v135, v17, -v18
    s_waitcnt lgkmcnt(0)
    v_fma_f32 v128, v128, v32, v24
    v_fma_f32 v129, v129, v33, v25
    v_fma_f32 v130, v130, v34, v26
    v_fma_f32 v131, v131, v35, v27
    v_fma_f32 v132, v132, v36, v28
    v_fma_f32 v133, v133, v37, v29
    v_fma_f32 v134, v134, v38, v30
    v_fma_f32 v135, v135, v39, v31
    v_cvt_pk_bf16_f32 v64, v128, v129
    v_cvt_pk_bf16_f32 v65, v130, v131
    v_cvt_pk_bf16_f32 v66, v132, v133
    v_cvt_pk_bf16_f32 v67, v134, v135
    buffer_store_dwordx4 v[64:67], v13, s[52:55], s5 offen offset:0 sc1
    ds_read_b128 v[24:27], v12 offset:64
    ds_read_b128 v[28:31], v12 offset:80
    ds_read_b128 v[32:35], v12 offset:2112
    ds_read_b128 v[36:39], v12 offset:2128
    v_fma_f32 v136, v136, v17, -v18
    v_fma_f32 v137, v137, v17, -v18
    v_fma_f32 v138, v138, v17, -v18
    v_fma_f32 v139, v139, v17, -v18
    v_fma_f32 v140, v140, v17, -v18
    v_fma_f32 v141, v141, v17, -v18
    v_fma_f32 v142, v142, v17, -v18
    v_fma_f32 v143, v143, v17, -v18
    s_waitcnt lgkmcnt(0)
    v_fma_f32 v136, v136, v32, v24
    v_fma_f32 v137, v137, v33, v25
    v_fma_f32 v138, v138, v34, v26
    v_fma_f32 v139, v139, v35, v27
    v_fma_f32 v140, v140, v36, v28
    v_fma_f32 v141, v141, v37, v29
    v_fma_f32 v142, v142, v38, v30
    v_fma_f32 v143, v143, v39, v31
    v_cvt_pk_bf16_f32 v68, v136, v137
    v_cvt_pk_bf16_f32 v69, v138, v139
    v_cvt_pk_bf16_f32 v70, v140, v141
    v_cvt_pk_bf16_f32 v71, v142, v143
    buffer_store_dwordx4 v[68:71], v13, s[52:55], s5 offen offset:1024 sc1
    ds_read_b128 v[24:27], v12 offset:128
    ds_read_b128 v[28:31], v12 offset:144
    ds_read_b128 v[32:35], v12 offset:2176
    ds_read_b128 v[36:39], v12 offset:2192
    v_fma_f32 v144, v144, v17, -v18
    v_fma_f32 v145, v145, v17, -v18
    v_fma_f32 v146, v146, v17, -v18
    v_fma_f32 v147, v147, v17, -v18
    v_fma_f32 v148, v148, v17, -v18
    v_fma_f32 v149, v149, v17, -v18
    v_fma_f32 v150, v150, v17, -v18
    v_fma_f32 v151, v151, v17, -v18
    s_waitcnt lgkmcnt(0)
    v_fma_f32 v144, v144, v32, v24
    v_fma_f32 v145, v145, v33, v25
    v_fma_f32 v146, v146, v34, v26
    v_fma_f32 v147, v147, v35, v27
    v_fma_f32 v148, v148, v36, v28
    v_fma_f32 v149, v149, v37, v29
    v_fma_f32 v150, v150, v38, v30
    v_fma_f32 v151, v151, v39, v31
    v_cvt_pk_bf16_f32 v72, v144, v145
    v_cvt_pk_bf16_f32 v73, v146, v147
    v_cvt_pk_bf16_f32 v74, v148, v149
    v_cvt_pk_bf16_f32 v75, v150, v151
    buffer_store_dwordx4 v[72:75], v13, s[52:55], s5 offen offset:2048 sc1
    ds_read_b128 v[24:27], v12 offset:192
    ds_read_b128 v[28:31], v12 offset:208
    ds_read_b128 v[32:35], v12 offset:2240
    ds_read_b128 v[36:39], v12 offset:2256
    v_fma_f32 v152, v152, v17, -v18
    v_fma_f32 v153, v153, v17, -v18
    v_fma_f32 v154, v154, v17, -v18
    v_fma_f32 v155, v155, v17, -v18
    v_fma_f32 v156, v156, v17, -v18
    v_fma_f32 v157, v157, v17, -v18
    v_fma_f32 v158, v158, v17, -v18
    v_fma_f32 v159, v159, v17, -v18
    s_waitcnt lgkmcnt(0)
    v_fma_f32 v152, v152, v32, v24
    v_fma_f32 v153, v153, v33, v25
    v_fma_f32 v154, v154, v34, v26
    v_fma_f32 v155, v155, v35, v27
    v_fma_f32 v156, v156, v36, v28
    v_fma_f32 v157, v157, v37, v29
    v_fma_f32 v158, v158, v38, v30
    v_fma_f32 v159, v159, v39, v31
    v_cvt_pk_bf16_f32 v76, v152, v153
    v_cvt_pk_bf16_f32 v77, v154, v155
    v_cvt_pk_bf16_f32 v78, v156, v157
    v_cvt_pk_bf16_f32 v79, v158, v159
    buffer_store_dwordx4 v[76:79], v13, s[52:55], s5 offen offset:3072 sc1
    ds_read_b128 v[24:27], v12 offset:256
    ds_read_b128 v[28:31], v12 offset:272
    ds_read_b128 v[32:35], v12 offset:2304
    ds_read_b128 v[36:39], v12 offset:2320
    v_fma_f32 v160, v160, v17, -v18
    v_fma_f32 v161, v161, v17, -v18
    v_fma_f32 v162, v162, v17, -v18
    v_fma_f32 v163, v163, v17, -v18
    v_fma_f32 v164, v164, v17, -v18
    v_fma_f32 v165, v165, v17, -v18
    v_fma_f32 v166, v166, v17, -v18
    v_fma_f32 v167, v167, v17, -v18
    s_waitcnt lgkmcnt(0)
    v_fma_f32 v160, v160, v32, v24
    v_fma_f32 v161, v161, v33, v25
    v_fma_f32 v162, v162, v34, v26
    v_fma_f32 v163, v163, v35, v27
    v_fma_f32 v164, v164, v36, v28
    v_fma_f32 v165, v165, v37, v29
    v_fma_f32 v166, v166, v38, v30
    v_fma_f32 v167, v167, v39, v31
    v_cvt_pk_bf16_f32 v80, v160, v161
    v_cvt_pk_bf16_f32 v81, v162, v163
    v_cvt_pk_bf16_f32 v82, v164, v165
    v_cvt_pk_bf16_f32 v83, v166, v167
    s_add_u32 s5, s5, 4096
    buffer_store_dwordx4 v[80:83], v13, s[52:55], s5 offen offset:0 sc1
    ds_read_b128 v[24:27], v12 offset:320
    ds_read_b128 v[28:31], v12 offset:336
    ds_read_b128 v[32:35], v12 offset:2368
    ds_read_b128 v[36:39], v12 offset:2384
    v_fma_f32 v168, v168, v17, -v18
    v_fma_f32 v169, v169, v17, -v18
    v_fma_f32 v170, v170, v17, -v18
    v_fma_f32 v171, v171, v17, -v18
    v_fma_f32 v172, v172, v17, -v18
    v_fma_f32 v173, v173, v17, -v18
    v_fma_f32 v174, v174, v17, -v18
    v_fma_f32 v175, v175, v17, -v18
    s_waitcnt lgkmcnt(0)
    v_fma_f32 v168, v168, v32, v24
    v_fma_f32 v169, v169, v33, v25
    v_fma_f32 v170, v170, v34, v26
    v_fma_f32 v171, v171, v35, v27
    v_fma_f32 v172, v172, v36, v28
    v_fma_f32 v173, v173, v37, v29
    v_fma_f32 v174, v174, v38, v30
    v_fma_f32 v175, v175, v39, v31
    v_cvt_pk_bf16_f32 v84, v168, v169
    v_cvt_pk_bf16_f32 v85, v170, v171
    v_cvt_pk_bf16_f32 v86, v172, v173
    v_cvt_pk_bf16_f32 v87, v174, v175
    buffer_store_dwordx4 v[84:87], v13, s[52:55], s5 offen offset:1024 sc1
    ds_read_b128 v[24:27], v12 offset:384
    ds_read_b128 v[28:31], v12 offset:400
    ds_read_b128 v[32:35], v12 offset:2432
    ds_read_b128 v[36:39], v12 offset:2448
    v_fma_f32 v176, v176, v17, -v18
    v_fma_f32 v177, v177, v17, -v18
    v_fma_f32 v178, v178, v17, -v18
    v_fma_f32 v179, v179, v17, -v18
    v_fma_f32 v180, v180, v17, -v18
    v_fma_f32 v181, v181, v17, -v18
    v_fma_f32 v182, v182, v17, -v18
    v_fma_f32 v183, v183, v17, -v18
    s_waitcnt lgkmcnt(0)
    v_fma_f32 v176, v176, v32, v24
    v_fma_f32 v177, v177, v33, v25
    v_fma_f32 v178, v178, v34, v26
    v_fma_f32 v179, v179, v35, v27
    v_fma_f32 v180, v180, v36, v28
    v_fma_f32 v181, v181, v37, v29
    v_fma_f32 v182, v182, v38, v30
    v_fma_f32 v183, v183, v39, v31
    v_cvt_pk_bf16_f32 v88, v176, v177
    v_cvt_pk_bf16_f32 v89, v178, v179
    v_cvt_pk_bf16_f32 v90, v180, v181
    v_cvt_pk_bf16_f32 v91, v182, v183
    buffer_store_dwordx4 v[88:91], v13, s[52:55], s5 offen offset:2048 sc1
    ds_read_b128 v[24:27], v12 offset:448
    ds_read_b128 v[28:31], v12 offset:464
    ds_read_b128 v[32:35], v12 offset:2496
    ds_read_b128 v[36:39], v12 offset:2512
    v_fma_f32 v184, v184, v17, -v18
    v_fma_f32 v185, v185, v17, -v18
    v_fma_f32 v186, v186, v17, -v18
    v_fma_f32 v187, v187, v17, -v18
    v_fma_f32 v188, v188, v17, -v18
    v_fma_f32 v189, v189, v17, -v18
    v_fma_f32 v190, v190, v17, -v18
    v_fma_f32 v191, v191, v17, -v18
    s_waitcnt lgkmcnt(0)
    v_fma_f32 v184, v184, v32, v24
    v_fma_f32 v185, v185, v33, v25
    v_fma_f32 v186, v186, v34, v26
    v_fma_f32 v187, v187, v35, v27
    v_fma_f32 v188, v188, v36, v28
    v_fma_f32 v189, v189, v37, v29
    v_fma_f32 v190, v190, v38, v30
    v_fma_f32 v191, v191, v39, v31
    v_cvt_pk_bf16_f32 v92, v184, v185
    v_cvt_pk_bf16_f32 v93, v186, v187
    v_cvt_pk_bf16_f32 v94, v188, v189
    v_cvt_pk_bf16_f32 v95, v190, v191
    buffer_store_dwordx4 v[92:95], v13, s[52:55], s5 offen offset:3072 sc1
    s_waitcnt vmcnt(0)
    s_barrier
    s_mov_b32 s7, 7
    s_cmp_lg_u32 s4, 0
    s_cbranch_scc1 DA_104
    s_mov_b64 exec, 1
    v_mov_b32 v1, 1
    buffer_atomic_add v1, off, s[60:63], 0 offset:132
    s_mov_b64 exec, -1
DA_104:
    s_lshr_b32 s90, s3, 5
    s_and_b32 s3, s3, 31
    v_lshrrev_b32 v1, 6, v0
    s_nop 0
    v_readfirstlane_b32 s4, v1
    s_nop 3
    v_and_b32 v1, 63, v0
    v_and_b32 v2, 15, v1
    v_lshrrev_b32 v3, 4, v1
    v_lshrrev_b32 v4, 2, v2
    v_and_b32 v5, 3, v2
    v_lshrrev_b32 v6, 1, v3
    v_and_b32 v7, 1, v3
    v_lshlrev_b32 v8, 4, v1
    s_mov_b32 s56, s26
    s_and_b32 s57, s27, 0xffff
    s_mov_b32 s58, 0x400000
    s_mov_b32 s59, 0x00020000
    s_lshl_b32 s6, s3, 17
    s_lshl_b32 s7, s4, 15
    s_add_u32 s6, s6, s7
    s_mov_b32 m0, s7
    s_add_u32 s7, s7, 1024
    buffer_load_dwordx4 v8, s[56:59], s6 offen lds
    s_add_u32 s6, s6, 1024
    s_mov_b32 m0, s7
    s_add_u32 s7, s7, 1024
    buffer_load_dwordx4 v8, s[56:59], s6 offen lds
    s_add_u32 s6, s6, 1024
    s_mov_b32 m0, s7
    s_add_u32 s7, s7, 1024
    buffer_load_dwordx4 v8, s[56:59], s6 offen lds
    s_add_u32 s6, s6, 1024
    s_mov_b32 m0, s7
    s_add_u32 s7, s7, 1024
    buffer_load_dwordx4 v8, s[56:59], s6 offen lds
    s_add_u32 s6, s6, 1024
    s_mov_b32 m0, s7
    s_add_u32 s7, s7, 1024
    buffer_load_dwordx4 v8, s[56:59], s6 offen lds
    s_add_u32 s6, s6, 1024
    s_mov_b32 m0, s7
    s_add_u32 s7, s7, 1024
    buffer_load_dwordx4 v8, s[56:59], s6 offen lds
    s_add_u32 s6, s6, 1024
    s_mov_b32 m0, s7
    s_add_u32 s7, s7, 1024
    buffer_load_dwordx4 v8, s[56:59], s6 offen lds
    s_add_u32 s6, s6, 1024
    s_mov_b32 m0, s7
    s_add_u32 s7, s7, 1024
    buffer_load_dwordx4 v8, s[56:59], s6 offen lds
    s_add_u32 s6, s6, 1024
    s_mov_b32 m0, s7
    s_add_u32 s7, s7, 1024
    buffer_load_dwordx4 v8, s[56:59], s6 offen lds
    s_add_u32 s6, s6, 1024
    s_mov_b32 m0, s7
    s_add_u32 s7, s7, 1024
    buffer_load_dwordx4 v8, s[56:59], s6 offen lds
    s_add_u32 s6, s6, 1024
    s_mov_b32 m0, s7
    s_add_u32 s7, s7, 1024
    buffer_load_dwordx4 v8, s[56:59], s6 offen lds
    s_add_u32 s6, s6, 1024
    s_mov_b32 m0, s7
    s_add_u32 s7, s7, 1024
    buffer_load_dwordx4 v8, s[56:59], s6 offen lds
    s_add_u32 s6, s6, 1024
    s_mov_b32 m0, s7
    s_add_u32 s7, s7, 1024
    buffer_load_dwordx4 v8, s[56:59], s6 offen lds
    s_add_u32 s6, s6, 1024
    s_mov_b32 m0, s7
    s_add_u32 s7, s7, 1024
    buffer_load_dwordx4 v8, s[56:59], s6 offen lds
    s_add_u32 s6, s6, 1024
    s_mov_b32 m0, s7
    s_add_u32 s7, s7, 1024
    buffer_load_dwordx4 v8, s[56:59], s6 offen lds
    s_add_u32 s6, s6, 1024
    s_mov_b32 m0, s7
    s_add_u32 s7, s7, 1024
    buffer_load_dwordx4 v8, s[56:59], s6 offen lds
    s_add_u32 s6, s6, 1024
    s_mov_b32 m0, s7
    s_add_u32 s7, s7, 1024
    buffer_load_dwordx4 v8, s[56:59], s6 offen lds
    s_add_u32 s6, s6, 1024
    s_mov_b32 m0, s7
    s_add_u32 s7, s7, 1024
    buffer_load_dwordx4 v8, s[56:59], s6 offen lds
    s_add_u32 s6, s6, 1024
    s_mov_b32 m0, s7
    s_add_u32 s7, s7, 1024
    buffer_load_dwordx4 v8, s[56:59], s6 offen lds
    s_add_u32 s6, s6, 1024
    s_mov_b32 m0, s7
    s_add_u32 s7, s7, 1024
    buffer_load_dwordx4 v8, s[56:59], s6 offen lds
    s_add_u32 s6, s6, 1024
    s_mov_b32 m0, s7
    s_add_u32 s7, s7, 1024
    buffer_load_dwordx4 v8, s[56:59], s6 offen lds
    s_add_u32 s6, s6, 1024
    s_mov_b32 m0, s7
    s_add_u32 s7, s7, 1024
    buffer_load_dwordx4 v8, s[56:59], s6 offen lds
    s_add_u32 s6, s6, 1024
    s_mov_b32 m0, s7
    s_add_u32 s7, s7, 1024
    buffer_load_dwordx4 v8, s[56:59], s6 offen lds
    s_add_u32 s6, s6, 1024
    s_mov_b32 m0, s7
    s_add_u32 s7, s7, 1024
    buffer_load_dwordx4 v8, s[56:59], s6 offen lds
    s_add_u32 s6, s6, 1024
    s_mov_b32 m0, s7
    s_add_u32 s7, s7, 1024
    buffer_load_dwordx4 v8, s[56:59], s6 offen lds
    s_add_u32 s6, s6, 1024
    s_mov_b32 m0, s7
    s_add_u32 s7, s7, 1024
    buffer_load_dwordx4 v8, s[56:59], s6 offen lds
    s_add_u32 s6, s6, 1024
    s_mov_b32 m0, s7
    s_add_u32 s7, s7, 1024
    buffer_load_dwordx4 v8, s[56:59], s6 offen lds
    s_add_u32 s6, s6, 1024
    s_mov_b32 m0, s7
    s_add_u32 s7, s7, 1024
    buffer_load_dwordx4 v8, s[56:59], s6 offen lds
    s_add_u32 s6, s6, 1024
    s_mov_b32 m0, s7
    s_add_u32 s7, s7, 1024
    buffer_load_dwordx4 v8, s[56:59], s6 offen lds
    s_add_u32 s6, s6, 1024
    s_mov_b32 m0, s7
    s_add_u32 s7, s7, 1024
    buffer_load_dwordx4 v8, s[56:59], s6 offen lds
    s_add_u32 s6, s6, 1024
    s_mov_b32 m0, s7
    s_add_u32 s7, s7, 1024
    buffer_load_dwordx4 v8, s[56:59], s6 offen lds
    s_add_u32 s6, s6, 1024
    s_mov_b32 m0, s7
    s_add_u32 s7, s7, 1024
    buffer_load_dwordx4 v8, s[56:59], s6 offen lds
    s_add_u32 s6, s6, 1024
    v_lshl_add_u32 v9, v6, 3, v4
    v_lshlrev_b32 v9, 10, v9
    v_lshl_add_u32 v9, v7, 5, v9
    v_lshl_add_u32 v9, v5, 3, v9
    s_lshl_b32 s6, s4, 8
    v_add_u32 v9, s6, v9
    v_add_u32 v10, 0x10000, v9
    s_waitcnt vmcnt(0)
    s_barrier
    ds_read_b64_tr_b16 a[0:1], v9 offset:0
    ds_read_b64_tr_b16 a[2:3], v9 offset:4096
    ds_read_b64_tr_b16 a[4:5], v9 offset:16384
    ds_read_b64_tr_b16 a[6:7], v9 offset:20480
    ds_read_b64_tr_b16 a[8:9], v9 offset:32768
    ds_read_b64_tr_b16 a[10:11], v9 offset:36864
    ds_read_b64_tr_b16 a[12:13], v9 offset:49152
    ds_read_b64_tr_b16 a[14:15], v9 offset:53248
    ds_read_b64_tr_b16 a[16:17], v10 offset:0
    ds_read_b64_tr_b16 a[18:19], v10 offset:4096
    ds_read_b64_tr_b16 a[20:21], v10 offset:16384
    ds_read_b64_tr_b16 a[22:23], v10 offset:20480
    ds_read_b64_tr_b16 a[24:25], v10 offset:32768
    ds_read_b64_tr_b16 a[26:27], v10 offset:36864
    ds_read_b64_tr_b16 a[28:29], v10 offset:49152
    ds_read_b64_tr_b16 a[30:31], v10 offset:53248
    ds_read_b64_tr_b16 a[32:33], v9 offset:64
    ds_read_b64_tr_b16 a[34:35], v9 offset:4160
    ds_read_b64_tr_b16 a[36:37], v9 offset:16448
    ds_read_b64_tr_b16 a[38:39], v9 offset:20544
    ds_read_b64_tr_b16 a[40:41], v9 offset:32832
    ds_read_b64_tr_b16 a[42:43], v9 offset:36928
    ds_read_b64_tr_b16 a[44:45], v9 offset:49216
    ds_read_b64_tr_b16 a[46:47], v9 offset:53312
    ds_read_b64_tr_b16 a[48:49], v10 offset:64
    ds_read_b64_tr_b16 a[50:51], v10 offset:4160
    ds_read_b64_tr_b16 a[52:53], v10 offset:16448
    ds_read_b64_tr_b16 a[54:55], v10 offset:20544
    ds_read_b64_tr_b16 a[56:57], v10 offset:32832
    ds_read_b64_tr_b16 a[58:59], v10 offset:36928
    ds_read_b64_tr_b16 a[60:61], v10 offset:49216
    ds_read_b64_tr_b16 a[62:63], v10 offset:53312
    ds_read_b64_tr_b16 a[64:65], v9 offset:128
    ds_read_b64_tr_b16 a[66:67], v9 offset:4224
    ds_read_b64_tr_b16 a[68:69], v9 offset:16512
    ds_read_b64_tr_b16 a[70:71], v9 offset:20608
    ds_read_b64_tr_b16 a[72:73], v9 offset:32896
    ds_read_b64_tr_b16 a[74:75], v9 offset:36992
    ds_read_b64_tr_b16 a[76:77], v9 offset:49280
    ds_read_b64_tr_b16 a[78:79], v9 offset:53376
    ds_read_b64_tr_b16 a[80:81], v10 offset:128
    ds_read_b64_tr_b16 a[82:83], v10 offset:4224
    ds_read_b64_tr_b16 a[84:85], v10 offset:16512
    ds_read_b64_tr_b16 a[86:87], v10 offset:20608
    ds_read_b64_tr_b16 a[88:89], v10 offset:32896
    ds_read_b64_tr_b16 a[90:91], v10 offset:36992
    ds_read_b64_tr_b16 a[92:93], v10 offset:49280
    ds_read_b64_tr_b16 a[94:95], v10 offset:53376
    ds_read_b64_tr_b16 a[96:97], v9 offset:192
    ds_read_b64_tr_b16 a[98:99], v9 offset:4288
    ds_read_b64_tr_b16 a[100:101], v9 offset:16576
    ds_read_b64_tr_b16 a[102:103], v9 offset:20672
    ds_read_b64_tr_b16 a[104:105], v9 offset:32960
    ds_read_b64_tr_b16 a[106:107], v9 offset:37056
    ds_read_b64_tr_b16 a[108:109], v9 offset:49344
    ds_read_b64_tr_b16 a[110:111], v9 offset:53440
    ds_read_b64_tr_b16 a[112:113], v10 offset:192
    ds_read_b64_tr_b16 a[114:115], v10 offset:4288
    ds_read_b64_tr_b16 a[116:117], v10 offset:16576
    ds_read_b64_tr_b16 a[118:119], v10 offset:20672
    ds_read_b64_tr_b16 a[120:121], v10 offset:32960
    ds_read_b64_tr_b16 a[122:123], v10 offset:37056
    ds_read_b64_tr_b16 a[124:125], v10 offset:49344
    ds_read_b64_tr_b16 a[126:127], v10 offset:53440
    s_and_b32 s5, s4, 1
    s_lshr_b32 s92, s4, 1
    s_lshl_b32 s6, s5, 4
    v_add_u32 v11, s6, v2
    v_lshlrev_b32 v12, 2, v3
    v_add_u32 v13, 0, v12
    v_cmp_le_u32 s[32:33], v13, v11
    v_add_u32 v13, 1, v12
    v_cmp_le_u32 s[34:35], v13, v11
    v_add_u32 v13, 2, v12
    v_cmp_le_u32 s[36:37], v13, v11
    v_add_u32 v13, 3, v12
    v_cmp_le_u32 s[38:39], v13, v11
    v_add_u32 v13, 16, v12
    v_cmp_le_u32 s[40:41], v13, v11
    v_add_u32 v13, 17, v12
    v_cmp_le_u32 s[42:43], v13, v11
    v_add_u32 v13, 18, v12
    v_cmp_le_u32 s[44:45], v13, v11
    v_add_u32 v13, 19, v12
    v_cmp_le_u32 s[46:47], v13, v11
    v_cmp_gt_u32 vcc, 2, v3
    s_nop 1
    v_cndmask_b32 v14, 0, 1.0, vcc
    v_lshl_add_u32 v9, v6, 5, v11
    v_lshlrev_b32 v9, 4, v9
    v_lshl_add_u32 v9, v7, 3, v9
    s_lshl_b32 s6, s92, 12
    v_add_u32 v9, s6, v9
    v_and_b32 v10, 31, v1
    v_lshlrev_b32 v10, 15, v10
    v_lshl_add_u32 v10, v6, 4, v10
    s_lshl_b32 s6, s4, 8
    v_add_u32 v10, s6, v10
    s_mov_b32 s82, 0x3e0293ee
    s_mov_b32 s83, 0xbe0293ee
    v_mov_b32 v15, 0xff800000
    s_waitcnt lgkmcnt(0)
    s_barrier
    s_lshl_b32 s6, s3, 7
    s_add_u32 s94, s6, 0
    s_add_u32 s95, s6, 8192
    s_add_u32 s97, s6, 8256
    s_lshr_b32 s6, s3, 1
    s_lshl_b32 s6, s6, 7
    s_add_u32 s96, s6, 4096
    s_lshl_b32 s7, s3, 2
    s_add_u32 s88, s7, 16384
    v_cmp_eq_u32 s[48:49], s90, v6
    s_mov_b32 s99, 0
    s_add_u32 s93, s90, 1
    s_cmp_ge_u32 s99, s93
    s_cbranch_scc1 A_xok_105
FW_106:
    buffer_load_dword v137, off, s[52:55], s94 sc1
    buffer_load_dword v138, off, s[52:55], s96 sc1
    buffer_load_dword v139, off, s[52:55], s97 sc1
    s_add_u32 s79, s79, 1
    s_cmp_gt_u32 s79, 2097152
    s_cbranch_scc1 mega_kernel_exit
    s_waitcnt vmcnt(0)
    v_min_u32 v137, v137, v138
    v_min_u32 v137, v137, v139
    v_cmp_gt_u32 vcc, s93, v137
    s_nop 0
    s_cbranch_vccz FWok_107
    s_sleep 4
    s_branch FW_106
FWok_107:
    v_readfirstlane_b32 s99, v137
A_xok_105:
    s_lshl_b32 s6, s90, 5
    s_add_u32 s6, s6, s3
    s_lshl_b32 s7, s6, 13
    s_lshl_b32 s8, s4, 11
    s_add_u32 s7, s7, s8
    s_add_u32 s9, s8, 65536
    s_mov_b32 m0, s9
    s_add_u32 s10, s7, 50331648
    buffer_load_dwordx4 v8, s[52:55], s10 offen sc1 lds
    buffer_load_dwordx4 v8, s[52:55], s10 offen offset:1024 sc1 lds
    s_add_u32 s9, s8, 73728
    s_mov_b32 m0, s9
    s_add_u32 s10, s7, 16777216
    buffer_load_dwordx4 v8, s[52:55], s10 offen sc1 lds
    buffer_load_dwordx4 v8, s[52:55], s10 offen offset:1024 sc1 lds
    s_add_u32 s9, s8, 81920
    s_mov_b32 m0, s9
    s_add_u32 s10, s7, 33554432
    buffer_load_dwordx4 v8, s[52:55], s10 offen sc1 lds
    buffer_load_dwordx4 v8, s[52:55], s10 offen offset:1024 sc1 lds
    s_mov_b32 s85, 0
A_loop_108:
    s_add_u32 s91, s90, 1
    s_cmp_eq_u32 s85, 1
    s_cbranch_scc1 A_have_109
    s_add_u32 s93, s94, 64
    s_cmp_eq_u32 s90, 63
    s_cselect_b32 s93, s93, s95
FW_110:
    buffer_load_dword v137, off, s[52:55], s93 sc1
    s_add_u32 s79, s79, 1
    s_cmp_gt_u32 s79, 2097152
    s_cbranch_scc1 mega_kernel_exit
    s_waitcnt vmcnt(0)
    v_cmp_gt_u32 vcc, s91, v137
    s_nop 0
    s_cbranch_vccz FWok_111
    s_sleep 2
    s_branch FW_110
FWok_111:
    s_add_u32 s6, s90, 1
    s_lshr_b32 s7, s6, 6
    s_lshr_b32 s6, s90, 2
    s_add_u32 s6, s6, s7
    s_lshl_b32 s6, s6, 5
    s_add_u32 s6, s6, s3
    s_lshl_b32 s7, s6, 13
    s_bfe_u32 s6, s90, 0x10001
    s_lshl_b32 s12, s6, 12
    s_add_u32 s12, s12, s7
    s_lshl_b32 s8, s4, 10
    s_add_u32 s12, s12, s8
    s_add_u32 s12, s12, 67108864
    s_add_u32 s9, s8, 90112
    s_mov_b32 m0, s9
    s_lshl_b32 s8, s4, 11
    buffer_load_dwordx4 v8, s[52:55], s12 offen sc1 lds
    s_add_u32 s9, s8, 94208
    s_mov_b32 m0, s9
    s_add_u32 s13, s7, s8
    s_add_u32 s13, s13, 83886080
    buffer_load_dwordx4 v8, s[52:55], s13 offen sc1 lds
    buffer_load_dwordx4 v8, s[52:55], s13 offen offset:1024 sc1 lds
A_have_109:
    buffer_load_dword v204, off, s[52:55], s95 sc1
    s_waitcnt vmcnt(1)
    s_barrier
    s_lshl_b32 s6, s5, 12
    s_add_u32 s6, s6, 65536
    v_add_u32 v135, s6, v8
    v_add_u32 v136, 73728, v8
    s_lshl_b32 s6, s92, 12
    s_add_u32 s6, s6, 81920
    v_add_u32 v137, s6, v8
    s_bfe_u32 s7, s90, 0x10001
    s_lshl_b32 s7, s7, 3
    v_add_u32 v138, s7, v137
    ds_read_b128 v[16:19], v135 offset:0
    ds_read_b128 v[20:23], v135 offset:1024
    ds_read_b128 v[24:27], v135 offset:2048
    ds_read_b128 v[28:31], v135 offset:3072
    ds_read_b128 v[32:35], v136 offset:0
    ds_read_b128 v[36:39], v136 offset:1024
    ds_read_b128 v[40:43], v136 offset:2048
    ds_read_b128 v[44:47], v136 offset:3072
    ds_read_b128 v[48:51], v136 offset:4096
    ds_read_b128 v[52:55], v136 offset:5120
    ds_read_b128 v[56:59], v136 offset:6144
    ds_read_b128 v[60:63], v136 offset:7168
    ds_read_b128 v[64:67], v136 offset:16384
    ds_read_b128 v[68:71], v136 offset:17408
    ds_read_b128 v[72:75], v136 offset:18432
    ds_read_b128 v[76:79], v136 offset:19456
    ds_read_b128 v[80:83], v137 offset:0
    ds_read_b128 v[84:87], v137 offset:1024
    ds_read_b128 v[88:91], v137 offset:2048
    ds_read_b128 v[92:95], v137 offset:3072
    ds_read_b64 v[96:97], v138 offset:12288
    ds_read_b64 v[98:99], v138 offset:13312
    ds_read_b64 v[100:101], v138 offset:14336
    ds_read_b64 v[102:103], v138 offset:15360
    s_waitcnt lgkmcnt(0)
    s_waitcnt vmcnt(8)
    v_mfma_f32_16x16x32_bf16 v[108:111], v[32:35], v[16:19], 0
    v_mfma_f32_16x16x32_bf16 v[108:111], v[36:39], v[20:23], v[108:111]
    v_mfma_f32_16x16x32_bf16 v[108:111], v[40:43], v[24:27], v[108:111]
    v_mfma_f32_16x16x32_bf16 v[108:111], v[44:47], v[28:31], v[108:111]
    v_mfma_f32_16x16x32_bf16 v[112:115], v[48:51], v[16:19], 0
    v_mfma_f32_16x16x32_bf16 v[112:115], v[52:55], v[20:23], v[112:115]
    v_mfma_f32_16x16x32_bf16 v[112:115], v[56:59], v[24:27], v[112:115]
    v_mfma_f32_16x16x32_bf16 v[112:115], v[60:63], v[28:31], v[112:115]
    s_waitcnt vmcnt(4)
    v_mfma_f32_16x16x32_bf16 v[104:107], v[64:67], v[16:19], 0
    v_mfma_f32_16x16x32_bf16 v[104:107], v[68:71], v[20:23], v[104:107]
    v_mfma_f32_16x16x32_bf16 v[104:107], v[72:75], v[24:27], v[104:107]
    v_mfma_f32_16x16x32_bf16 v[104:107], v[76:79], v[28:31], v[104:107]
    v_cndmask_b32 v108, v15, v108, s[32:33]
    v_cndmask_b32 v109, v15, v109, s[34:35]
    v_cndmask_b32 v110, v15, v110, s[36:37]
    v_cndmask_b32 v111, v15, v111, s[38:39]
    v_cndmask_b32 v112, v15, v112, s[40:41]
    v_cndmask_b32 v113, v15, v113, s[42:43]
    v_cndmask_b32 v114, v15, v114, s[44:45]
    v_cndmask_b32 v115, v15, v115, s[46:47]
    v_cndmask_b32 v104, v15, v104, s[48:49]
    v_cndmask_b32 v105, v15, v105, s[48:49]
    v_cndmask_b32 v106, v15, v106, s[48:49]
    v_cndmask_b32 v107, v15, v107, s[48:49]
    v_max3_f32 v132, v108, v109, v110
    v_max3_f32 v132, v132, v111, v112
    v_max3_f32 v132, v132, v113, v114
    v_max3_f32 v132, v132, v115, v104
    v_max3_f32 v132, v132, v105, v106
    v_max_f32 v132, v132, v107
    v_mov_b32 v136, v132
    s_nop 1
    v_permlane32_swap_b32 v132, v136
    v_max_f32 v132, v132, v136
    v_mov_b32 v136, v132
    s_nop 1
    v_permlane16_swap_b32 v132, v136
    v_max_f32 v132, v132, v136
    v_mul_f32 v133, s83, v132
    v_fma_f32 v104, v104, s82, v133
    v_fma_f32 v105, v105, s82, v133
    v_fma_f32 v106, v106, s82, v133
    v_fma_f32 v107, v107, s82, v133
    v_fma_f32 v108, v108, s82, v133
    v_fma_f32 v109, v109, s82, v133
    v_fma_f32 v110, v110, s82, v133
    v_fma_f32 v111, v111, s82, v133
    v_fma_f32 v112, v112, s82, v133
    v_fma_f32 v113, v113, s82, v133
    v_fma_f32 v114, v114, s82, v133
    v_fma_f32 v115, v115, s82, v133
    v_exp_f32 v104, v104
    v_exp_f32 v105, v105
    v_exp_f32 v106, v106
    v_exp_f32 v107, v107
    v_exp_f32 v108, v108
    v_exp_f32 v109, v109
    v_exp_f32 v110, v110
    v_exp_f32 v111, v111
    v_exp_f32 v112, v112
    v_exp_f32 v113, v113
    v_exp_f32 v114, v114
    v_exp_f32 v115, v115
    v_add_f32 v134, v104, v105
    v_add_f32 v134, v134, v106
    v_add_f32 v134, v134, v107
    v_add_f32 v134, v134, v108
    v_add_f32 v134, v134, v109
    v_add_f32 v134, v134, v110
    v_add_f32 v134, v134, v111
    v_add_f32 v134, v134, v112
    v_add_f32 v134, v134, v113
    v_add_f32 v134, v134, v114
    v_add_f32 v134, v134, v115
    v_cvt_pk_bf16_f32 v104, v104, v105
    v_cvt_pk_bf16_f32 v105, v106, v107
    v_cvt_pk_bf16_f32 v108, v108, v109
    v_cvt_pk_bf16_f32 v109, v110, v111
    v_cvt_pk_bf16_f32 v110, v112, v113
    v_cvt_pk_bf16_f32 v111, v114, v115
    v_mov_b32 v136, v134
    s_nop 1
    v_permlane32_swap_b32 v134, v136
    v_add_f32 v134, v134, v136
    v_mov_b32 v136, v134
    s_nop 1
    v_permlane16_swap_b32 v134, v136
    v_add_f32 v134, v134, v136
    v_rcp_f32 v134, v134
    v_mfma_f32_16x16x32_bf16 v[116:119], v[80:83], v[108:111], 0
    v_mfma_f32_16x16x32_bf16 v[120:123], v[84:87], v[108:111], 0
    v_mfma_f32_16x16x32_bf16 v[124:127], v[88:91], v[108:111], 0
    v_mfma_f32_16x16x32_bf16 v[128:131], v[92:95], v[108:111], 0
    v_mfma_f32_16x16x16_bf16 v[116:119], v[96:97], v[104:105], v[116:119]
    v_mfma_f32_16x16x16_bf16 v[120:123], v[98:99], v[104:105], v[120:123]
    v_mfma_f32_16x16x16_bf16 v[124:127], v[100:101], v[104:105], v[124:127]
    v_mfma_f32_16x16x16_bf16 v[128:131], v[102:103], v[104:105], v[128:131]
    s_nop 4
    v_mul_f32 v116, v116, v134
    v_mul_f32 v117, v117, v134
    v_mul_f32 v118, v118, v134
    v_mul_f32 v119, v119, v134
    v_cvt_pk_bf16_f32 v116, v116, v117
    v_cvt_pk_bf16_f32 v117, v118, v119
    ds_write_b64 v9, v[116:117] offset:0
    v_mul_f32 v120, v120, v134
    v_mul_f32 v121, v121, v134
    v_mul_f32 v122, v122, v134
    v_mul_f32 v123, v123, v134
    v_cvt_pk_bf16_f32 v120, v120, v121
    v_cvt_pk_bf16_f32 v121, v122, v123
    ds_write_b64 v9, v[120:121] offset:1024
    v_mul_f32 v124, v124, v134
    v_mul_f32 v125, v125, v134
    v_mul_f32 v126, v126, v134
    v_mul_f32 v127, v127, v134
    v_cvt_pk_bf16_f32 v124, v124, v125
    v_cvt_pk_bf16_f32 v125, v126, v127
    ds_write_b64 v9, v[124:125] offset:2048
    v_mul_f32 v128, v128, v134
    v_mul_f32 v129, v129, v134
    v_mul_f32 v130, v130, v134
    v_mul_f32 v131, v131, v134
    v_cvt_pk_bf16_f32 v128, v128, v129
    v_cvt_pk_bf16_f32 v129, v130, v131
    ds_write_b64 v9, v[128:129] offset:3072
    s_waitcnt lgkmcnt(0)
    s_barrier
    ds_read_b128 v[16:19], v8 offset:0
    ds_read_b128 v[20:23], v8 offset:1024
    ds_read_b128 v[24:27], v8 offset:2048
    ds_read_b128 v[28:31], v8 offset:3072
    ds_read_b128 v[32:35], v8 offset:4096
    ds_read_b128 v[36:39], v8 offset:5120
    ds_read_b128 v[40:43], v8 offset:6144
    ds_read_b128 v[44:47], v8 offset:7168
    s_mov_b32 s87, s6
    s_add_u32 s89, s90, 2
    s_cmp_ge_u32 s89, 64
    s_cbranch_scc1 A_nom_112
    s_waitcnt vmcnt(0)
    v_readfirstlane_b32 s86, v204
    s_add_u32 s93, s89, 1
    s_cmp_ge_u32 s99, s93
    s_cbranch_scc1 A_xok_113
FW_114:
    buffer_load_dword v137, off, s[52:55], s94 sc1
    buffer_load_dword v138, off, s[52:55], s96 sc1
    buffer_load_dword v139, off, s[52:55], s97 sc1
    s_add_u32 s79, s79, 1
    s_cmp_gt_u32 s79, 2097152
    s_cbranch_scc1 mega_kernel_exit
    s_waitcnt vmcnt(0)
    v_min_u32 v137, v137, v138
    v_min_u32 v137, v137, v139
    v_cmp_gt_u32 vcc, s93, v137
    s_nop 0
    s_cbranch_vccz FWok_115
    s_sleep 4
    s_branch FW_114
FWok_115:
    v_readfirstlane_b32 s99, v137
A_xok_113:
    s_lshl_b32 s6, s89, 5
    s_add_u32 s6, s6, s3
    s_lshl_b32 s7, s6, 13
    s_lshl_b32 s8, s4, 11
    s_add_u32 s7, s7, s8
    s_add_u32 s9, s8, 65536
    s_mov_b32 m0, s9
    s_add_u32 s10, s7, 50331648
    buffer_load_dwordx4 v8, s[52:55], s10 offen sc1 lds
    buffer_load_dwordx4 v8, s[52:55], s10 offen offset:1024 sc1 lds
    s_add_u32 s9, s8, 73728
    s_mov_b32 m0, s9
    s_add_u32 s10, s7, 16777216
    buffer_load_dwordx4 v8, s[52:55], s10 offen sc1 lds
    buffer_load_dwordx4 v8, s[52:55], s10 offen offset:1024 sc1 lds
    s_add_u32 s9, s8, 81920
    s_mov_b32 m0, s9
    s_add_u32 s10, s7, 33554432
    buffer_load_dwordx4 v8, s[52:55], s10 offen sc1 lds
    buffer_load_dwordx4 v8, s[52:55], s10 offen offset:1024 sc1 lds
    s_mov_b32 s85, 0
    s_cmp_le_u32 s86, s89
    s_cbranch_scc1 A_nom_112
    s_add_u32 s6, s89, 1
    s_lshr_b32 s7, s6, 6
    s_lshr_b32 s6, s89, 2
    s_add_u32 s6, s6, s7
    s_lshl_b32 s6, s6, 5
    s_add_u32 s6, s6, s3
    s_lshl_b32 s7, s6, 13
    s_bfe_u32 s6, s89, 0x10001
    s_lshl_b32 s12, s6, 12
    s_add_u32 s12, s12, s7
    s_lshl_b32 s8, s4, 10
    s_add_u32 s12, s12, s8
    s_add_u32 s12, s12, 67108864
    s_add_u32 s9, s8, 90112
    s_mov_b32 m0, s9
    s_lshl_b32 s8, s4, 11
    buffer_load_dwordx4 v8, s[52:55], s12 offen sc1 lds
    s_add_u32 s9, s8, 94208
    s_mov_b32 m0, s9
    s_add_u32 s13, s7, s8
    s_add_u32 s13, s13, 83886080
    buffer_load_dwordx4 v8, s[52:55], s13 offen sc1 lds
    buffer_load_dwordx4 v8, s[52:55], s13 offen offset:1024 sc1 lds
    s_mov_b32 s85, 1
A_nom_112:
    s_mov_b32 s6, s87
    s_lshl_b32 s6, s90, 20
    s_lshl_b32 s7, s3, 10
    s_add_u32 s6, s6, s7
    s_add_u32 s6, s6, 100663296
    s_waitcnt lgkmcnt(7)
    v_mfma_f32_32x32x16_bf16 v[140:155], a[0:3], v[16:19], 0
    s_waitcnt lgkmcnt(6)
    v_mfma_f32_32x32x16_bf16 v[140:155], a[4:7], v[20:23], v[140:155]
    s_waitcnt lgkmcnt(5)
    v_mfma_f32_32x32x16_bf16 v[140:155], a[8:11], v[24:27], v[140:155]
    s_waitcnt lgkmcnt(4)
    v_mfma_f32_32x32x16_bf16 v[140:155], a[12:15], v[28:31], v[140:155]
    s_waitcnt lgkmcnt(3)
    v_mfma_f32_32x32x16_bf16 v[140:155], a[16:19], v[32:35], v[140:155]
    s_waitcnt lgkmcnt(2)
    v_mfma_f32_32x32x16_bf16 v[140:155], a[20:23], v[36:39], v[140:155]
    s_waitcnt lgkmcnt(1)
    v_mfma_f32_32x32x16_bf16 v[140:155], a[24:27], v[40:43], v[140:155]
    s_waitcnt lgkmcnt(0)
    v_mfma_f32_32x32x16_bf16 v[140:155], a[28:31], v[44:47], v[140:155]
    v_mfma_f32_32x32x16_bf16 v[156:171], a[32:35], v[16:19], 0
    v_mfma_f32_32x32x16_bf16 v[156:171], a[36:39], v[20:23], v[156:171]
    v_mfma_f32_32x32x16_bf16 v[156:171], a[40:43], v[24:27], v[156:171]
    v_mfma_f32_32x32x16_bf16 v[156:171], a[44:47], v[28:31], v[156:171]
    v_mfma_f32_32x32x16_bf16 v[156:171], a[48:51], v[32:35], v[156:171]
    v_mfma_f32_32x32x16_bf16 v[156:171], a[52:55], v[36:39], v[156:171]
    v_mfma_f32_32x32x16_bf16 v[156:171], a[56:59], v[40:43], v[156:171]
    v_mfma_f32_32x32x16_bf16 v[156:171], a[60:63], v[44:47], v[156:171]
    v_mfma_f32_32x32x16_bf16 v[172:187], a[64:67], v[16:19], 0
    v_mfma_f32_32x32x16_bf16 v[172:187], a[68:71], v[20:23], v[172:187]
    v_mfma_f32_32x32x16_bf16 v[172:187], a[72:75], v[24:27], v[172:187]
    v_mfma_f32_32x32x16_bf16 v[172:187], a[76:79], v[28:31], v[172:187]
    v_mfma_f32_32x32x16_bf16 v[172:187], a[80:83], v[32:35], v[172:187]
    v_mfma_f32_32x32x16_bf16 v[172:187], a[84:87], v[36:39], v[172:187]
    v_mfma_f32_32x32x16_bf16 v[172:187], a[88:91], v[40:43], v[172:187]
    v_mfma_f32_32x32x16_bf16 v[172:187], a[92:95], v[44:47], v[172:187]
    v_mfma_f32_32x32x16_bf16 v[188:203], a[96:99], v[16:19], 0
    v_mfma_f32_32x32x16_bf16 v[188:203], a[100:103], v[20:23], v[188:203]
    v_mfma_f32_32x32x16_bf16 v[188:203], a[104:107], v[24:27], v[188:203]
    v_mfma_f32_32x32x16_bf16 v[188:203], a[108:111], v[28:31], v[188:203]
    v_mfma_f32_32x32x16_bf16 v[188:203], a[112:115], v[32:35], v[188:203]
    v_mfma_f32_32x32x16_bf16 v[188:203], a[116:119], v[36:39], v[188:203]
    v_mfma_f32_32x32x16_bf16 v[188:203], a[120:123], v[40:43], v[188:203]
    v_mfma_f32_32x32x16_bf16 v[188:203], a[124:127], v[44:47], v[188:203]
    v_and_b32 v135, 31, v1
    v_mul_u32_u24 v135, 1040, v135
    v_lshl_add_u32 v135, v6, 4, v135
    s_lshl_b32 s7, s4, 8
    v_add_u32 v135, s7, v135
    s_mul_i32 s7, s4, 8320
    v_add_u32 v136, s7, v8
    s_lshl_b32 s7, s4, 18
    s_add_u32 s6, s6, s7
    v_cvt_pk_bf16_f32 v140, v140, v141
    v_cvt_pk_bf16_f32 v141, v142, v143
    v_cvt_pk_bf16_f32 v142, v144, v145
    v_cvt_pk_bf16_f32 v143, v146, v147
    ds_write_b128 v135, v[140:143] offset:16384
    v_cvt_pk_bf16_f32 v148, v148, v149
    v_cvt_pk_bf16_f32 v149, v150, v151
    v_cvt_pk_bf16_f32 v150, v152, v153
    v_cvt_pk_bf16_f32 v151, v154, v155
    ds_write_b128 v135, v[148:151] offset:16416
    v_cvt_pk_bf16_f32 v156, v156, v157
    v_cvt_pk_bf16_f32 v157, v158, v159
    v_cvt_pk_bf16_f32 v158, v160, v161
    v_cvt_pk_bf16_f32 v159, v162, v163
    ds_write_b128 v135, v[156:159] offset:16448
    v_cvt_pk_bf16_f32 v164, v164, v165
    v_cvt_pk_bf16_f32 v165, v166, v167
    v_cvt_pk_bf16_f32 v166, v168, v169
    v_cvt_pk_bf16_f32 v167, v170, v171
    ds_write_b128 v135, v[164:167] offset:16480
    v_cvt_pk_bf16_f32 v172, v172, v173
    v_cvt_pk_bf16_f32 v173, v174, v175
    v_cvt_pk_bf16_f32 v174, v176, v177
    v_cvt_pk_bf16_f32 v175, v178, v179
    ds_write_b128 v135, v[172:175] offset:16512
    v_cvt_pk_bf16_f32 v180, v180, v181
    v_cvt_pk_bf16_f32 v181, v182, v183
    v_cvt_pk_bf16_f32 v182, v184, v185
    v_cvt_pk_bf16_f32 v183, v186, v187
    ds_write_b128 v135, v[180:183] offset:16544
    v_cvt_pk_bf16_f32 v188, v188, v189
    v_cvt_pk_bf16_f32 v189, v190, v191
    v_cvt_pk_bf16_f32 v190, v192, v193
    v_cvt_pk_bf16_f32 v191, v194, v195
    ds_write_b128 v135, v[188:191] offset:16576
    v_cvt_pk_bf16_f32 v196, v196, v197
    v_cvt_pk_bf16_f32 v197, v198, v199
    v_cvt_pk_bf16_f32 v198, v200, v201
    v_cvt_pk_bf16_f32 v199, v202, v203
    ds_write_b128 v135, v[196:199] offset:16608
    s_waitcnt lgkmcnt(0)
    s_barrier
    ds_read_b128 v[140:143], v136 offset:16384
    ds_read_b128 v[144:147], v136 offset:17424
    ds_read_b128 v[148:151], v136 offset:18464
    ds_read_b128 v[152:155], v136 offset:19504
    ds_read_b128 v[156:159], v136 offset:20544
    ds_read_b128 v[160:163], v136 offset:21584
    ds_read_b128 v[164:167], v136 offset:22624
    ds_read_b128 v[168:171], v136 offset:23664
    s_waitcnt lgkmcnt(7)
    buffer_store_dwordx4 v[140:143], v8, s[52:55], s6 offen sc1
    s_add_u32 s6, s6, 32768
    s_waitcnt lgkmcnt(6)
    buffer_store_dwordx4 v[144:147], v8, s[52:55], s6 offen sc1
    s_add_u32 s6, s6, 32768
    s_waitcnt lgkmcnt(5)
    buffer_store_dwordx4 v[148:151], v8, s[52:55], s6 offen sc1
    s_add_u32 s6, s6, 32768
    s_waitcnt lgkmcnt(4)
    buffer_store_dwordx4 v[152:155], v8, s[52:55], s6 offen sc1
    s_add_u32 s6, s6, 32768
    s_waitcnt lgkmcnt(3)
    buffer_store_dwordx4 v[156:159], v8, s[52:55], s6 offen sc1
    s_add_u32 s6, s6, 32768
    s_waitcnt lgkmcnt(2)
    buffer_store_dwordx4 v[160:163], v8, s[52:55], s6 offen sc1
    s_add_u32 s6, s6, 32768
    s_waitcnt lgkmcnt(1)
    buffer_store_dwordx4 v[164:167], v8, s[52:55], s6 offen sc1
    s_add_u32 s6, s6, 32768
    s_waitcnt lgkmcnt(0)
    buffer_store_dwordx4 v[168:171], v8, s[52:55], s6 offen sc1
    s_add_u32 s6, s6, 32768
    s_waitcnt vmcnt(0)
    s_barrier
    s_lshl_b32 s98, s90, 7
    s_add_u32 s98, s98, s88
    s_cmp_lg_u32 s4, 0
    s_cbranch_scc1 FS_116
    s_mov_b64 exec, 1
    v_mov_b32 v137, s91
    buffer_store_dword v137, off, s[52:55], s98 sc1
    s_mov_b64 exec, -1
FS_116:
    s_add_u32 s90, s90, 2
    s_cmp_lt_u32 s90, 64
    s_cbranch_scc1 A_loop_108
    s_branch mega_kernel_exit
W_n_67:
    s_sub_u32 s3, s100, 200
    v_and_b32 v1, 63, v0
    v_and_b32 v2, 15, v1
    v_lshrrev_b32 v3, 4, v1
    v_lshrrev_b32 v4, 2, v2
    v_and_b32 v5, 3, v2
    v_lshrrev_b32 v6, 1, v3
    v_and_b32 v7, 1, v3
    v_lshlrev_b32 v8, 4, v1
    s_mov_b32 s56, s16
    s_and_b32 s57, s17, 0xffff
    s_mov_b32 s58, 0x200000
    s_mov_b32 s59, 0x00020000
    v_lshrrev_b32 v120, 1, v1
    v_lshlrev_b32 v120, 4, v120
    v_and_b32 v121, 1, v1
    v_lshl_add_u32 v120, v121, 2, v120
    v_lshlrev_b32 v121, 2, v120
    v_lshlrev_b32 v120, 1, v120
    s_mov_b32 s6, 200704
    buffer_load_dwordx4 v[96:99], v121, s[52:55], s6 offen sc1
    buffer_load_dwordx4 v[100:103], v121, s[52:55], s6 offen offset:32 sc1
    s_mov_b32 s6, 204800
    buffer_load_dwordx4 v[104:107], v121, s[52:55], s6 offen sc1
    buffer_load_dwordx4 v[108:111], v121, s[52:55], s6 offen offset:32 sc1
    s_mov_b32 s6, 202752
    buffer_load_dwordx4 v[112:115], v121, s[52:55], s6 offen sc1
    buffer_load_dwordx4 v[116:119], v121, s[52:55], s6 offen offset:32 sc1
    s_lshl_b32 s6, s3, 2
    s_add_u32 s6, s6, s4
    s_and_b32 s92, s6, 31
    s_lshr_b32 s90, s6, 5
    s_lshl_b32 s7, s92, 2
    s_add_u32 s88, s7, 24576
    v_lshlrev_b32 v122, 2, v1
    v_and_b32 v122, 127, v122
    v_lshlrev_b32 v125, 13, v1
    s_lshl_b32 s7, s4, 14
    v_add_u32 v126, s7, v8
    v_mov_b32 v123, 0x00003f80
    v_mov_b32 v124, 0x3f800000
N_loop_117:
    s_add_u32 s91, s90, 1
    s_lshl_b32 s97, s90, 7
    s_add_u32 s99, s97, s88
    s_add_u32 s97, s97, 16384
    s_lshl_b32 s93, s90, 5
    s_add_u32 s93, s93, s92
    s_lshl_b32 s8, s93, 10
    buffer_load_dwordx2 v[90:91], v120, s[56:59], s8 offen
    buffer_load_dwordx2 v[92:93], v120, s[56:59], s8 offen offset:16
    s_cmp_lg_u32 s4, 0
    s_cbranch_scc1 WFW_118
FW_119:
    buffer_load_dword v88, v122, s[52:55], s97 offen sc1
    s_add_u32 s79, s79, 1
    s_cmp_gt_u32 s79, 2097152
    s_cbranch_scc1 mega_kernel_exit
    s_waitcnt vmcnt(0)
    v_cmp_gt_u32 vcc, s91, v88
    s_nop 0
    s_cbranch_vccz FWok_120
    s_sleep 2
    s_branch FW_119
FWok_120:
WFW_118:
    s_barrier
    s_lshl_b32 s6, s93, 15
    s_add_u32 s6, s6, 100663296
    buffer_load_dwordx4 v[16:19], v8, s[52:55], s6 offen offset:0 sc1
    buffer_load_dwordx4 v[20:23], v8, s[52:55], s6 offen offset:1024 sc1
    buffer_load_dwordx4 v[24:27], v8, s[52:55], s6 offen offset:2048 sc1
    buffer_load_dwordx4 v[28:31], v8, s[52:55], s6 offen offset:3072 sc1
    s_add_u32 s6, s6, 4096
    buffer_load_dwordx4 v[32:35], v8, s[52:55], s6 offen offset:0 sc1
    buffer_load_dwordx4 v[36:39], v8, s[52:55], s6 offen offset:1024 sc1
    buffer_load_dwordx4 v[40:43], v8, s[52:55], s6 offen offset:2048 sc1
    buffer_load_dwordx4 v[44:47], v8, s[52:55], s6 offen offset:3072 sc1
    s_add_u32 s6, s6, 4096
    buffer_load_dwordx4 v[48:51], v8, s[52:55], s6 offen offset:0 sc1
    buffer_load_dwordx4 v[52:55], v8, s[52:55], s6 offen offset:1024 sc1
    buffer_load_dwordx4 v[56:59], v8, s[52:55], s6 offen offset:2048 sc1
    buffer_load_dwordx4 v[60:63], v8, s[52:55], s6 offen offset:3072 sc1
    s_add_u32 s6, s6, 4096
    buffer_load_dwordx4 v[64:67], v8, s[52:55], s6 offen offset:0 sc1
    buffer_load_dwordx4 v[68:71], v8, s[52:55], s6 offen offset:1024 sc1
    buffer_load_dwordx4 v[72:75], v8, s[52:55], s6 offen offset:2048 sc1
    buffer_load_dwordx4 v[76:79], v8, s[52:55], s6 offen offset:3072 sc1
    s_add_u32 s6, s6, 4096
    s_lshl_b32 s7, s4, 14
    s_mov_b32 m0, s7
    s_add_u32 s7, s7, 4096
    buffer_load_dwordx4 v8, s[52:55], s6 offen offset:0 sc1 lds
    buffer_load_dwordx4 v8, s[52:55], s6 offen offset:1024 sc1 lds
    buffer_load_dwordx4 v8, s[52:55], s6 offen offset:2048 sc1 lds
    buffer_load_dwordx4 v8, s[52:55], s6 offen offset:3072 sc1 lds
    s_add_u32 s6, s6, 4096
    s_mov_b32 m0, s7
    s_add_u32 s7, s7, 4096
    buffer_load_dwordx4 v8, s[52:55], s6 offen offset:0 sc1 lds
    buffer_load_dwordx4 v8, s[52:55], s6 offen offset:1024 sc1 lds
    buffer_load_dwordx4 v8, s[52:55], s6 offen offset:2048 sc1 lds
    buffer_load_dwordx4 v8, s[52:55], s6 offen offset:3072 sc1 lds
    s_add_u32 s6, s6, 4096
    s_mov_b32 m0, s7
    s_add_u32 s7, s7, 4096
    buffer_load_dwordx4 v8, s[52:55], s6 offen offset:0 sc1 lds
    buffer_load_dwordx4 v8, s[52:55], s6 offen offset:1024 sc1 lds
    buffer_load_dwordx4 v8, s[52:55], s6 offen offset:2048 sc1 lds
    buffer_load_dwordx4 v8, s[52:55], s6 offen offset:3072 sc1 lds
    s_add_u32 s6, s6, 4096
    s_mov_b32 m0, s7
    s_add_u32 s7, s7, 4096
    buffer_load_dwordx4 v8, s[52:55], s6 offen offset:0 sc1 lds
    buffer_load_dwordx4 v8, s[52:55], s6 offen offset:1024 sc1 lds
    buffer_load_dwordx4 v8, s[52:55], s6 offen offset:2048 sc1 lds
    buffer_load_dwordx4 v8, s[52:55], s6 offen offset:3072 sc1 lds
    s_add_u32 s6, s6, 4096
    v_mov_b64 v[80:81], 0
    v_mov_b64 v[82:83], 0
    v_mov_b64 v[84:85], 0
    v_mov_b64 v[86:87], 0
    s_waitcnt vmcnt(31)
    v_dot2c_f32_bf16 v80, v16, v123
    v_dot2c_f32_bf16 v81, v16, v124
    v_dot2c_f32_bf16 v82, v17, v123
    v_dot2c_f32_bf16 v83, v17, v124
    v_dot2c_f32_bf16 v84, v18, v123
    v_dot2c_f32_bf16 v85, v18, v124
    v_dot2c_f32_bf16 v86, v19, v123
    v_dot2c_f32_bf16 v87, v19, v124
    s_waitcnt vmcnt(30)
    v_dot2c_f32_bf16 v80, v20, v123
    v_dot2c_f32_bf16 v81, v20, v124
    v_dot2c_f32_bf16 v82, v21, v123
    v_dot2c_f32_bf16 v83, v21, v124
    v_dot2c_f32_bf16 v84, v22, v123
    v_dot2c_f32_bf16 v85, v22, v124
    v_dot2c_f32_bf16 v86, v23, v123
    v_dot2c_f32_bf16 v87, v23, v124
    s_waitcnt vmcnt(29)
    v_dot2c_f32_bf16 v80, v24, v123
    v_dot2c_f32_bf16 v81, v24, v124
    v_dot2c_f32_bf16 v82, v25, v123
    v_dot2c_f32_bf16 v83, v25, v124
    v_dot2c_f32_bf16 v84, v26, v123
    v_dot2c_f32_bf16 v85, v26, v124
    v_dot2c_f32_bf16 v86, v27, v123
    v_dot2c_f32_bf16 v87, v27, v124
    s_waitcnt vmcnt(28)
    v_dot2c_f32_bf16 v80, v28, v123
    v_dot2c_f32_bf16 v81, v28, v124
    v_dot2c_f32_bf16 v82, v29, v123
    v_dot2c_f32_bf16 v83, v29, v124
    v_dot2c_f32_bf16 v84, v30, v123
    v_dot2c_f32_bf16 v85, v30, v124
    v_dot2c_f32_bf16 v86, v31, v123
    v_dot2c_f32_bf16 v87, v31, v124
    s_waitcnt vmcnt(27)
    v_dot2c_f32_bf16 v80, v32, v123
    v_dot2c_f32_bf16 v81, v32, v124
    v_dot2c_f32_bf16 v82, v33, v123
    v_dot2c_f32_bf16 v83, v33, v124
    v_dot2c_f32_bf16 v84, v34, v123
    v_dot2c_f32_bf16 v85, v34, v124
    v_dot2c_f32_bf16 v86, v35, v123
    v_dot2c_f32_bf16 v87, v35, v124
    s_waitcnt vmcnt(26)
    v_dot2c_f32_bf16 v80, v36, v123
    v_dot2c_f32_bf16 v81, v36, v124
    v_dot2c_f32_bf16 v82, v37, v123
    v_dot2c_f32_bf16 v83, v37, v124
    v_dot2c_f32_bf16 v84, v38, v123
    v_dot2c_f32_bf16 v85, v38, v124
    v_dot2c_f32_bf16 v86, v39, v123
    v_dot2c_f32_bf16 v87, v39, v124
    s_waitcnt vmcnt(25)
    v_dot2c_f32_bf16 v80, v40, v123
    v_dot2c_f32_bf16 v81, v40, v124
    v_dot2c_f32_bf16 v82, v41, v123
    v_dot2c_f32_bf16 v83, v41, v124
    v_dot2c_f32_bf16 v84, v42, v123
    v_dot2c_f32_bf16 v85, v42, v124
    v_dot2c_f32_bf16 v86, v43, v123
    v_dot2c_f32_bf16 v87, v43, v124
    s_waitcnt vmcnt(24)
    v_dot2c_f32_bf16 v80, v44, v123
    v_dot2c_f32_bf16 v81, v44, v124
    v_dot2c_f32_bf16 v82, v45, v123
    v_dot2c_f32_bf16 v83, v45, v124
    v_dot2c_f32_bf16 v84, v46, v123
    v_dot2c_f32_bf16 v85, v46, v124
    v_dot2c_f32_bf16 v86, v47, v123
    v_dot2c_f32_bf16 v87, v47, v124
    s_waitcnt vmcnt(23)
    v_dot2c_f32_bf16 v80, v48, v123
    v_dot2c_f32_bf16 v81, v48, v124
    v_dot2c_f32_bf16 v82, v49, v123
    v_dot2c_f32_bf16 v83, v49, v124
    v_dot2c_f32_bf16 v84, v50, v123
    v_dot2c_f32_bf16 v85, v50, v124
    v_dot2c_f32_bf16 v86, v51, v123
    v_dot2c_f32_bf16 v87, v51, v124
    s_waitcnt vmcnt(22)
    v_dot2c_f32_bf16 v80, v52, v123
    v_dot2c_f32_bf16 v81, v52, v124
    v_dot2c_f32_bf16 v82, v53, v123
    v_dot2c_f32_bf16 v83, v53, v124
    v_dot2c_f32_bf16 v84, v54, v123
    v_dot2c_f32_bf16 v85, v54, v124
    v_dot2c_f32_bf16 v86, v55, v123
    v_dot2c_f32_bf16 v87, v55, v124
    s_waitcnt vmcnt(21)
    v_dot2c_f32_bf16 v80, v56, v123
    v_dot2c_f32_bf16 v81, v56, v124
    v_dot2c_f32_bf16 v82, v57, v123
    v_dot2c_f32_bf16 v83, v57, v124
    v_dot2c_f32_bf16 v84, v58, v123
    v_dot2c_f32_bf16 v85, v58, v124
    v_dot2c_f32_bf16 v86, v59, v123
    v_dot2c_f32_bf16 v87, v59, v124
    s_waitcnt vmcnt(20)
    v_dot2c_f32_bf16 v80, v60, v123
    v_dot2c_f32_bf16 v81, v60, v124
    v_dot2c_f32_bf16 v82, v61, v123
    v_dot2c_f32_bf16 v83, v61, v124
    v_dot2c_f32_bf16 v84, v62, v123
    v_dot2c_f32_bf16 v85, v62, v124
    v_dot2c_f32_bf16 v86, v63, v123
    v_dot2c_f32_bf16 v87, v63, v124
    s_waitcnt vmcnt(19)
    v_dot2c_f32_bf16 v80, v64, v123
    v_dot2c_f32_bf16 v81, v64, v124
    v_dot2c_f32_bf16 v82, v65, v123
    v_dot2c_f32_bf16 v83, v65, v124
    v_dot2c_f32_bf16 v84, v66, v123
    v_dot2c_f32_bf16 v85, v66, v124
    v_dot2c_f32_bf16 v86, v67, v123
    v_dot2c_f32_bf16 v87, v67, v124
    s_waitcnt vmcnt(18)
    v_dot2c_f32_bf16 v80, v68, v123
    v_dot2c_f32_bf16 v81, v68, v124
    v_dot2c_f32_bf16 v82, v69, v123
    v_dot2c_f32_bf16 v83, v69, v124
    v_dot2c_f32_bf16 v84, v70, v123
    v_dot2c_f32_bf16 v85, v70, v124
    v_dot2c_f32_bf16 v86, v71, v123
    v_dot2c_f32_bf16 v87, v71, v124
    s_waitcnt vmcnt(17)
    v_dot2c_f32_bf16 v80, v72, v123
    v_dot2c_f32_bf16 v81, v72, v124
    v_dot2c_f32_bf16 v82, v73, v123
    v_dot2c_f32_bf16 v83, v73, v124
    v_dot2c_f32_bf16 v84, v74, v123
    v_dot2c_f32_bf16 v85, v74, v124
    v_dot2c_f32_bf16 v86, v75, v123
    v_dot2c_f32_bf16 v87, v75, v124
    s_waitcnt vmcnt(16)
    v_dot2c_f32_bf16 v80, v76, v123
    v_dot2c_f32_bf16 v81, v76, v124
    v_dot2c_f32_bf16 v82, v77, v123
    v_dot2c_f32_bf16 v83, v77, v124
    v_dot2c_f32_bf16 v84, v78, v123
    v_dot2c_f32_bf16 v85, v78, v124
    v_dot2c_f32_bf16 v86, v79, v123
    v_dot2c_f32_bf16 v87, v79, v124
    s_waitcnt vmcnt(0)
    ds_read_b128 v[16:19], v126 offset:0
    ds_read_b128 v[20:23], v126 offset:1024
    ds_read_b128 v[24:27], v126 offset:2048
    ds_read_b128 v[28:31], v126 offset:3072
    ds_read_b128 v[32:35], v126 offset:4096
    ds_read_b128 v[36:39], v126 offset:5120
    ds_read_b128 v[40:43], v126 offset:6144
    ds_read_b128 v[44:47], v126 offset:7168
    ds_read_b128 v[48:51], v126 offset:8192
    ds_read_b128 v[52:55], v126 offset:9216
    ds_read_b128 v[56:59], v126 offset:10240
    ds_read_b128 v[60:63], v126 offset:11264
    ds_read_b128 v[64:67], v126 offset:12288
    ds_read_b128 v[68:71], v126 offset:13312
    ds_read_b128 v[72:75], v126 offset:14336
    ds_read_b128 v[76:79], v126 offset:15360
    s_waitcnt lgkmcnt(15)
    v_dot2c_f32_bf16 v80, v16, v123
    v_dot2c_f32_bf16 v81, v16, v124
    v_dot2c_f32_bf16 v82, v17, v123
    v_dot2c_f32_bf16 v83, v17, v124
    v_dot2c_f32_bf16 v84, v18, v123
    v_dot2c_f32_bf16 v85, v18, v124
    v_dot2c_f32_bf16 v86, v19, v123
    v_dot2c_f32_bf16 v87, v19, v124
    s_waitcnt lgkmcnt(14)
    v_dot2c_f32_bf16 v80, v20, v123
    v_dot2c_f32_bf16 v81, v20, v124
    v_dot2c_f32_bf16 v82, v21, v123
    v_dot2c_f32_bf16 v83, v21, v124
    v_dot2c_f32_bf16 v84, v22, v123
    v_dot2c_f32_bf16 v85, v22, v124
    v_dot2c_f32_bf16 v86, v23, v123
    v_dot2c_f32_bf16 v87, v23, v124
    s_waitcnt lgkmcnt(13)
    v_dot2c_f32_bf16 v80, v24, v123
    v_dot2c_f32_bf16 v81, v24, v124
    v_dot2c_f32_bf16 v82, v25, v123
    v_dot2c_f32_bf16 v83, v25, v124
    v_dot2c_f32_bf16 v84, v26, v123
    v_dot2c_f32_bf16 v85, v26, v124
    v_dot2c_f32_bf16 v86, v27, v123
    v_dot2c_f32_bf16 v87, v27, v124
    s_waitcnt lgkmcnt(12)
    v_dot2c_f32_bf16 v80, v28, v123
    v_dot2c_f32_bf16 v81, v28, v124
    v_dot2c_f32_bf16 v82, v29, v123
    v_dot2c_f32_bf16 v83, v29, v124
    v_dot2c_f32_bf16 v84, v30, v123
    v_dot2c_f32_bf16 v85, v30, v124
    v_dot2c_f32_bf16 v86, v31, v123
    v_dot2c_f32_bf16 v87, v31, v124
    s_waitcnt lgkmcnt(11)
    v_dot2c_f32_bf16 v80, v32, v123
    v_dot2c_f32_bf16 v81, v32, v124
    v_dot2c_f32_bf16 v82, v33, v123
    v_dot2c_f32_bf16 v83, v33, v124
    v_dot2c_f32_bf16 v84, v34, v123
    v_dot2c_f32_bf16 v85, v34, v124
    v_dot2c_f32_bf16 v86, v35, v123
    v_dot2c_f32_bf16 v87, v35, v124
    s_waitcnt lgkmcnt(10)
    v_dot2c_f32_bf16 v80, v36, v123
    v_dot2c_f32_bf16 v81, v36, v124
    v_dot2c_f32_bf16 v82, v37, v123
    v_dot2c_f32_bf16 v83, v37, v124
    v_dot2c_f32_bf16 v84, v38, v123
    v_dot2c_f32_bf16 v85, v38, v124
    v_dot2c_f32_bf16 v86, v39, v123
    v_dot2c_f32_bf16 v87, v39, v124
    s_waitcnt lgkmcnt(9)
    v_dot2c_f32_bf16 v80, v40, v123
    v_dot2c_f32_bf16 v81, v40, v124
    v_dot2c_f32_bf16 v82, v41, v123
    v_dot2c_f32_bf16 v83, v41, v124
    v_dot2c_f32_bf16 v84, v42, v123
    v_dot2c_f32_bf16 v85, v42, v124
    v_dot2c_f32_bf16 v86, v43, v123
    v_dot2c_f32_bf16 v87, v43, v124
    s_waitcnt lgkmcnt(8)
    v_dot2c_f32_bf16 v80, v44, v123
    v_dot2c_f32_bf16 v81, v44, v124
    v_dot2c_f32_bf16 v82, v45, v123
    v_dot2c_f32_bf16 v83, v45, v124
    v_dot2c_f32_bf16 v84, v46, v123
    v_dot2c_f32_bf16 v85, v46, v124
    v_dot2c_f32_bf16 v86, v47, v123
    v_dot2c_f32_bf16 v87, v47, v124
    s_waitcnt lgkmcnt(7)
    v_dot2c_f32_bf16 v80, v48, v123
    v_dot2c_f32_bf16 v81, v48, v124
    v_dot2c_f32_bf16 v82, v49, v123
    v_dot2c_f32_bf16 v83, v49, v124
    v_dot2c_f32_bf16 v84, v50, v123
    v_dot2c_f32_bf16 v85, v50, v124
    v_dot2c_f32_bf16 v86, v51, v123
    v_dot2c_f32_bf16 v87, v51, v124
    s_waitcnt lgkmcnt(6)
    v_dot2c_f32_bf16 v80, v52, v123
    v_dot2c_f32_bf16 v81, v52, v124
    v_dot2c_f32_bf16 v82, v53, v123
    v_dot2c_f32_bf16 v83, v53, v124
    v_dot2c_f32_bf16 v84, v54, v123
    v_dot2c_f32_bf16 v85, v54, v124
    v_dot2c_f32_bf16 v86, v55, v123
    v_dot2c_f32_bf16 v87, v55, v124
    s_waitcnt lgkmcnt(5)
    v_dot2c_f32_bf16 v80, v56, v123
    v_dot2c_f32_bf16 v81, v56, v124
    v_dot2c_f32_bf16 v82, v57, v123
    v_dot2c_f32_bf16 v83, v57, v124
    v_dot2c_f32_bf16 v84, v58, v123
    v_dot2c_f32_bf16 v85, v58, v124
    v_dot2c_f32_bf16 v86, v59, v123
    v_dot2c_f32_bf16 v87, v59, v124
    s_waitcnt lgkmcnt(4)
    v_dot2c_f32_bf16 v80, v60, v123
    v_dot2c_f32_bf16 v81, v60, v124
    v_dot2c_f32_bf16 v82, v61, v123
    v_dot2c_f32_bf16 v83, v61, v124
    v_dot2c_f32_bf16 v84, v62, v123
    v_dot2c_f32_bf16 v85, v62, v124
    v_dot2c_f32_bf16 v86, v63, v123
    v_dot2c_f32_bf16 v87, v63, v124
    s_waitcnt lgkmcnt(3)
    v_dot2c_f32_bf16 v80, v64, v123
    v_dot2c_f32_bf16 v81, v64, v124
    v_dot2c_f32_bf16 v82, v65, v123
    v_dot2c_f32_bf16 v83, v65, v124
    v_dot2c_f32_bf16 v84, v66, v123
    v_dot2c_f32_bf16 v85, v66, v124
    v_dot2c_f32_bf16 v86, v67, v123
    v_dot2c_f32_bf16 v87, v67, v124
    s_waitcnt lgkmcnt(2)
    v_dot2c_f32_bf16 v80, v68, v123
    v_dot2c_f32_bf16 v81, v68, v124
    v_dot2c_f32_bf16 v82, v69, v123
    v_dot2c_f32_bf16 v83, v69, v124
    v_dot2c_f32_bf16 v84, v70, v123
    v_dot2c_f32_bf16 v85, v70, v124
    v_dot2c_f32_bf16 v86, v71, v123
    v_dot2c_f32_bf16 v87, v71, v124
    s_waitcnt lgkmcnt(1)
    v_dot2c_f32_bf16 v80, v72, v123
    v_dot2c_f32_bf16 v81, v72, v124
    v_dot2c_f32_bf16 v82, v73, v123
    v_dot2c_f32_bf16 v83, v73, v124
    v_dot2c_f32_bf16 v84, v74, v123
    v_dot2c_f32_bf16 v85, v74, v124
    v_dot2c_f32_bf16 v86, v75, v123
    v_dot2c_f32_bf16 v87, v75, v124
    s_waitcnt lgkmcnt(0)
    v_dot2c_f32_bf16 v80, v76, v123
    v_dot2c_f32_bf16 v81, v76, v124
    v_dot2c_f32_bf16 v82, v77, v123
    v_dot2c_f32_bf16 v83, v77, v124
    v_dot2c_f32_bf16 v84, v78, v123
    v_dot2c_f32_bf16 v85, v78, v124
    v_dot2c_f32_bf16 v86, v79, v123
    v_dot2c_f32_bf16 v87, v79, v124
    s_nop 3
    v_lshlrev_b32 v24, 16, v90
    v_and_b32 v25, 0xffff0000, v90
    v_lshlrev_b32 v26, 16, v91
    v_and_b32 v27, 0xffff0000, v91
    v_lshlrev_b32 v28, 16, v92
    v_and_b32 v29, 0xffff0000, v92
    v_lshlrev_b32 v30, 16, v93
    v_and_b32 v31, 0xffff0000, v93
    v_fma_f32 v80, v80, v96, v24
    v_fma_f32 v81, v81, v97, v25
    v_fma_f32 v82, v82, v98, v26
    v_fma_f32 v83, v83, v99, v27
    v_fma_f32 v84, v84, v100, v28
    v_fma_f32 v85, v85, v101, v29
    v_fma_f32 v86, v86, v102, v30
    v_fma_f32 v87, v87, v103, v31
    v_cvt_pk_bf16_f32 v16, v80, v81
    v_cvt_pk_bf16_f32 v17, v82, v83
    v_cvt_pk_bf16_f32 v18, v84, v85
    v_cvt_pk_bf16_f32 v19, v86, v87
    s_add_u32 s9, s8, 3145728
    buffer_store_dwordx2 v[16:17], v120, s[52:55], s9 offen sc1
    buffer_store_dwordx2 v[18:19], v120, s[52:55], s9 offen offset:16 sc1
    v_lshlrev_b32 v80, 16, v16
    v_and_b32 v81, 0xffff0000, v16
    v_lshlrev_b32 v82, 16, v17
    v_and_b32 v83, 0xffff0000, v17
    v_lshlrev_b32 v84, 16, v18
    v_and_b32 v85, 0xffff0000, v18
    v_lshlrev_b32 v86, 16, v19
    v_and_b32 v87, 0xffff0000, v19
    v_add_f32 v94, v80, v81
    v_mul_f32 v95, v80, v80
    v_fmac_f32 v95, v81, v81
    v_add_f32 v94, v94, v82
    v_fmac_f32 v95, v82, v82
    v_add_f32 v94, v94, v83
    v_fmac_f32 v95, v83, v83
    v_add_f32 v94, v94, v84
    v_fmac_f32 v95, v84, v84
    v_add_f32 v94, v94, v85
    v_fmac_f32 v95, v85, v85
    v_add_f32 v94, v94, v86
    v_fmac_f32 v95, v86, v86
    v_add_f32 v94, v94, v87
    v_fmac_f32 v95, v87, v87
    s_nop 0
    v_add_f32_dpp v88, v94, v94 row_ror:8 row_mask:0xf bank_mask:0xf
    v_add_f32_dpp v89, v95, v95 row_ror:8 row_mask:0xf bank_mask:0xf
    v_mov_b32 v94, v88
    v_mov_b32 v95, v89
    s_nop 0
    v_add_f32_dpp v88, v94, v94 row_ror:4 row_mask:0xf bank_mask:0xf
    v_add_f32_dpp v89, v95, v95 row_ror:4 row_mask:0xf bank_mask:0xf
    v_mov_b32 v94, v88
    v_mov_b32 v95, v89
    s_nop 0
    v_add_f32_dpp v88, v94, v94 row_ror:2 row_mask:0xf bank_mask:0xf
    v_add_f32_dpp v89, v95, v95 row_ror:2 row_mask:0xf bank_mask:0xf
    v_mov_b32 v94, v88
    v_mov_b32 v95, v89
    s_nop 0
    v_add_f32_dpp v88, v94, v94 row_ror:1 row_mask:0xf bank_mask:0xf
    v_add_f32_dpp v89, v95, v95 row_ror:1 row_mask:0xf bank_mask:0xf
    v_mov_b32 v94, v88
    v_mov_b32 v95, v89
    s_nop 0
    v_permlane16_swap_b32 v94, v88
    v_permlane16_swap_b32 v95, v89
    v_add_f32 v94, v94, v88
    v_add_f32 v95, v95, v89
    v_mov_b32 v88, v94
    v_mov_b32 v89, v95
    s_nop 0
    v_permlane32_swap_b32 v94, v88
    v_permlane32_swap_b32 v95, v89
    v_add_f32 v94, v94, v88
    v_add_f32 v95, v95, v89
    v_mul_f32 v94, 0x3b000000, v94
    v_mul_f32 v95, 0x3b000000, v95
    v_fma_f32 v95, -v94, v94, v95
    v_max_f32 v95, 0, v95
    v_add_f32 v95, 0x3727c5ac, v95
    v_rsq_f32 v95, v95
    s_nop 0
    v_mul_f32 v94, v94, v95
    v_fma_f32 v80, v80, v95, -v94
    v_fma_f32 v81, v81, v95, -v94
    v_fma_f32 v82, v82, v95, -v94
    v_fma_f32 v83, v83, v95, -v94
    v_fma_f32 v84, v84, v95, -v94
    v_fma_f32 v85, v85, v95, -v94
    v_fma_f32 v86, v86, v95, -v94
    v_fma_f32 v87, v87, v95, -v94
    v_fma_f32 v80, v80, v104, v112
    v_fma_f32 v81, v81, v105, v113
    v_fma_f32 v82, v82, v106, v114
    v_fma_f32 v83, v83, v107, v115
    v_fma_f32 v84, v84, v108, v116
    v_fma_f32 v85, v85, v109, v117
    v_fma_f32 v86, v86, v110, v118
    v_fma_f32 v87, v87, v111, v119
    v_add_f32 v94, v80, v81
    v_mul_f32 v95, v80, v80
    v_fmac_f32 v95, v81, v81
    v_add_f32 v94, v94, v82
    v_fmac_f32 v95, v82, v82
    v_add_f32 v94, v94, v83
    v_fmac_f32 v95, v83, v83
    v_add_f32 v94, v94, v84
    v_fmac_f32 v95, v84, v84
    v_add_f32 v94, v94, v85
    v_fmac_f32 v95, v85, v85
    v_add_f32 v94, v94, v86
    v_fmac_f32 v95, v86, v86
    v_add_f32 v94, v94, v87
    v_fmac_f32 v95, v87, v87
    s_nop 0
    v_add_f32_dpp v88, v94, v94 row_ror:8 row_mask:0xf bank_mask:0xf
    v_add_f32_dpp v89, v95, v95 row_ror:8 row_mask:0xf bank_mask:0xf
    v_mov_b32 v94, v88
    v_mov_b32 v95, v89
    s_nop 0
    v_add_f32_dpp v88, v94, v94 row_ror:4 row_mask:0xf bank_mask:0xf
    v_add_f32_dpp v89, v95, v95 row_ror:4 row_mask:0xf bank_mask:0xf
    v_mov_b32 v94, v88
    v_mov_b32 v95, v89
    s_nop 0
    v_add_f32_dpp v88, v94, v94 row_ror:2 row_mask:0xf bank_mask:0xf
    v_add_f32_dpp v89, v95, v95 row_ror:2 row_mask:0xf bank_mask:0xf
    v_mov_b32 v94, v88
    v_mov_b32 v95, v89
    s_nop 0
    v_add_f32_dpp v88, v94, v94 row_ror:1 row_mask:0xf bank_mask:0xf
    v_add_f32_dpp v89, v95, v95 row_ror:1 row_mask:0xf bank_mask:0xf
    v_mov_b32 v94, v88
    v_mov_b32 v95, v89
    s_nop 0
    v_permlane16_swap_b32 v94, v88
    v_permlane16_swap_b32 v95, v89
    v_add_f32 v94, v94, v88
    v_add_f32 v95, v95, v89
    v_mov_b32 v88, v94
    v_mov_b32 v89, v95
    s_nop 0
    v_permlane32_swap_b32 v94, v88
    v_permlane32_swap_b32 v95, v89
    v_add_f32 v94, v94, v88
    v_add_f32 v95, v95, v89
    v_mul_f32 v94, 0x3b000000, v94
    v_mul_f32 v95, 0x3b000000, v95
    v_fma_f32 v95, -v94, v94, v95
    v_max_f32 v95, 0, v95
    v_add_f32 v95, 0x3727c5ac, v95
    v_rsq_f32 v95, v95
    s_nop 0
    v_mul_f32 v94, v94, v95
    v_fma_f32 v80, v80, v95, -v94
    v_fma_f32 v81, v81, v95, -v94
    v_fma_f32 v82, v82, v95, -v94
    v_fma_f32 v83, v83, v95, -v94
    v_fma_f32 v84, v84, v95, -v94
    v_fma_f32 v85, v85, v95, -v94
    v_fma_f32 v86, v86, v95, -v94
    v_fma_f32 v87, v87, v95, -v94
    v_cvt_pk_bf16_f32 v20, v80, v81
    v_cvt_pk_bf16_f32 v21, v82, v83
    v_cvt_pk_bf16_f32 v22, v84, v85
    v_cvt_pk_bf16_f32 v23, v86, v87
    s_add_u32 s9, s8, 5242880
    buffer_store_dwordx2 v[20:21], v120, s[52:55], s9 offen sc1
    buffer_store_dwordx2 v[22:23], v120, s[52:55], s9 offen offset:16 sc1
    v_mov_b32 v88, s91
    s_waitcnt vmcnt(0)
    s_mov_b64 exec, 15
    buffer_store_dword v88, v125, s[52:55], s99 offen sc1
    s_mov_b64 exec, -1
    s_add_u32 s90, s90, 3
    s_cmp_lt_u32 s90, 64
    s_cbranch_scc1 N_loop_117
    s_barrier
    s_branch W_g2_69
W_g1_66:
    s_sub_u32 s6, s100, 144
    s_cmp_ge_u32 s6, 64
    s_cbranch_scc1 W_nopf_121
    s_lshr_b32 s7, s6, 4
    s_cmp_eq_u32 s7, 0
    s_cselect_b32 s56, s26, s24
    s_cselect_b32 s57, s27, s25
    s_cmp_eq_u32 s7, 2
    s_cselect_b32 s56, s22, s56
    s_cselect_b32 s57, s23, s57
    s_cmp_eq_u32 s7, 3
    s_cselect_b32 s56, s20, s56
    s_cselect_b32 s57, s21, s57
    s_and_b32 s57, s57, 0xffff
    s_mov_b32 s58, 0x400000
    s_mov_b32 s59, 0x00020000
    s_and_b32 s6, s6, 15
    s_lshl_b32 s6, s6, 18
    v_lshlrev_b32 v1, 4, v0
    buffer_load_dwordx4 v[4:7], v1, s[56:59], s6 offen
    s_add_u32 s6, s6, 4096
    buffer_load_dwordx4 v[8:11], v1, s[56:59], s6 offen
    s_add_u32 s6, s6, 4096
    buffer_load_dwordx4 v[12:15], v1, s[56:59], s6 offen
    s_add_u32 s6, s6, 4096
    buffer_load_dwordx4 v[16:19], v1, s[56:59], s6 offen
    s_add_u32 s6, s6, 4096
    buffer_load_dwordx4 v[20:23], v1, s[56:59], s6 offen
    s_add_u32 s6, s6, 4096
    buffer_load_dwordx4 v[24:27], v1, s[56:59], s6 offen
    s_add_u32 s6, s6, 4096
    buffer_load_dwordx4 v[28:31], v1, s[56:59], s6 offen
    s_add_u32 s6, s6, 4096
    buffer_load_dwordx4 v[32:35], v1, s[56:59], s6 offen
    s_add_u32 s6, s6, 4096
    buffer_load_dwordx4 v[36:39], v1, s[56:59], s6 offen
    s_add_u32 s6, s6, 4096
    buffer_load_dwordx4 v[40:43], v1, s[56:59], s6 offen
    s_add_u32 s6, s6, 4096
    buffer_load_dwordx4 v[44:47], v1, s[56:59], s6 offen
    s_add_u32 s6, s6, 4096
    buffer_load_dwordx4 v[48:51], v1, s[56:59], s6 offen
    s_add_u32 s6, s6, 4096
    buffer_load_dwordx4 v[52:55], v1, s[56:59], s6 offen
    s_add_u32 s6, s6, 4096
    buffer_load_dwordx4 v[56:59], v1, s[56:59], s6 offen
    s_add_u32 s6, s6, 4096
    buffer_load_dwordx4 v[60:63], v1, s[56:59], s6 offen
    s_add_u32 s6, s6, 4096
    buffer_load_dwordx4 v[64:67], v1, s[56:59], s6 offen
    s_add_u32 s6, s6, 4096
    buffer_load_dwordx4 v[68:71], v1, s[56:59], s6 offen
    s_add_u32 s6, s6, 4096
    buffer_load_dwordx4 v[72:75], v1, s[56:59], s6 offen
    s_add_u32 s6, s6, 4096
    buffer_load_dwordx4 v[76:79], v1, s[56:59], s6 offen
    s_add_u32 s6, s6, 4096
    buffer_load_dwordx4 v[80:83], v1, s[56:59], s6 offen
    s_add_u32 s6, s6, 4096
    buffer_load_dwordx4 v[84:87], v1, s[56:59], s6 offen
    s_add_u32 s6, s6, 4096
    buffer_load_dwordx4 v[88:91], v1, s[56:59], s6 offen
    s_add_u32 s6, s6, 4096
    buffer_load_dwordx4 v[92:95], v1, s[56:59], s6 offen
    s_add_u32 s6, s6, 4096
    buffer_load_dwordx4 v[96:99], v1, s[56:59], s6 offen
    s_add_u32 s6, s6, 4096
    buffer_load_dwordx4 v[100:103], v1, s[56:59], s6 offen
    s_add_u32 s6, s6, 4096
    buffer_load_dwordx4 v[104:107], v1, s[56:59], s6 offen
    s_add_u32 s6, s6, 4096
    buffer_load_dwordx4 v[108:111], v1, s[56:59], s6 offen
    s_add_u32 s6, s6, 4096
    buffer_load_dwordx4 v[112:115], v1, s[56:59], s6 offen
    s_add_u32 s6, s6, 4096
    buffer_load_dwordx4 v[116:119], v1, s[56:59], s6 offen
    s_add_u32 s6, s6, 4096
    buffer_load_dwordx4 v[120:123], v1, s[56:59], s6 offen
    s_add_u32 s6, s6, 4096
    buffer_load_dwordx4 v[124:127], v1, s[56:59], s6 offen
    s_add_u32 s6, s6, 4096
    buffer_load_dwordx4 v[128:131], v1, s[56:59], s6 offen
    s_add_u32 s6, s6, 4096
    buffer_load_dwordx4 v[4:7], v1, s[56:59], s6 offen
    s_add_u32 s6, s6, 4096
    buffer_load_dwordx4 v[8:11], v1, s[56:59], s6 offen
    s_add_u32 s6, s6, 4096
    buffer_load_dwordx4 v[12:15], v1, s[56:59], s6 offen
    s_add_u32 s6, s6, 4096
    buffer_load_dwordx4 v[16:19], v1, s[56:59], s6 offen
    s_add_u32 s6, s6, 4096
    buffer_load_dwordx4 v[20:23], v1, s[56:59], s6 offen
    s_add_u32 s6, s6, 4096
    buffer_load_dwordx4 v[24:27], v1, s[56:59], s6 offen
    s_add_u32 s6, s6, 4096
    buffer_load_dwordx4 v[28:31], v1, s[56:59], s6 offen
    s_add_u32 s6, s6, 4096
    buffer_load_dwordx4 v[32:35], v1, s[56:59], s6 offen
    s_add_u32 s6, s6, 4096
    buffer_load_dwordx4 v[36:39], v1, s[56:59], s6 offen
    s_add_u32 s6, s6, 4096
    buffer_load_dwordx4 v[40:43], v1, s[56:59], s6 offen
    s_add_u32 s6, s6, 4096
    buffer_load_dwordx4 v[44:47], v1, s[56:59], s6 offen
    s_add_u32 s6, s6, 4096
    buffer_load_dwordx4 v[48:51], v1, s[56:59], s6 offen
    s_add_u32 s6, s6, 4096
    buffer_load_dwordx4 v[52:55], v1, s[56:59], s6 offen
    s_add_u32 s6, s6, 4096
    buffer_load_dwordx4 v[56:59], v1, s[56:59], s6 offen
    s_add_u32 s6, s6, 4096
    buffer_load_dwordx4 v[60:63], v1, s[56:59], s6 offen
    s_add_u32 s6, s6, 4096
    buffer_load_dwordx4 v[64:67], v1, s[56:59], s6 offen
    s_add_u32 s6, s6, 4096
    s_waitcnt vmcnt(32)
    buffer_load_dwordx4 v[68:71], v1, s[56:59], s6 offen
    s_add_u32 s6, s6, 4096
    buffer_load_dwordx4 v[72:75], v1, s[56:59], s6 offen
    s_add_u32 s6, s6, 4096
    buffer_load_dwordx4 v[76:79], v1, s[56:59], s6 offen
    s_add_u32 s6, s6, 4096
    buffer_load_dwordx4 v[80:83], v1, s[56:59], s6 offen
    s_add_u32 s6, s6, 4096
    buffer_load_dwordx4 v[84:87], v1, s[56:59], s6 offen
    s_add_u32 s6, s6, 4096
    buffer_load_dwordx4 v[88:91], v1, s[56:59], s6 offen
    s_add_u32 s6, s6, 4096
    buffer_load_dwordx4 v[92:95], v1, s[56:59], s6 offen
    s_add_u32 s6, s6, 4096
    buffer_load_dwordx4 v[96:99], v1, s[56:59], s6 offen
    s_add_u32 s6, s6, 4096
    buffer_load_dwordx4 v[100:103], v1, s[56:59], s6 offen
    s_add_u32 s6, s6, 4096
    buffer_load_dwordx4 v[104:107], v1, s[56:59], s6 offen
    s_add_u32 s6, s6, 4096
    buffer_load_dwordx4 v[108:111], v1, s[56:59], s6 offen
    s_add_u32 s6, s6, 4096
    buffer_load_dwordx4 v[112:115], v1, s[56:59], s6 offen
    s_add_u32 s6, s6, 4096
    buffer_load_dwordx4 v[116:119], v1, s[56:59], s6 offen
    s_add_u32 s6, s6, 4096
    buffer_load_dwordx4 v[120:123], v1, s[56:59], s6 offen
    s_add_u32 s6, s6, 4096
    buffer_load_dwordx4 v[124:127], v1, s[56:59], s6 offen
    s_add_u32 s6, s6, 4096
    buffer_load_dwordx4 v[128:131], v1, s[56:59], s6 offen
    s_add_u32 s6, s6, 4096
    s_waitcnt vmcnt(0)
W_nopf_121:
    s_cmp_lg_u32 s100, 222
    s_cbranch_scc1 W_nomf_122
    s_cmp_lg_u32 s4, 0
    s_cbranch_scc1 WDW_123
DW_124:
    buffer_load_dword v1, off, s[60:63], 0 offset:128 sc1
    s_add_u32 s79, s79, 1
    s_cmp_gt_u32 s79, 2097152
    s_cbranch_scc1 mega_kernel_exit
    s_waitcnt vmcnt(0)
    v_cmp_gt_u32 vcc, 0xc0, v1
    s_nop 0
    s_cbranch_vccz DWok_125
    s_sleep 8
    s_branch DW_124
DWok_125:
WDW_123:
    s_barrier
    v_lshlrev_b32 v5, 4, v0
    s_mov_b32 s9, 65536
    buffer_load_dwordx4 v[16:19], v5, s[52:55], s9 offen sc1
    s_mov_b32 s9, 77824
    buffer_load_dwordx4 v[20:23], v5, s[52:55], s9 offen sc1
    s_mov_b32 s9, 90112
    buffer_load_dwordx4 v[24:27], v5, s[52:55], s9 offen sc1
    s_mov_b32 s9, 102400
    buffer_load_dwordx4 v[28:31], v5, s[52:55], s9 offen sc1
    s_mov_b32 s9, 114688
    buffer_load_dwordx4 v[32:35], v5, s[52:55], s9 offen sc1
    s_mov_b32 s9, 126976
    buffer_load_dwordx4 v[36:39], v5, s[52:55], s9 offen sc1
    s_mov_b32 s9, 139264
    buffer_load_dwordx4 v[40:43], v5, s[52:55], s9 offen sc1
    s_mov_b32 s9, 151552
    buffer_load_dwordx4 v[44:47], v5, s[52:55], s9 offen sc1
    s_waitcnt vmcnt(0)
    v_add_f32 v8, v16, v20
    v_add_f32 v8, v8, v24
    v_add_f32 v8, v8, v28
    v_add_f32 v8, v8, v32
    v_add_f32 v8, v8, v36
    v_add_f32 v8, v8, v40
    v_add_f32 v8, v8, v44
    v_add_f32 v9, v17, v21
    v_add_f32 v9, v9, v25
    v_add_f32 v9, v9, v29
    v_add_f32 v9, v9, v33
    v_add_f32 v9, v9, v37
    v_add_f32 v9, v9, v41
    v_add_f32 v9, v9, v45
    v_add_f32 v10, v18, v22
    v_add_f32 v10, v10, v26
    v_add_f32 v10, v10, v30
    v_add_f32 v10, v10, v34
    v_add_f32 v10, v10, v38
    v_add_f32 v10, v10, v42
    v_add_f32 v10, v10, v46
    v_add_f32 v11, v19, v23
    v_add_f32 v11, v11, v27
    v_add_f32 v11, v11, v31
    v_add_f32 v11, v11, v35
    v_add_f32 v11, v11, v39
    v_add_f32 v11, v11, v43
    v_add_f32 v11, v11, v47
    v_cvt_pk_bf16_f32 v8, v8, v8
    v_lshlrev_b32 v8, 16, v8
    v_cvt_pk_bf16_f32 v9, v9, v9
    v_lshlrev_b32 v9, 16, v9
    v_cvt_pk_bf16_f32 v10, v10, v10
    v_lshlrev_b32 v10, 16, v10
    v_cvt_pk_bf16_f32 v11, v11, v11
    v_lshlrev_b32 v11, 16, v11
    s_cmp_lt_u32 s4, 2
    s_cbranch_scc1 MF_126
    v_add_f32 v8, 1.0, v8
    v_cvt_pk_bf16_f32 v8, v8, v8
    v_lshlrev_b32 v8, 16, v8
    v_add_f32 v9, 1.0, v9
    v_cvt_pk_bf16_f32 v9, v9, v9
    v_lshlrev_b32 v9, 16, v9
    v_add_f32 v10, 1.0, v10
    v_cvt_pk_bf16_f32 v10, v10, v10
    v_lshlrev_b32 v10, 16, v10
    v_add_f32 v11, 1.0, v11
    v_cvt_pk_bf16_f32 v11, v11, v11
    v_lshlrev_b32 v11, 16, v11
MF_126:
    s_mov_b32 s10, 196608
    buffer_store_dwordx4 v[8:11], v5, s[52:55], s10 offen sc1
    s_mov_b32 s9, 69632
    buffer_load_dwordx4 v[16:19], v5, s[52:55], s9 offen sc1
    s_mov_b32 s9, 81920
    buffer_load_dwordx4 v[20:23], v5, s[52:55], s9 offen sc1
    s_mov_b32 s9, 94208
    buffer_load_dwordx4 v[24:27], v5, s[52:55], s9 offen sc1
    s_mov_b32 s9, 106496
    buffer_load_dwordx4 v[28:31], v5, s[52:55], s9 offen sc1
    s_mov_b32 s9, 118784
    buffer_load_dwordx4 v[32:35], v5, s[52:55], s9 offen sc1
    s_mov_b32 s9, 131072
    buffer_load_dwordx4 v[36:39], v5, s[52:55], s9 offen sc1
    s_mov_b32 s9, 143360
    buffer_load_dwordx4 v[40:43], v5, s[52:55], s9 offen sc1
    s_mov_b32 s9, 155648
    buffer_load_dwordx4 v[44:47], v5, s[52:55], s9 offen sc1
    s_waitcnt vmcnt(0)
    v_add_f32 v8, v16, v20
    v_add_f32 v8, v8, v24
    v_add_f32 v8, v8, v28
    v_add_f32 v8, v8, v32
    v_add_f32 v8, v8, v36
    v_add_f32 v8, v8, v40
    v_add_f32 v8, v8, v44
    v_add_f32 v9, v17, v21
    v_add_f32 v9, v9, v25
    v_add_f32 v9, v9, v29
    v_add_f32 v9, v9, v33
    v_add_f32 v9, v9, v37
    v_add_f32 v9, v9, v41
    v_add_f32 v9, v9, v45
    v_add_f32 v10, v18, v22
    v_add_f32 v10, v10, v26
    v_add_f32 v10, v10, v30
    v_add_f32 v10, v10, v34
    v_add_f32 v10, v10, v38
    v_add_f32 v10, v10, v42
    v_add_f32 v10, v10, v46
    v_add_f32 v11, v19, v23
    v_add_f32 v11, v11, v27
    v_add_f32 v11, v11, v31
    v_add_f32 v11, v11, v35
    v_add_f32 v11, v11, v39
    v_add_f32 v11, v11, v43
    v_add_f32 v11, v11, v47
    v_cvt_pk_bf16_f32 v8, v8, v8
    v_lshlrev_b32 v8, 16, v8
    v_cvt_pk_bf16_f32 v9, v9, v9
    v_lshlrev_b32 v9, 16, v9
    v_cvt_pk_bf16_f32 v10, v10, v10
    v_lshlrev_b32 v10, 16, v10
    v_cvt_pk_bf16_f32 v11, v11, v11
    v_lshlrev_b32 v11, 16, v11
    s_mov_b32 s10, 200704
    buffer_store_dwordx4 v[8:11], v5, s[52:55], s10 offen sc1
    s_mov_b32 s9, 73728
    buffer_load_dwordx4 v[16:19], v5, s[52:55], s9 offen sc1
    s_mov_b32 s9, 86016
    buffer_load_dwordx4 v[20:23], v5, s[52:55], s9 offen sc1
    s_mov_b32 s9, 98304
    buffer_load_dwordx4 v[24:27], v5, s[52:55], s9 offen sc1
    s_mov_b32 s9, 110592
    buffer_load_dwordx4 v[28:31], v5, s[52:55], s9 offen sc1
    s_mov_b32 s9, 122880
    buffer_load_dwordx4 v[32:35], v5, s[52:55], s9 offen sc1
    s_mov_b32 s9, 135168
    buffer_load_dwordx4 v[36:39], v5, s[52:55], s9 offen sc1
    s_mov_b32 s9, 147456
    buffer_load_dwordx4 v[40:43], v5, s[52:55], s9 offen sc1
    s_mov_b32 s9, 159744
    buffer_load_dwordx4 v[44:47], v5, s[52:55], s9 offen sc1
    s_waitcnt vmcnt(0)
    v_add_f32 v8, v16, v20
    v_add_f32 v8, v8, v24
    v_add_f32 v8, v8, v28
    v_add_f32 v8, v8, v32
    v_add_f32 v8, v8, v36
    v_add_f32 v8, v8, v40
    v_add_f32 v8, v8, v44
    v_add_f32 v9, v17, v21
    v_add_f32 v9, v9, v25
    v_add_f32 v9, v9, v29
    v_add_f32 v9, v9, v33
    v_add_f32 v9, v9, v37
    v_add_f32 v9, v9, v41
    v_add_f32 v9, v9, v45
    v_add_f32 v10, v18, v22
    v_add_f32 v10, v10, v26
    v_add_f32 v10, v10, v30
    v_add_f32 v10, v10, v34
    v_add_f32 v10, v10, v38
    v_add_f32 v10, v10, v42
    v_add_f32 v10, v10, v46
    v_add_f32 v11, v19, v23
    v_add_f32 v11, v11, v27
    v_add_f32 v11, v11, v31
    v_add_f32 v11, v11, v35
    v_add_f32 v11, v11, v39
    v_add_f32 v11, v11, v43
    v_add_f32 v11, v11, v47
    v_cvt_pk_bf16_f32 v8, v8, v8
    v_lshlrev_b32 v8, 16, v8
    v_cvt_pk_bf16_f32 v9, v9, v9
    v_lshlrev_b32 v9, 16, v9
    v_cvt_pk_bf16_f32 v10, v10, v10
    v_lshlrev_b32 v10, 16, v10
    v_cvt_pk_bf16_f32 v11, v11, v11
    v_lshlrev_b32 v11, 16, v11
    s_cmp_ge_u32 s4, 2
    s_cbranch_scc1 MF_127
    v_add_f32 v8, 1.0, v8
    v_cvt_pk_bf16_f32 v8, v8, v8
    v_lshlrev_b32 v8, 16, v8
    v_add_f32 v9, 1.0, v9
    v_cvt_pk_bf16_f32 v9, v9, v9
    v_lshlrev_b32 v9, 16, v9
    v_add_f32 v10, 1.0, v10
    v_cvt_pk_bf16_f32 v10, v10, v10
    v_lshlrev_b32 v10, 16, v10
    v_add_f32 v11, 1.0, v11
    v_cvt_pk_bf16_f32 v11, v11, v11
    v_lshlrev_b32 v11, 16, v11
MF_127:
    s_mov_b32 s10, 204800
    buffer_store_dwordx4 v[8:11], v5, s[52:55], s10 offen sc1
    s_waitcnt vmcnt(0)
    s_barrier
    s_cmp_lg_u32 s4, 0
    s_cbranch_scc1 DA_128
    s_mov_b64 exec, 1
    v_mov_b32 v1, 1
    buffer_atomic_add v1, off, s[60:63], 0 offset:16
    s_mov_b64 exec, -1
DA_128:
W_nomf_122:
    s_cmp_lg_u32 s4, 0
    s_cbranch_scc1 WDW_129
DW_130:
    buffer_load_dword v1, off, s[60:63], 0 offset:16 sc1
    s_add_u32 s79, s79, 1
    s_cmp_gt_u32 s79, 2097152
    s_cbranch_scc1 mega_kernel_exit
    s_waitcnt vmcnt(0)
    v_cmp_gt_u32 vcc, 33, v1
    s_nop 0
    s_cbranch_vccz DWok_131
    s_sleep 60
    s_branch DW_130
DWok_131:
WDW_129:
    s_barrier
    s_cmp_lg_u32 s4, 0
    s_cbranch_scc1 GTsk_134
    s_mov_b64 exec, 1
    s_getreg_b32 s6, hwreg(HW_REG_XCC_ID, 0, 3)
GT_132:
    s_lshl_b32 s7, s6, 2
    v_mov_b32 v1, 1
    buffer_atomic_add v1, off, s[60:63], s7 offset:32 sc0
    s_waitcnt vmcnt(0)
    v_readfirstlane_b32 s8, v1
    s_nop 0
    s_cmp_lt_u32 s8, 16
    s_cbranch_scc1 GTok_133
    s_add_u32 s6, s6, 7
    s_and_b32 s6, s6, 7
    s_branch GT_132
GTok_133:
    s_lshl_b32 s8, s8, 3
    s_add_u32 s8, s8, s6
    v_mov_b32 v1, s8
    v_mov_b32 v2, 0
    ds_write_b32 v2, v1
    s_waitcnt lgkmcnt(0)
    s_mov_b64 exec, -1
GTsk_134:
    s_barrier
    v_mov_b32 v2, 0
    ds_read_b32 v1, v2
    s_waitcnt lgkmcnt(0)
    v_readfirstlane_b32 s101, v1
    s_barrier
W_pre_70:
    s_load_dwordx16 s[16:31], s[0:1], 0
    s_load_dwordx16 s[32:47], s[0:1], 64
    s_load_dwordx2 s[48:49], s[0:1], 128
    s_waitcnt lgkmcnt(0)
    v_and_b32 v1, 63, v0
    v_and_b32 v2, 15, v1
    v_lshrrev_b32 v3, 4, v1
    v_lshrrev_b32 v4, 2, v2
    v_and_b32 v5, 3, v2
    v_lshrrev_b32 v6, 1, v3
    v_and_b32 v7, 1, v3
    v_lshlrev_b32 v8, 4, v1
    s_mov_b32 s56, s36
    s_and_b32 s57, s37, 0xffff
    s_mov_b32 s58, 0x700000
    s_mov_b32 s59, 0x00020000
    v_lshl_add_u32 v10, v6, 2, v4
    v_lshlrev_b32 v10, 8, v10
    v_lshl_add_u32 v10, v7, 5, v10
    v_lshl_add_u32 v10, v5, 3, v10
    v_xor_b32 v11, s4, v4
    v_lshl_add_u32 v10, v11, 6, v10
    v_add_u32 v10, 65536, v10
    v_add_u32 v11, 0xc000, v10
    v_lshlrev_b32 v9, 2, v3
    v_xor_b32 v9, v9, v2
    v_lshlrev_b32 v9, 4, v9
    v_lshl_add_u32 v9, v3, 12, v9
    s_lshr_b32 s6, s101, 3
    s_lshl_b32 s6, s6, 8
    s_mul_i32 s7, s4, 393216
    s_add_u32 s6, s6, s7
    s_mul_i32 s9, s4, 24576
    s_add_u32 s9, s9, 65536
    s_add_u32 s7, s6, 0
    s_mov_b32 s8, s9
    s_mov_b32 m0, s8
    s_add_u32 s8, s8, 1024
    buffer_load_dwordx4 v9, s[56:59], s7 offen lds
    s_add_u32 s7, s7, 16384
    s_mov_b32 m0, s8
    s_add_u32 s8, s8, 1024
    buffer_load_dwordx4 v9, s[56:59], s7 offen lds
    s_add_u32 s7, s7, 16384
    s_mov_b32 m0, s8
    s_add_u32 s8, s8, 1024
    buffer_load_dwordx4 v9, s[56:59], s7 offen lds
    s_add_u32 s7, s7, 16384
    s_mov_b32 m0, s8
    s_add_u32 s8, s8, 1024
    buffer_load_dwordx4 v9, s[56:59], s7 offen lds
    s_add_u32 s7, s7, 16384
    s_mov_b32 m0, s8
    s_add_u32 s8, s8, 1024
    buffer_load_dwordx4 v9, s[56:59], s7 offen lds
    s_add_u32 s7, s7, 16384
    s_mov_b32 m0, s8
    s_add_u32 s8, s8, 1024
    buffer_load_dwordx4 v9, s[56:59], s7 offen lds
    s_add_u32 s7, s7, 16384
    s_mov_b32 m0, s8
    s_add_u32 s8, s8, 1024
    buffer_load_dwordx4 v9, s[56:59], s7 offen lds
    s_add_u32 s7, s7, 16384
    s_mov_b32 m0, s8
    s_add_u32 s8, s8, 1024
    buffer_load_dwordx4 v9, s[56:59], s7 offen lds
    s_add_u32 s7, s7, 16384
    s_mov_b32 m0, s8
    s_add_u32 s8, s8, 1024
    buffer_load_dwordx4 v9, s[56:59], s7 offen lds
    s_add_u32 s7, s7, 16384
    s_mov_b32 m0, s8
    s_add_u32 s8, s8, 1024
    buffer_load_dwordx4 v9, s[56:59], s7 offen lds
    s_add_u32 s7, s7, 16384
    s_mov_b32 m0, s8
    s_add_u32 s8, s8, 1024
    buffer_load_dwordx4 v9, s[56:59], s7 offen lds
    s_add_u32 s7, s7, 16384
    s_mov_b32 m0, s8
    s_add_u32 s8, s8, 1024
    buffer_load_dwordx4 v9, s[56:59], s7 offen lds
    s_add_u32 s7, s7, 16384
    s_mov_b32 m0, s8
    s_add_u32 s8, s8, 1024
    buffer_load_dwordx4 v9, s[56:59], s7 offen lds
    s_add_u32 s7, s7, 16384
    s_mov_b32 m0, s8
    s_add_u32 s8, s8, 1024
    buffer_load_dwordx4 v9, s[56:59], s7 offen lds
    s_add_u32 s7, s7, 16384
    s_mov_b32 m0, s8
    s_add_u32 s8, s8, 1024
    buffer_load_dwordx4 v9, s[56:59], s7 offen lds
    s_add_u32 s7, s7, 16384
    s_mov_b32 m0, s8
    s_add_u32 s8, s8, 1024
    buffer_load_dwordx4 v9, s[56:59], s7 offen lds
    s_add_u32 s7, s7, 16384
    s_mov_b32 m0, s8
    s_add_u32 s8, s8, 1024
    buffer_load_dwordx4 v9, s[56:59], s7 offen lds
    s_add_u32 s7, s7, 16384
    s_mov_b32 m0, s8
    s_add_u32 s8, s8, 1024
    buffer_load_dwordx4 v9, s[56:59], s7 offen lds
    s_add_u32 s7, s7, 16384
    s_mov_b32 m0, s8
    s_add_u32 s8, s8, 1024
    buffer_load_dwordx4 v9, s[56:59], s7 offen lds
    s_add_u32 s7, s7, 16384
    s_mov_b32 m0, s8
    s_add_u32 s8, s8, 1024
    buffer_load_dwordx4 v9, s[56:59], s7 offen lds
    s_add_u32 s7, s7, 16384
    s_mov_b32 m0, s8
    s_add_u32 s8, s8, 1024
    buffer_load_dwordx4 v9, s[56:59], s7 offen lds
    s_add_u32 s7, s7, 16384
    s_mov_b32 m0, s8
    s_add_u32 s8, s8, 1024
    buffer_load_dwordx4 v9, s[56:59], s7 offen lds
    s_add_u32 s7, s7, 16384
    s_mov_b32 m0, s8
    s_add_u32 s8, s8, 1024
    buffer_load_dwordx4 v9, s[56:59], s7 offen lds
    s_add_u32 s7, s7, 16384
    s_mov_b32 m0, s8
    s_add_u32 s8, s8, 1024
    buffer_load_dwordx4 v9, s[56:59], s7 offen lds
    s_add_u32 s7, s7, 16384
    s_waitcnt vmcnt(0)
    s_barrier
    ds_read_b64_tr_b16 v[128:129], v10 offset:0
    ds_read_b64_tr_b16 v[130:131], v10 offset:2048
    ds_read_b64_tr_b16 v[132:133], v10 offset:4096
    ds_read_b64_tr_b16 v[134:135], v10 offset:6144
    ds_read_b64_tr_b16 v[136:137], v10 offset:8192
    ds_read_b64_tr_b16 v[138:139], v10 offset:10240
    ds_read_b64_tr_b16 v[140:141], v10 offset:12288
    ds_read_b64_tr_b16 v[142:143], v10 offset:14336
    ds_read_b64_tr_b16 v[144:145], v10 offset:16384
    ds_read_b64_tr_b16 v[146:147], v10 offset:18432
    ds_read_b64_tr_b16 v[148:149], v10 offset:20480
    ds_read_b64_tr_b16 v[150:151], v10 offset:22528
    ds_read_b64_tr_b16 v[152:153], v10 offset:24576
    ds_read_b64_tr_b16 v[154:155], v10 offset:26624
    ds_read_b64_tr_b16 v[156:157], v10 offset:28672
    ds_read_b64_tr_b16 v[158:159], v10 offset:30720
    ds_read_b64_tr_b16 v[160:161], v10 offset:32768
    ds_read_b64_tr_b16 v[162:163], v10 offset:34816
    ds_read_b64_tr_b16 v[164:165], v10 offset:36864
    ds_read_b64_tr_b16 v[166:167], v10 offset:38912
    ds_read_b64_tr_b16 v[168:169], v10 offset:40960
    ds_read_b64_tr_b16 v[170:171], v10 offset:43008
    ds_read_b64_tr_b16 v[172:173], v10 offset:45056
    ds_read_b64_tr_b16 v[174:175], v10 offset:47104
    ds_read_b64_tr_b16 v[176:177], v11 offset:0
    ds_read_b64_tr_b16 v[178:179], v11 offset:2048
    ds_read_b64_tr_b16 v[180:181], v11 offset:4096
    ds_read_b64_tr_b16 v[182:183], v11 offset:6144
    ds_read_b64_tr_b16 v[184:185], v11 offset:8192
    ds_read_b64_tr_b16 v[186:187], v11 offset:10240
    ds_read_b64_tr_b16 v[188:189], v11 offset:12288
    ds_read_b64_tr_b16 v[190:191], v11 offset:14336
    ds_read_b64_tr_b16 v[192:193], v11 offset:16384
    ds_read_b64_tr_b16 v[194:195], v11 offset:18432
    ds_read_b64_tr_b16 v[196:197], v11 offset:20480
    ds_read_b64_tr_b16 v[198:199], v11 offset:22528
    ds_read_b64_tr_b16 v[200:201], v11 offset:24576
    ds_read_b64_tr_b16 v[202:203], v11 offset:26624
    ds_read_b64_tr_b16 v[204:205], v11 offset:32768
    ds_read_b64_tr_b16 v[206:207], v11 offset:34816
    ds_read_b64_tr_b16 v[208:209], v11 offset:36864
    ds_read_b64_tr_b16 v[210:211], v11 offset:38912
    ds_read_b64_tr_b16 v[212:213], v11 offset:40960
    ds_read_b64_tr_b16 v[214:215], v11 offset:43008
    s_waitcnt lgkmcnt(0)
    s_barrier
    s_add_u32 s7, s6, 1572864
    s_mov_b32 s8, s9
    s_mov_b32 m0, s8
    s_add_u32 s8, s8, 1024
    buffer_load_dwordx4 v9, s[56:59], s7 offen lds
    s_add_u32 s7, s7, 16384
    s_mov_b32 m0, s8
    s_add_u32 s8, s8, 1024
    buffer_load_dwordx4 v9, s[56:59], s7 offen lds
    s_add_u32 s7, s7, 16384
    s_mov_b32 m0, s8
    s_add_u32 s8, s8, 1024
    buffer_load_dwordx4 v9, s[56:59], s7 offen lds
    s_add_u32 s7, s7, 16384
    s_mov_b32 m0, s8
    s_add_u32 s8, s8, 1024
    buffer_load_dwordx4 v9, s[56:59], s7 offen lds
    s_add_u32 s7, s7, 16384
    s_mov_b32 m0, s8
    s_add_u32 s8, s8, 1024
    buffer_load_dwordx4 v9, s[56:59], s7 offen lds
    s_add_u32 s7, s7, 16384
    s_mov_b32 m0, s8
    s_add_u32 s8, s8, 1024
    buffer_load_dwordx4 v9, s[56:59], s7 offen lds
    s_add_u32 s7, s7, 16384
    s_mov_b32 m0, s8
    s_add_u32 s8, s8, 1024
    buffer_load_dwordx4 v9, s[56:59], s7 offen lds
    s_add_u32 s7, s7, 16384
    s_mov_b32 m0, s8
    s_add_u32 s8, s8, 1024
    buffer_load_dwordx4 v9, s[56:59], s7 offen lds
    s_add_u32 s7, s7, 16384
    s_mov_b32 m0, s8
    s_add_u32 s8, s8, 1024
    buffer_load_dwordx4 v9, s[56:59], s7 offen lds
    s_add_u32 s7, s7, 16384
    s_mov_b32 m0, s8
    s_add_u32 s8, s8, 1024
    buffer_load_dwordx4 v9, s[56:59], s7 offen lds
    s_add_u32 s7, s7, 16384
    s_mov_b32 m0, s8
    s_add_u32 s8, s8, 1024
    buffer_load_dwordx4 v9, s[56:59], s7 offen lds
    s_add_u32 s7, s7, 16384
    s_mov_b32 m0, s8
    s_add_u32 s8, s8, 1024
    buffer_load_dwordx4 v9, s[56:59], s7 offen lds
    s_add_u32 s7, s7, 16384
    s_mov_b32 m0, s8
    s_add_u32 s8, s8, 1024
    buffer_load_dwordx4 v9, s[56:59], s7 offen lds
    s_add_u32 s7, s7, 16384
    s_mov_b32 m0, s8
    s_add_u32 s8, s8, 1024
    buffer_load_dwordx4 v9, s[56:59], s7 offen lds
    s_add_u32 s7, s7, 16384
    s_mov_b32 m0, s8
    s_add_u32 s8, s8, 1024
    buffer_load_dwordx4 v9, s[56:59], s7 offen lds
    s_add_u32 s7, s7, 16384
    s_mov_b32 m0, s8
    s_add_u32 s8, s8, 1024
    buffer_load_dwordx4 v9, s[56:59], s7 offen lds
    s_add_u32 s7, s7, 16384
    s_mov_b32 m0, s8
    s_add_u32 s8, s8, 1024
    buffer_load_dwordx4 v9, s[56:59], s7 offen lds
    s_add_u32 s7, s7, 16384
    s_mov_b32 m0, s8
    s_add_u32 s8, s8, 1024
    buffer_load_dwordx4 v9, s[56:59], s7 offen lds
    s_add_u32 s7, s7, 16384
    s_mov_b32 m0, s8
    s_add_u32 s8, s8, 1024
    buffer_load_dwordx4 v9, s[56:59], s7 offen lds
    s_add_u32 s7, s7, 16384
    s_mov_b32 m0, s8
    s_add_u32 s8, s8, 1024
    buffer_load_dwordx4 v9, s[56:59], s7 offen lds
    s_add_u32 s7, s7, 16384
    s_mov_b32 m0, s8
    s_add_u32 s8, s8, 1024
    buffer_load_dwordx4 v9, s[56:59], s7 offen lds
    s_add_u32 s7, s7, 16384
    s_mov_b32 m0, s8
    s_add_u32 s8, s8, 1024
    buffer_load_dwordx4 v9, s[56:59], s7 offen lds
    s_add_u32 s7, s7, 16384
    s_mov_b32 m0, s8
    s_add_u32 s8, s8, 1024
    buffer_load_dwordx4 v9, s[56:59], s7 offen lds
    s_add_u32 s7, s7, 16384
    s_mov_b32 m0, s8
    s_add_u32 s8, s8, 1024
    buffer_load_dwordx4 v9, s[56:59], s7 offen lds
    s_add_u32 s7, s7, 16384
    s_waitcnt vmcnt(0)
    s_barrier
    ds_read_b64_tr_b16 v[216:217], v10 offset:0
    ds_read_b64_tr_b16 v[218:219], v10 offset:2048
    ds_read_b64_tr_b16 v[220:221], v10 offset:4096
    ds_read_b64_tr_b16 v[222:223], v10 offset:6144
    ds_read_b64_tr_b16 a[0:1], v10 offset:8192
    ds_read_b64_tr_b16 a[2:3], v10 offset:10240
    ds_read_b64_tr_b16 a[4:5], v10 offset:16384
    ds_read_b64_tr_b16 a[6:7], v10 offset:18432
    ds_read_b64_tr_b16 a[8:9], v10 offset:20480
    ds_read_b64_tr_b16 a[10:11], v10 offset:22528
    ds_read_b64_tr_b16 a[12:13], v10 offset:24576
    ds_read_b64_tr_b16 a[14:15], v10 offset:26624
    ds_read_b64_tr_b16 a[16:17], v10 offset:32768
    ds_read_b64_tr_b16 a[18:19], v10 offset:34816
    ds_read_b64_tr_b16 a[20:21], v10 offset:36864
    ds_read_b64_tr_b16 a[22:23], v10 offset:38912
    ds_read_b64_tr_b16 a[24:25], v10 offset:40960
    ds_read_b64_tr_b16 a[26:27], v10 offset:43008
    ds_read_b64_tr_b16 a[28:29], v11 offset:0
    ds_read_b64_tr_b16 a[30:31], v11 offset:2048
    ds_read_b64_tr_b16 a[32:33], v11 offset:4096
    ds_read_b64_tr_b16 a[34:35], v11 offset:6144
    ds_read_b64_tr_b16 a[36:37], v11 offset:8192
    ds_read_b64_tr_b16 a[38:39], v11 offset:10240
    ds_read_b64_tr_b16 a[40:41], v11 offset:16384
    ds_read_b64_tr_b16 a[42:43], v11 offset:18432
    ds_read_b64_tr_b16 a[44:45], v11 offset:20480
    ds_read_b64_tr_b16 a[46:47], v11 offset:22528
    ds_read_b64_tr_b16 a[48:49], v11 offset:24576
    ds_read_b64_tr_b16 a[50:51], v11 offset:26624
    ds_read_b64_tr_b16 a[52:53], v11 offset:32768
    ds_read_b64_tr_b16 a[54:55], v11 offset:34816
    ds_read_b64_tr_b16 a[56:57], v11 offset:36864
    ds_read_b64_tr_b16 a[58:59], v11 offset:38912
    ds_read_b64_tr_b16 a[60:61], v11 offset:40960
    ds_read_b64_tr_b16 a[62:63], v11 offset:43008
    s_waitcnt lgkmcnt(0)
    s_barrier
    s_add_u32 s7, s6, 3145728
    s_mov_b32 s8, s9
    s_mov_b32 m0, s8
    s_add_u32 s8, s8, 1024
    buffer_load_dwordx4 v9, s[56:59], s7 offen lds
    s_add_u32 s7, s7, 16384
    s_mov_b32 m0, s8
    s_add_u32 s8, s8, 1024
    buffer_load_dwordx4 v9, s[56:59], s7 offen lds
    s_add_u32 s7, s7, 16384
    s_mov_b32 m0, s8
    s_add_u32 s8, s8, 1024
    buffer_load_dwordx4 v9, s[56:59], s7 offen lds
    s_add_u32 s7, s7, 16384
    s_mov_b32 m0, s8
    s_add_u32 s8, s8, 1024
    buffer_load_dwordx4 v9, s[56:59], s7 offen lds
    s_add_u32 s7, s7, 16384
    s_mov_b32 m0, s8
    s_add_u32 s8, s8, 1024
    buffer_load_dwordx4 v9, s[56:59], s7 offen lds
    s_add_u32 s7, s7, 16384
    s_mov_b32 m0, s8
    s_add_u32 s8, s8, 1024
    buffer_load_dwordx4 v9, s[56:59], s7 offen lds
    s_add_u32 s7, s7, 16384
    s_mov_b32 m0, s8
    s_add_u32 s8, s8, 1024
    buffer_load_dwordx4 v9, s[56:59], s7 offen lds
    s_add_u32 s7, s7, 16384
    s_mov_b32 m0, s8
    s_add_u32 s8, s8, 1024
    buffer_load_dwordx4 v9, s[56:59], s7 offen lds
    s_add_u32 s7, s7, 16384
    s_mov_b32 m0, s8
    s_add_u32 s8, s8, 1024
    buffer_load_dwordx4 v9, s[56:59], s7 offen lds
    s_add_u32 s7, s7, 16384
    s_mov_b32 m0, s8
    s_add_u32 s8, s8, 1024
    buffer_load_dwordx4 v9, s[56:59], s7 offen lds
    s_add_u32 s7, s7, 16384
    s_mov_b32 m0, s8
    s_add_u32 s8, s8, 1024
    buffer_load_dwordx4 v9, s[56:59], s7 offen lds
    s_add_u32 s7, s7, 16384
    s_mov_b32 m0, s8
    s_add_u32 s8, s8, 1024
    buffer_load_dwordx4 v9, s[56:59], s7 offen lds
    s_add_u32 s7, s7, 16384
    s_mov_b32 m0, s8
    s_add_u32 s8, s8, 1024
    buffer_load_dwordx4 v9, s[56:59], s7 offen lds
    s_add_u32 s7, s7, 16384
    s_mov_b32 m0, s8
    s_add_u32 s8, s8, 1024
    buffer_load_dwordx4 v9, s[56:59], s7 offen lds
    s_add_u32 s7, s7, 16384
    s_mov_b32 m0, s8
    s_add_u32 s8, s8, 1024
    buffer_load_dwordx4 v9, s[56:59], s7 offen lds
    s_add_u32 s7, s7, 16384
    s_mov_b32 m0, s8
    s_add_u32 s8, s8, 1024
    buffer_load_dwordx4 v9, s[56:59], s7 offen lds
    s_add_u32 s7, s7, 16384
    s_mov_b32 m0, s8
    s_add_u32 s8, s8, 1024
    buffer_load_dwordx4 v9, s[56:59], s7 offen lds
    s_add_u32 s7, s7, 16384
    s_mov_b32 m0, s8
    s_add_u32 s8, s8, 1024
    buffer_load_dwordx4 v9, s[56:59], s7 offen lds
    s_add_u32 s7, s7, 16384
    s_mov_b32 m0, s8
    s_add_u32 s8, s8, 1024
    buffer_load_dwordx4 v9, s[56:59], s7 offen lds
    s_add_u32 s7, s7, 16384
    s_mov_b32 m0, s8
    s_add_u32 s8, s8, 1024
    buffer_load_dwordx4 v9, s[56:59], s7 offen lds
    s_add_u32 s7, s7, 16384
    s_mov_b32 m0, s8
    s_add_u32 s8, s8, 1024
    buffer_load_dwordx4 v9, s[56:59], s7 offen lds
    s_add_u32 s7, s7, 16384
    s_mov_b32 m0, s8
    s_add_u32 s8, s8, 1024
    buffer_load_dwordx4 v9, s[56:59], s7 offen lds
    s_add_u32 s7, s7, 16384
    s_mov_b32 m0, s8
    s_add_u32 s8, s8, 1024
    buffer_load_dwordx4 v9, s[56:59], s7 offen lds
    s_add_u32 s7, s7, 16384
    s_mov_b32 m0, s8
    s_add_u32 s8, s8, 1024
    buffer_load_dwordx4 v9, s[56:59], s7 offen lds
    s_add_u32 s7, s7, 16384
    s_waitcnt vmcnt(0)
    s_barrier
    ds_read_b64_tr_b16 a[64:65], v10 offset:0
    ds_read_b64_tr_b16 a[66:67], v10 offset:2048
    ds_read_b64_tr_b16 a[68:69], v10 offset:4096
    ds_read_b64_tr_b16 a[70:71], v10 offset:6144
    ds_read_b64_tr_b16 a[72:73], v10 offset:8192
    ds_read_b64_tr_b16 a[74:75], v10 offset:10240
    ds_read_b64_tr_b16 a[76:77], v10 offset:16384
    ds_read_b64_tr_b16 a[78:79], v10 offset:18432
    ds_read_b64_tr_b16 a[80:81], v10 offset:20480
    ds_read_b64_tr_b16 a[82:83], v10 offset:22528
    ds_read_b64_tr_b16 a[84:85], v10 offset:24576
    ds_read_b64_tr_b16 a[86:87], v10 offset:26624
    ds_read_b64_tr_b16 a[88:89], v10 offset:32768
    ds_read_b64_tr_b16 a[90:91], v10 offset:34816
    ds_read_b64_tr_b16 a[92:93], v10 offset:36864
    ds_read_b64_tr_b16 a[94:95], v10 offset:38912
    ds_read_b64_tr_b16 a[96:97], v10 offset:40960
    ds_read_b64_tr_b16 a[98:99], v10 offset:43008
    ds_read_b64_tr_b16 a[100:101], v11 offset:0
    ds_read_b64_tr_b16 a[102:103], v11 offset:2048
    ds_read_b64_tr_b16 a[104:105], v11 offset:4096
    ds_read_b64_tr_b16 a[106:107], v11 offset:6144
    ds_read_b64_tr_b16 a[108:109], v11 offset:8192
    ds_read_b64_tr_b16 a[110:111], v11 offset:10240
    ds_read_b64_tr_b16 a[112:113], v11 offset:16384
    ds_read_b64_tr_b16 a[114:115], v11 offset:18432
    ds_read_b64_tr_b16 a[116:117], v11 offset:20480
    ds_read_b64_tr_b16 a[118:119], v11 offset:22528
    ds_read_b64_tr_b16 a[120:121], v11 offset:24576
    ds_read_b64_tr_b16 a[122:123], v11 offset:26624
    ds_read_b64_tr_b16 a[124:125], v11 offset:32768
    ds_read_b64_tr_b16 a[126:127], v11 offset:34816
    ds_read_b64_tr_b16 a[128:129], v11 offset:36864
    ds_read_b64_tr_b16 a[130:131], v11 offset:38912
    ds_read_b64_tr_b16 a[132:133], v11 offset:40960
    ds_read_b64_tr_b16 a[134:135], v11 offset:43008
    s_waitcnt lgkmcnt(0)
    s_barrier
    s_add_u32 s7, s6, 4718592
    s_mov_b32 s8, s9
    s_mov_b32 m0, s8
    s_add_u32 s8, s8, 1024
    buffer_load_dwordx4 v9, s[56:59], s7 offen lds
    s_add_u32 s7, s7, 16384
    s_mov_b32 m0, s8
    s_add_u32 s8, s8, 1024
    buffer_load_dwordx4 v9, s[56:59], s7 offen lds
    s_add_u32 s7, s7, 16384
    s_mov_b32 m0, s8
    s_add_u32 s8, s8, 1024
    buffer_load_dwordx4 v9, s[56:59], s7 offen lds
    s_add_u32 s7, s7, 16384
    s_mov_b32 m0, s8
    s_add_u32 s8, s8, 1024
    buffer_load_dwordx4 v9, s[56:59], s7 offen lds
    s_add_u32 s7, s7, 16384
    s_mov_b32 m0, s8
    s_add_u32 s8, s8, 1024
    buffer_load_dwordx4 v9, s[56:59], s7 offen lds
    s_add_u32 s7, s7, 16384
    s_mov_b32 m0, s8
    s_add_u32 s8, s8, 1024
    buffer_load_dwordx4 v9, s[56:59], s7 offen lds
    s_add_u32 s7, s7, 16384
    s_mov_b32 m0, s8
    s_add_u32 s8, s8, 1024
    buffer_load_dwordx4 v9, s[56:59], s7 offen lds
    s_add_u32 s7, s7, 16384
    s_mov_b32 m0, s8
    s_add_u32 s8, s8, 1024
    buffer_load_dwordx4 v9, s[56:59], s7 offen lds
    s_add_u32 s7, s7, 16384
    s_mov_b32 m0, s8
    s_add_u32 s8, s8, 1024
    buffer_load_dwordx4 v9, s[56:59], s7 offen lds
    s_add_u32 s7, s7, 16384
    s_mov_b32 m0, s8
    s_add_u32 s8, s8, 1024
    buffer_load_dwordx4 v9, s[56:59], s7 offen lds
    s_add_u32 s7, s7, 16384
    s_mov_b32 m0, s8
    s_add_u32 s8, s8, 1024
    buffer_load_dwordx4 v9, s[56:59], s7 offen lds
    s_add_u32 s7, s7, 16384
    s_mov_b32 m0, s8
    s_add_u32 s8, s8, 1024
    buffer_load_dwordx4 v9, s[56:59], s7 offen lds
    s_add_u32 s7, s7, 16384
    s_mov_b32 m0, s8
    s_add_u32 s8, s8, 1024
    buffer_load_dwordx4 v9, s[56:59], s7 offen lds
    s_add_u32 s7, s7, 16384
    s_mov_b32 m0, s8
    s_add_u32 s8, s8, 1024
    buffer_load_dwordx4 v9, s[56:59], s7 offen lds
    s_add_u32 s7, s7, 16384
    s_mov_b32 m0, s8
    s_add_u32 s8, s8, 1024
    buffer_load_dwordx4 v9, s[56:59], s7 offen lds
    s_add_u32 s7, s7, 16384
    s_mov_b32 m0, s8
    s_add_u32 s8, s8, 1024
    buffer_load_dwordx4 v9, s[56:59], s7 offen lds
    s_add_u32 s7, s7, 16384
    s_mov_b32 m0, s8
    s_add_u32 s8, s8, 1024
    buffer_load_dwordx4 v9, s[56:59], s7 offen lds
    s_add_u32 s7, s7, 16384
    s_mov_b32 m0, s8
    s_add_u32 s8, s8, 1024
    buffer_load_dwordx4 v9, s[56:59], s7 offen lds
    s_add_u32 s7, s7, 16384
    s_mov_b32 m0, s8
    s_add_u32 s8, s8, 1024
    buffer_load_dwordx4 v9, s[56:59], s7 offen lds
    s_add_u32 s7, s7, 16384
    s_mov_b32 m0, s8
    s_add_u32 s8, s8, 1024
    buffer_load_dwordx4 v9, s[56:59], s7 offen lds
    s_add_u32 s7, s7, 16384
    s_mov_b32 m0, s8
    s_add_u32 s8, s8, 1024
    buffer_load_dwordx4 v9, s[56:59], s7 offen lds
    s_add_u32 s7, s7, 16384
    s_mov_b32 m0, s8
    s_add_u32 s8, s8, 1024
    buffer_load_dwordx4 v9, s[56:59], s7 offen lds
    s_add_u32 s7, s7, 16384
    s_mov_b32 m0, s8
    s_add_u32 s8, s8, 1024
    buffer_load_dwordx4 v9, s[56:59], s7 offen lds
    s_add_u32 s7, s7, 16384
    s_mov_b32 m0, s8
    s_add_u32 s8, s8, 1024
    buffer_load_dwordx4 v9, s[56:59], s7 offen lds
    s_add_u32 s7, s7, 16384
    s_waitcnt vmcnt(0)
    s_barrier
    ds_read_b64_tr_b16 a[136:137], v10 offset:0
    ds_read_b64_tr_b16 a[138:139], v10 offset:2048
    ds_read_b64_tr_b16 a[140:141], v10 offset:4096
    ds_read_b64_tr_b16 a[142:143], v10 offset:6144
    ds_read_b64_tr_b16 a[144:145], v10 offset:8192
    ds_read_b64_tr_b16 a[146:147], v10 offset:10240
    ds_read_b64_tr_b16 a[148:149], v10 offset:16384
    ds_read_b64_tr_b16 a[150:151], v10 offset:18432
    ds_read_b64_tr_b16 a[152:153], v10 offset:20480
    ds_read_b64_tr_b16 a[154:155], v10 offset:22528
    ds_read_b64_tr_b16 a[156:157], v10 offset:24576
    ds_read_b64_tr_b16 a[158:159], v10 offset:26624
    ds_read_b64_tr_b16 a[160:161], v10 offset:32768
    ds_read_b64_tr_b16 a[162:163], v10 offset:34816
    ds_read_b64_tr_b16 a[164:165], v10 offset:36864
    ds_read_b64_tr_b16 a[166:167], v10 offset:38912
    ds_read_b64_tr_b16 a[168:169], v10 offset:40960
    ds_read_b64_tr_b16 a[170:171], v10 offset:43008
    ds_read_b64_tr_b16 a[172:173], v11 offset:0
    ds_read_b64_tr_b16 a[174:175], v11 offset:2048
    ds_read_b64_tr_b16 a[176:177], v11 offset:4096
    ds_read_b64_tr_b16 a[178:179], v11 offset:6144
    ds_read_b64_tr_b16 a[180:181], v11 offset:8192
    ds_read_b64_tr_b16 a[182:183], v11 offset:10240
    ds_read_b64_tr_b16 a[184:185], v11 offset:16384
    ds_read_b64_tr_b16 a[186:187], v11 offset:18432
    ds_read_b64_tr_b16 a[188:189], v11 offset:20480
    ds_read_b64_tr_b16 a[190:191], v11 offset:22528
    ds_read_b64_tr_b16 a[192:193], v11 offset:24576
    ds_read_b64_tr_b16 a[194:195], v11 offset:26624
    ds_read_b64_tr_b16 a[196:197], v11 offset:32768
    ds_read_b64_tr_b16 a[198:199], v11 offset:34816
    ds_read_b64_tr_b16 a[200:201], v11 offset:36864
    ds_read_b64_tr_b16 a[202:203], v11 offset:38912
    ds_read_b64_tr_b16 a[204:205], v11 offset:40960
    ds_read_b64_tr_b16 a[206:207], v11 offset:43008
    s_waitcnt lgkmcnt(0)
    s_barrier
    s_add_u32 s7, s6, 5767168
    s_mov_b32 s8, s9
    s_mov_b32 m0, s8
    s_add_u32 s8, s8, 1024
    buffer_load_dwordx4 v9, s[56:59], s7 offen lds
    s_add_u32 s7, s7, 16384
    s_mov_b32 m0, s8
    s_add_u32 s8, s8, 1024
    buffer_load_dwordx4 v9, s[56:59], s7 offen lds
    s_add_u32 s7, s7, 16384
    s_mov_b32 m0, s8
    s_add_u32 s8, s8, 1024
    buffer_load_dwordx4 v9, s[56:59], s7 offen lds
    s_add_u32 s7, s7, 16384
    s_mov_b32 m0, s8
    s_add_u32 s8, s8, 1024
    buffer_load_dwordx4 v9, s[56:59], s7 offen lds
    s_add_u32 s7, s7, 16384
    s_mov_b32 m0, s8
    s_add_u32 s8, s8, 1024
    buffer_load_dwordx4 v9, s[56:59], s7 offen lds
    s_add_u32 s7, s7, 16384
    s_mov_b32 m0, s8
    s_add_u32 s8, s8, 1024
    buffer_load_dwordx4 v9, s[56:59], s7 offen lds
    s_add_u32 s7, s7, 16384
    s_mov_b32 m0, s8
    s_add_u32 s8, s8, 1024
    buffer_load_dwordx4 v9, s[56:59], s7 offen lds
    s_add_u32 s7, s7, 16384
    s_mov_b32 m0, s8
    s_add_u32 s8, s8, 1024
    buffer_load_dwordx4 v9, s[56:59], s7 offen lds
    s_add_u32 s7, s7, 16384
    s_mov_b32 m0, s8
    s_add_u32 s8, s8, 1024
    buffer_load_dwordx4 v9, s[56:59], s7 offen lds
    s_add_u32 s7, s7, 16384
    s_mov_b32 m0, s8
    s_add_u32 s8, s8, 1024
    buffer_load_dwordx4 v9, s[56:59], s7 offen lds
    s_add_u32 s7, s7, 16384
    s_mov_b32 m0, s8
    s_add_u32 s8, s8, 1024
    buffer_load_dwordx4 v9, s[56:59], s7 offen lds
    s_add_u32 s7, s7, 16384
    s_mov_b32 m0, s8
    s_add_u32 s8, s8, 1024
    buffer_load_dwordx4 v9, s[56:59], s7 offen lds
    s_add_u32 s7, s7, 16384
    s_mov_b32 m0, s8
    s_add_u32 s8, s8, 1024
    buffer_load_dwordx4 v9, s[56:59], s7 offen lds
    s_add_u32 s7, s7, 16384
    s_mov_b32 m0, s8
    s_add_u32 s8, s8, 1024
    buffer_load_dwordx4 v9, s[56:59], s7 offen lds
    s_add_u32 s7, s7, 16384
    s_mov_b32 m0, s8
    s_add_u32 s8, s8, 1024
    buffer_load_dwordx4 v9, s[56:59], s7 offen lds
    s_add_u32 s7, s7, 16384
    s_mov_b32 m0, s8
    s_add_u32 s8, s8, 1024
    buffer_load_dwordx4 v9, s[56:59], s7 offen lds
    s_add_u32 s7, s7, 16384
    s_mov_b32 m0, s8
    s_add_u32 s8, s8, 1024
    buffer_load_dwordx4 v9, s[56:59], s7 offen lds
    s_add_u32 s7, s7, 16384
    s_mov_b32 m0, s8
    s_add_u32 s8, s8, 1024
    buffer_load_dwordx4 v9, s[56:59], s7 offen lds
    s_add_u32 s7, s7, 16384
    s_mov_b32 m0, s8
    s_add_u32 s8, s8, 1024
    buffer_load_dwordx4 v9, s[56:59], s7 offen lds
    s_add_u32 s7, s7, 16384
    s_mov_b32 m0, s8
    s_add_u32 s8, s8, 1024
    buffer_load_dwordx4 v9, s[56:59], s7 offen lds
    s_add_u32 s7, s7, 16384
    s_mov_b32 m0, s8
    s_add_u32 s8, s8, 1024
    buffer_load_dwordx4 v9, s[56:59], s7 offen lds
    s_add_u32 s7, s7, 16384
    s_mov_b32 m0, s8
    s_add_u32 s8, s8, 1024
    buffer_load_dwordx4 v9, s[56:59], s7 offen lds
    s_add_u32 s7, s7, 16384
    s_mov_b32 m0, s8
    s_add_u32 s8, s8, 1024
    buffer_load_dwordx4 v9, s[56:59], s7 offen lds
    s_add_u32 s7, s7, 16384
    s_mov_b32 m0, s8
    s_add_u32 s8, s8, 1024
    buffer_load_dwordx4 v9, s[56:59], s7 offen lds
    s_add_u32 s7, s7, 16384
    s_waitcnt vmcnt(0)
    s_barrier
    ds_read_b64_tr_b16 a[208:209], v10 offset:32768
    ds_read_b64_tr_b16 a[210:211], v10 offset:34816
    ds_read_b64_tr_b16 a[212:213], v10 offset:36864
    ds_read_b64_tr_b16 a[214:215], v10 offset:38912
    ds_read_b64_tr_b16 a[216:217], v10 offset:40960
    ds_read_b64_tr_b16 a[218:219], v10 offset:43008
    ds_read_b64_tr_b16 a[220:221], v11 offset:0
    ds_read_b64_tr_b16 a[222:223], v11 offset:2048
    ds_read_b64_tr_b16 a[224:225], v11 offset:4096
    ds_read_b64_tr_b16 a[226:227], v11 offset:6144
    ds_read_b64_tr_b16 a[228:229], v11 offset:8192
    ds_read_b64_tr_b16 a[230:231], v11 offset:10240
    ds_read_b64_tr_b16 a[232:233], v11 offset:16384
    ds_read_b64_tr_b16 a[234:235], v11 offset:18432
    ds_read_b64_tr_b16 a[236:237], v11 offset:20480
    ds_read_b64_tr_b16 a[238:239], v11 offset:22528
    ds_read_b64_tr_b16 a[240:241], v11 offset:24576
    ds_read_b64_tr_b16 a[242:243], v11 offset:26624
    ds_read_b64_tr_b16 a[244:245], v11 offset:32768
    ds_read_b64_tr_b16 a[246:247], v11 offset:34816
    ds_read_b64_tr_b16 a[248:249], v11 offset:36864
    ds_read_b64_tr_b16 a[250:251], v11 offset:38912
    ds_read_b64_tr_b16 a[252:253], v11 offset:40960
    ds_read_b64_tr_b16 a[254:255], v11 offset:43008
    s_waitcnt lgkmcnt(0)
    s_barrier
    s_mul_i32 s7, s4, 1179648
    s_add_u32 s7, s7, s6
    s_add_u32 s7, s7, 1245184
    s_mov_b32 s8, s9
    s_mov_b32 m0, s8
    s_add_u32 s8, s8, 1024
    buffer_load_dwordx4 v9, s[56:59], s7 offen lds
    s_add_u32 s7, s7, 16384
    s_mov_b32 m0, s8
    s_add_u32 s8, s8, 1024
    buffer_load_dwordx4 v9, s[56:59], s7 offen lds
    s_add_u32 s7, s7, 16384
    s_mov_b32 m0, s8
    s_add_u32 s8, s8, 1024
    buffer_load_dwordx4 v9, s[56:59], s7 offen lds
    s_add_u32 s7, s7, 16384
    s_mov_b32 m0, s8
    s_add_u32 s8, s8, 1024
    buffer_load_dwordx4 v9, s[56:59], s7 offen lds
    s_add_u32 s7, s7, 212992
    s_mov_b32 m0, s8
    s_add_u32 s8, s8, 1024
    buffer_load_dwordx4 v9, s[56:59], s7 offen lds
    s_add_u32 s7, s7, 16384
    s_mov_b32 m0, s8
    s_add_u32 s8, s8, 1024
    buffer_load_dwordx4 v9, s[56:59], s7 offen lds
    s_add_u32 s7, s7, 16384
    s_mov_b32 m0, s8
    s_add_u32 s8, s8, 1024
    buffer_load_dwordx4 v9, s[56:59], s7 offen lds
    s_add_u32 s7, s7, 16384
    s_mov_b32 m0, s8
    s_add_u32 s8, s8, 1024
    buffer_load_dwordx4 v9, s[56:59], s7 offen lds
    s_add_u32 s7, s7, 212992
    s_mov_b32 m0, s8
    s_add_u32 s8, s8, 1024
    buffer_load_dwordx4 v9, s[56:59], s7 offen lds
    s_add_u32 s7, s7, 16384
    s_mov_b32 m0, s8
    s_add_u32 s8, s8, 1024
    buffer_load_dwordx4 v9, s[56:59], s7 offen lds
    s_add_u32 s7, s7, 16384
    s_mov_b32 m0, s8
    s_add_u32 s8, s8, 1024
    buffer_load_dwordx4 v9, s[56:59], s7 offen lds
    s_add_u32 s7, s7, 16384
    s_mov_b32 m0, s8
    s_add_u32 s8, s8, 1024
    buffer_load_dwordx4 v9, s[56:59], s7 offen lds
    s_add_u32 s7, s7, 212992
    s_mov_b32 m0, s8
    s_add_u32 s8, s8, 1024
    buffer_load_dwordx4 v9, s[56:59], s7 offen lds
    s_add_u32 s7, s7, 16384
    s_mov_b32 m0, s8
    s_add_u32 s8, s8, 1024
    buffer_load_dwordx4 v9, s[56:59], s7 offen lds
    s_add_u32 s7, s7, 16384
    s_mov_b32 m0, s8
    s_add_u32 s8, s8, 1024
    buffer_load_dwordx4 v9, s[56:59], s7 offen lds
    s_add_u32 s7, s7, 16384
    s_mov_b32 m0, s8
    s_add_u32 s8, s8, 1024
    buffer_load_dwordx4 v9, s[56:59], s7 offen lds
    s_add_u32 s7, s7, 212992
    s_mov_b32 m0, s8
    s_add_u32 s8, s8, 1024
    buffer_load_dwordx4 v9, s[56:59], s7 offen lds
    s_add_u32 s7, s7, 16384
    s_mov_b32 m0, s8
    s_add_u32 s8, s8, 1024
    buffer_load_dwordx4 v9, s[56:59], s7 offen lds
    s_add_u32 s7, s7, 16384
    s_mov_b32 m0, s8
    s_add_u32 s8, s8, 1024
    buffer_load_dwordx4 v9, s[56:59], s7 offen lds
    s_add_u32 s7, s7, 16384
    s_mov_b32 m0, s8
    s_add_u32 s8, s8, 1024
    buffer_load_dwordx4 v9, s[56:59], s7 offen lds
    s_add_u32 s7, s7, 212992
    s_mov_b32 m0, s8
    s_add_u32 s8, s8, 1024
    buffer_load_dwordx4 v9, s[56:59], s7 offen lds
    s_add_u32 s7, s7, 16384
    s_mov_b32 m0, s8
    s_add_u32 s8, s8, 1024
    buffer_load_dwordx4 v9, s[56:59], s7 offen lds
    s_add_u32 s7, s7, 16384
    s_mov_b32 m0, s8
    s_add_u32 s8, s8, 1024
    buffer_load_dwordx4 v9, s[56:59], s7 offen lds
    s_add_u32 s7, s7, 16384
    s_mov_b32 m0, s8
    s_add_u32 s8, s8, 1024
    buffer_load_dwordx4 v9, s[56:59], s7 offen lds
    s_add_u32 s7, s7, 212992
    s_waitcnt vmcnt(0)
    s_barrier
    s_mov_b32 s75, 1
    s_branch W_g2_69
W_back_71:
    s_cmp_lt_u32 s100, 144
    s_cbranch_scc1 W_g2_69
    s_cmp_ge_u32 s100, 200
    s_cbranch_scc1 W_n_67
    s_sub_u32 s3, s100, 144
    v_and_b32 v1, 63, v0
    v_and_b32 v2, 15, v1
    v_lshrrev_b32 v3, 4, v1
    v_lshrrev_b32 v4, 2, v2
    v_and_b32 v5, 3, v2
    v_lshrrev_b32 v6, 1, v3
    v_and_b32 v7, 1, v3
    v_lshlrev_b32 v8, 4, v1
    s_mov_b32 s56, s32
    s_and_b32 s57, s33, 0xffff
    s_mov_b32 s58, 0x700000
    s_mov_b32 s59, 0x00020000
    s_mov_b32 s64, s34
    s_and_b32 s65, s35, 0xffff
    s_mov_b32 s66, 0xe00
    s_mov_b32 s67, 0x00020000
    v_lshlrev_b32 v25, 2, v1
    s_and_b32 s5, s3, 3
    s_lshr_b32 s6, s3, 2
    s_and_b32 s92, s4, 1
    s_lshr_b32 s93, s4, 1
    v_lshlrev_b32 v9, 2, v3
    v_xor_b32 v9, v9, v2
    v_lshlrev_b32 v9, 4, v9
    s_lshl_b32 s7, s4, 3
    v_add_u32 v10, s7, v3
    v_lshl_add_u32 v11, v10, 10, v9
    s_movk_i32 s7, 3584
    v_mul_lo_u32 v12, v10, s7
    v_add_u32 v12, v12, v9
    s_lshl_b32 s94, s5, 8
    s_add_u32 s94, s94, 5242880
    s_lshl_b32 s95, s6, 8
    s_lshl_b32 s96, s4, 11
    s_lshl_b32 s91, s5, 13
    s_add_u32 s91, s91, 24576
    v_lshl_add_u32 v13, v6, 3, v4
    v_lshlrev_b32 v13, 8, v13
    v_lshl_add_u32 v13, v7, 5, v13
    v_lshl_add_u32 v13, v5, 3, v13
    s_lshl_b32 s7, s92, 1
    s_add_u32 s7, s7, 0
    v_xor_b32 v14, s7, v4
    v_lshl_add_u32 v16, v14, 6, v13
    s_lshl_b32 s7, s93, 1
    s_add_u32 s7, s7, 0
    v_xor_b32 v14, s7, v4
    v_lshl_add_u32 v18, v14, 6, v13
    v_add_u32 v18, 0x2000, v18
    s_lshl_b32 s7, s92, 1
    s_add_u32 s7, s7, 1
    v_xor_b32 v14, s7, v4
    v_lshl_add_u32 v17, v14, 6, v13
    s_lshl_b32 s7, s93, 1
    s_add_u32 s7, s7, 1
    v_xor_b32 v14, s7, v4
    v_lshl_add_u32 v19, v14, 6, v13
    v_add_u32 v19, 0x2000, v19
    s_lshl_b32 s8, s5, 2
    s_lshl_b32 s9, s92, 1
    s_add_u32 s8, s8, s9
    s_mul_i32 s8, s8, 112
    s_lshl_b32 s9, s6, 3
    s_add_u32 s8, s8, s9
    s_lshl_b32 s9, s93, 2
    s_add_u32 s8, s8, s9
    s_lshl_b32 s8, s8, 10
    s_add_u32 s88, s8, 7340032
    s_mov_b32 s90, 0xbdd2d3e8
    v_mov_b32 v26, 0xc0135761
    s_mov_b32 s74, 0x40000000
    s_branch G1_fin_135
G1_real_136:
    s_lshl_b32 s8, s6, 8
    s_lshl_b32 s9, s93, 7
    s_add_u32 s8, s8, s9
    v_lshlrev_b32 v20, 3, v6
    buffer_load_dwordx2 v[32:33], v20, s[64:67], s8 offen offset:0
    buffer_load_dwordx2 v[34:35], v20, s[64:67], s8 offen offset:16
    buffer_load_dwordx2 v[36:37], v20, s[64:67], s8 offen offset:32
    buffer_load_dwordx2 v[38:39], v20, s[64:67], s8 offen offset:48
    buffer_load_dwordx2 v[40:41], v20, s[64:67], s8 offen offset:64
    buffer_load_dwordx2 v[42:43], v20, s[64:67], s8 offen offset:80
    buffer_load_dwordx2 v[44:45], v20, s[64:67], s8 offen offset:96
    buffer_load_dwordx2 v[46:47], v20, s[64:67], s8 offen offset:112
    s_waitcnt vmcnt(0)
    v_lshlrev_b32 v64, 16, v32
    v_and_b32 v65, 0xffff0000, v32
    v_lshlrev_b32 v66, 16, v33
    v_and_b32 v67, 0xffff0000, v33
    v_lshlrev_b32 v68, 16, v34
    v_and_b32 v69, 0xffff0000, v34
    v_lshlrev_b32 v70, 16, v35
    v_and_b32 v71, 0xffff0000, v35
    v_lshlrev_b32 v72, 16, v36
    v_and_b32 v73, 0xffff0000, v36
    v_lshlrev_b32 v74, 16, v37
    v_and_b32 v75, 0xffff0000, v37
    v_lshlrev_b32 v76, 16, v38
    v_and_b32 v77, 0xffff0000, v38
    v_lshlrev_b32 v78, 16, v39
    v_and_b32 v79, 0xffff0000, v39
    v_lshlrev_b32 v80, 16, v32
    v_and_b32 v81, 0xffff0000, v32
    v_lshlrev_b32 v82, 16, v33
    v_and_b32 v83, 0xffff0000, v33
    v_lshlrev_b32 v84, 16, v34
    v_and_b32 v85, 0xffff0000, v34
    v_lshlrev_b32 v86, 16, v35
    v_and_b32 v87, 0xffff0000, v35
    v_lshlrev_b32 v88, 16, v36
    v_and_b32 v89, 0xffff0000, v36
    v_lshlrev_b32 v90, 16, v37
    v_and_b32 v91, 0xffff0000, v37
    v_lshlrev_b32 v92, 16, v38
    v_and_b32 v93, 0xffff0000, v38
    v_lshlrev_b32 v94, 16, v39
    v_and_b32 v95, 0xffff0000, v39
    v_lshlrev_b32 v96, 16, v40
    v_and_b32 v97, 0xffff0000, v40
    v_lshlrev_b32 v98, 16, v41
    v_and_b32 v99, 0xffff0000, v41
    v_lshlrev_b32 v100, 16, v42
    v_and_b32 v101, 0xffff0000, v42
    v_lshlrev_b32 v102, 16, v43
    v_and_b32 v103, 0xffff0000, v43
    v_lshlrev_b32 v104, 16, v44
    v_and_b32 v105, 0xffff0000, v44
    v_lshlrev_b32 v106, 16, v45
    v_and_b32 v107, 0xffff0000, v45
    v_lshlrev_b32 v108, 16, v46
    v_and_b32 v109, 0xffff0000, v46
    v_lshlrev_b32 v110, 16, v47
    v_and_b32 v111, 0xffff0000, v47
    v_lshlrev_b32 v112, 16, v40
    v_and_b32 v113, 0xffff0000, v40
    v_lshlrev_b32 v114, 16, v41
    v_and_b32 v115, 0xffff0000, v41
    v_lshlrev_b32 v116, 16, v42
    v_and_b32 v117, 0xffff0000, v42
    v_lshlrev_b32 v118, 16, v43
    v_and_b32 v119, 0xffff0000, v43
    v_lshlrev_b32 v120, 16, v44
    v_and_b32 v121, 0xffff0000, v44
    v_lshlrev_b32 v122, 16, v45
    v_and_b32 v123, 0xffff0000, v45
    v_lshlrev_b32 v124, 16, v46
    v_and_b32 v125, 0xffff0000, v46
    v_lshlrev_b32 v126, 16, v47
    v_and_b32 v127, 0xffff0000, v47
    v_lshrrev_b32 v27, 1, v1
    s_movk_i32 s7, 3584
    v_mul_lo_u32 v27, v27, s7
    v_and_b32 v28, 1, v1
    v_lshl_add_u32 v27, v28, 7, v27
    s_mul_i32 s8, s4, 1835008
    s_add_u32 s8, s8, s95
    buffer_load_dword v28, v27, s[56:59], s8 offen
    s_add_u32 s8, s8, 114688
    buffer_load_dword v28, v27, s[56:59], s8 offen
    s_add_u32 s8, s8, 114688
    buffer_load_dword v28, v27, s[56:59], s8 offen
    s_add_u32 s8, s8, 114688
    buffer_load_dword v28, v27, s[56:59], s8 offen
    s_add_u32 s8, s8, 114688
    buffer_load_dword v28, v27, s[56:59], s8 offen
    s_add_u32 s8, s8, 114688
    buffer_load_dword v28, v27, s[56:59], s8 offen
    s_add_u32 s8, s8, 114688
    buffer_load_dword v28, v27, s[56:59], s8 offen
    s_add_u32 s8, s8, 114688
    buffer_load_dword v28, v27, s[56:59], s8 offen
    s_add_u32 s8, s8, 114688
    buffer_load_dword v28, v27, s[56:59], s8 offen
    s_add_u32 s8, s8, 114688
    buffer_load_dword v28, v27, s[56:59], s8 offen
    s_add_u32 s8, s8, 114688
    buffer_load_dword v28, v27, s[56:59], s8 offen
    s_add_u32 s8, s8, 114688
    buffer_load_dword v28, v27, s[56:59], s8 offen
    s_add_u32 s8, s8, 114688
    buffer_load_dword v28, v27, s[56:59], s8 offen
    s_add_u32 s8, s8, 114688
    buffer_load_dword v28, v27, s[56:59], s8 offen
    s_add_u32 s8, s8, 114688
    buffer_load_dword v28, v27, s[56:59], s8 offen
    s_add_u32 s8, s8, 114688
    buffer_load_dword v28, v27, s[56:59], s8 offen
    s_add_u32 s8, s8, 114688
    s_mov_b32 s97, 0
    s_mov_b32 s89, 1
G1_loop_137:
    s_and_b32 s98, s97, 1
    s_lshl_b32 s98, s98, 15
    s_add_u32 s11, s98, s96
    s_mul_i32 s10, s97, 229376
    s_add_u32 s10, s10, s95
    s_lshl_b32 s9, s97, 16
    s_add_u32 s9, s9, s94
    s_add_u32 s12, s11, 8192
    s_mov_b32 m0, s12
    s_add_u32 s13, s10, 0
    buffer_load_dwordx4 v12, s[56:59], s13 offen lds
    s_add_u32 s12, s11, 9216
    s_mov_b32 m0, s12
    s_add_u32 s13, s10, 14336
    buffer_load_dwordx4 v12, s[56:59], s13 offen lds
    s_add_u32 s12, s11, 24576
    s_mov_b32 m0, s12
    s_add_u32 s13, s10, 114688
    buffer_load_dwordx4 v12, s[56:59], s13 offen lds
    s_add_u32 s12, s11, 25600
    s_mov_b32 m0, s12
    s_add_u32 s13, s10, 129024
    buffer_load_dwordx4 v12, s[56:59], s13 offen lds
    s_lshl_b32 s12, s97, 8
    s_add_u32 s12, s12, s91
    s_cmp_lg_u32 s4, 0
    s_cbranch_scc1 WFW_138
FW_139:
    buffer_load_dword v24, v25, s[52:55], s12 offen sc1
    s_add_u32 s79, s79, 1
    s_cmp_gt_u32 s79, 2097152
    s_cbranch_scc1 mega_kernel_exit
    s_waitcnt vmcnt(0)
    v_cmp_gt_u32 vcc, s89, v24
    s_nop 0
    s_cbranch_vccz FWok_140
    s_sleep 1
    s_branch FW_139
FWok_140:
WFW_138:
    s_barrier
    s_lshl_b32 s8, s97, 1
    s_add_u32 s12, s11, 0
    s_mov_b32 m0, s12
    s_add_u32 s13, s9, 0
    buffer_load_dwordx4 v11, s[52:55], s13 offen sc1 lds
    s_add_u32 s12, s11, 1024
    s_mov_b32 m0, s12
    s_add_u32 s13, s9, 4096
    buffer_load_dwordx4 v11, s[52:55], s13 offen sc1 lds
    s_add_u32 s12, s11, 16384
    s_mov_b32 m0, s12
    s_add_u32 s13, s9, 32768
    buffer_load_dwordx4 v11, s[52:55], s13 offen sc1 lds
    s_add_u32 s12, s11, 17408
    s_mov_b32 m0, s12
    s_add_u32 s13, s9, 36864
    buffer_load_dwordx4 v11, s[52:55], s13 offen sc1 lds
    v_add_u32 v20, s98, v16
    v_add_u32 v21, s98, v17
    v_add_u32 v22, s98, v18
    v_add_u32 v23, s98, v19
    s_waitcnt vmcnt(0)
    s_barrier
    ds_read_b64_tr_b16 v[32:33], v20 offset:0
    ds_read_b64_tr_b16 v[48:49], v22 offset:0
    ds_read_b64_tr_b16 v[34:35], v20 offset:1024
    ds_read_b64_tr_b16 v[50:51], v22 offset:1024
    ds_read_b64_tr_b16 v[36:37], v21 offset:0
    ds_read_b64_tr_b16 v[52:53], v23 offset:0
    ds_read_b64_tr_b16 v[38:39], v21 offset:1024
    ds_read_b64_tr_b16 v[54:55], v23 offset:1024
    ds_read_b64_tr_b16 v[40:41], v20 offset:4096
    ds_read_b64_tr_b16 v[56:57], v22 offset:4096
    ds_read_b64_tr_b16 v[42:43], v20 offset:5120
    ds_read_b64_tr_b16 v[58:59], v22 offset:5120
    ds_read_b64_tr_b16 v[44:45], v21 offset:4096
    ds_read_b64_tr_b16 v[60:61], v23 offset:4096
    ds_read_b64_tr_b16 v[46:47], v21 offset:5120
    ds_read_b64_tr_b16 v[62:63], v23 offset:5120
    s_waitcnt lgkmcnt(8)
    v_mfma_f32_32x32x16_bf16 v[64:79], v[48:51], v[32:35], v[64:79]
    v_mfma_f32_32x32x16_bf16 v[80:95], v[48:51], v[36:39], v[80:95]
    v_mfma_f32_32x32x16_bf16 v[96:111], v[52:55], v[32:35], v[96:111]
    v_mfma_f32_32x32x16_bf16 v[112:127], v[52:55], v[36:39], v[112:127]
    ds_read_b64_tr_b16 v[32:33], v20 offset:16384
    ds_read_b64_tr_b16 v[48:49], v22 offset:16384
    ds_read_b64_tr_b16 v[34:35], v20 offset:17408
    ds_read_b64_tr_b16 v[50:51], v22 offset:17408
    ds_read_b64_tr_b16 v[36:37], v21 offset:16384
    ds_read_b64_tr_b16 v[52:53], v23 offset:16384
    ds_read_b64_tr_b16 v[38:39], v21 offset:17408
    ds_read_b64_tr_b16 v[54:55], v23 offset:17408
    s_waitcnt lgkmcnt(8)
    v_mfma_f32_32x32x16_bf16 v[64:79], v[56:59], v[40:43], v[64:79]
    v_mfma_f32_32x32x16_bf16 v[80:95], v[56:59], v[44:47], v[80:95]
    v_mfma_f32_32x32x16_bf16 v[96:111], v[60:63], v[40:43], v[96:111]
    v_mfma_f32_32x32x16_bf16 v[112:127], v[60:63], v[44:47], v[112:127]
    ds_read_b64_tr_b16 v[40:41], v20 offset:20480
    ds_read_b64_tr_b16 v[56:57], v22 offset:20480
    ds_read_b64_tr_b16 v[42:43], v20 offset:21504
    ds_read_b64_tr_b16 v[58:59], v22 offset:21504
    ds_read_b64_tr_b16 v[44:45], v21 offset:20480
    ds_read_b64_tr_b16 v[60:61], v23 offset:20480
    ds_read_b64_tr_b16 v[46:47], v21 offset:21504
    ds_read_b64_tr_b16 v[62:63], v23 offset:21504
    s_waitcnt lgkmcnt(8)
    v_mfma_f32_32x32x16_bf16 v[64:79], v[48:51], v[32:35], v[64:79]
    v_mfma_f32_32x32x16_bf16 v[80:95], v[48:51], v[36:39], v[80:95]
    v_mfma_f32_32x32x16_bf16 v[96:111], v[52:55], v[32:35], v[96:111]
    v_mfma_f32_32x32x16_bf16 v[112:127], v[52:55], v[36:39], v[112:127]
    s_waitcnt lgkmcnt(0)
    v_mfma_f32_32x32x16_bf16 v[64:79], v[56:59], v[40:43], v[64:79]
    v_mfma_f32_32x32x16_bf16 v[80:95], v[56:59], v[44:47], v[80:95]
    v_mfma_f32_32x32x16_bf16 v[96:111], v[60:63], v[40:43], v[96:111]
    v_mfma_f32_32x32x16_bf16 v[112:127], v[60:63], v[44:47], v[112:127]
    s_add_u32 s97, s97, 1
    s_cmp_lt_u32 s97, 32
    s_cbranch_scc1 G1_loop_137
G1_fin_135:
    s_add_u32 s8, s88, s74
    s_add_u32 s9, s8, 114688
    s_nop 3
    v_pk_mul_f32 v[32:33], v[64:65], v[64:65]
    v_pk_mul_f32 v[34:35], v[66:67], v[66:67]
    v_pk_mul_f32 v[36:37], v[68:69], v[68:69]
    v_pk_mul_f32 v[38:39], v[70:71], v[70:71]
    v_fma_f32 v32, v32, s90, v26
    v_fma_f32 v33, v33, s90, v26
    v_fma_f32 v34, v34, s90, v26
    v_fma_f32 v35, v35, s90, v26
    v_fma_f32 v36, v36, s90, v26
    v_fma_f32 v37, v37, s90, v26
    v_fma_f32 v38, v38, s90, v26
    v_fma_f32 v39, v39, s90, v26
    v_pk_mul_f32 v[32:33], v[32:33], v[64:65]
    v_pk_mul_f32 v[34:35], v[34:35], v[66:67]
    v_pk_mul_f32 v[36:37], v[36:37], v[68:69]
    v_pk_mul_f32 v[38:39], v[38:39], v[70:71]
    v_exp_f32 v32, v32
    v_exp_f32 v33, v33
    v_exp_f32 v34, v34
    v_exp_f32 v35, v35
    v_exp_f32 v36, v36
    v_exp_f32 v37, v37
    v_exp_f32 v38, v38
    v_exp_f32 v39, v39
    v_pk_add_f32 v[32:33], v[32:33], 1.0 op_sel_hi:[1,0]
    v_pk_add_f32 v[34:35], v[34:35], 1.0 op_sel_hi:[1,0]
    v_pk_add_f32 v[36:37], v[36:37], 1.0 op_sel_hi:[1,0]
    v_pk_add_f32 v[38:39], v[38:39], 1.0 op_sel_hi:[1,0]
    v_rcp_f32 v32, v32
    v_rcp_f32 v33, v33
    v_rcp_f32 v34, v34
    v_rcp_f32 v35, v35
    v_rcp_f32 v36, v36
    v_rcp_f32 v37, v37
    v_rcp_f32 v38, v38
    v_rcp_f32 v39, v39
    v_pk_mul_f32 v[64:65], v[64:65], v[32:33]
    v_pk_mul_f32 v[66:67], v[66:67], v[34:35]
    v_pk_mul_f32 v[68:69], v[68:69], v[36:37]
    v_pk_mul_f32 v[70:71], v[70:71], v[38:39]
    v_cvt_pk_bf16_f32 v64, v64, v65
    v_cvt_pk_bf16_f32 v65, v66, v67
    v_cvt_pk_bf16_f32 v66, v68, v69
    v_cvt_pk_bf16_f32 v67, v70, v71
    buffer_store_dwordx4 v[64:67], v8, s[52:55], s8 offen offset:0 sc1
    v_pk_mul_f32 v[32:33], v[72:73], v[72:73]
    v_pk_mul_f32 v[34:35], v[74:75], v[74:75]
    v_pk_mul_f32 v[36:37], v[76:77], v[76:77]
    v_pk_mul_f32 v[38:39], v[78:79], v[78:79]
    v_fma_f32 v32, v32, s90, v26
    v_fma_f32 v33, v33, s90, v26
    v_fma_f32 v34, v34, s90, v26
    v_fma_f32 v35, v35, s90, v26
    v_fma_f32 v36, v36, s90, v26
    v_fma_f32 v37, v37, s90, v26
    v_fma_f32 v38, v38, s90, v26
    v_fma_f32 v39, v39, s90, v26
    v_pk_mul_f32 v[32:33], v[32:33], v[72:73]
    v_pk_mul_f32 v[34:35], v[34:35], v[74:75]
    v_pk_mul_f32 v[36:37], v[36:37], v[76:77]
    v_pk_mul_f32 v[38:39], v[38:39], v[78:79]
    v_exp_f32 v32, v32
    v_exp_f32 v33, v33
    v_exp_f32 v34, v34
    v_exp_f32 v35, v35
    v_exp_f32 v36, v36
    v_exp_f32 v37, v37
    v_exp_f32 v38, v38
    v_exp_f32 v39, v39
    v_pk_add_f32 v[32:33], v[32:33], 1.0 op_sel_hi:[1,0]
    v_pk_add_f32 v[34:35], v[34:35], 1.0 op_sel_hi:[1,0]
    v_pk_add_f32 v[36:37], v[36:37], 1.0 op_sel_hi:[1,0]
    v_pk_add_f32 v[38:39], v[38:39], 1.0 op_sel_hi:[1,0]
    v_rcp_f32 v32, v32
    v_rcp_f32 v33, v33
    v_rcp_f32 v34, v34
    v_rcp_f32 v35, v35
    v_rcp_f32 v36, v36
    v_rcp_f32 v37, v37
    v_rcp_f32 v38, v38
    v_rcp_f32 v39, v39
    v_pk_mul_f32 v[72:73], v[72:73], v[32:33]
    v_pk_mul_f32 v[74:75], v[74:75], v[34:35]
    v_pk_mul_f32 v[76:77], v[76:77], v[36:37]
    v_pk_mul_f32 v[78:79], v[78:79], v[38:39]
    v_cvt_pk_bf16_f32 v72, v72, v73
    v_cvt_pk_bf16_f32 v73, v74, v75
    v_cvt_pk_bf16_f32 v74, v76, v77
    v_cvt_pk_bf16_f32 v75, v78, v79
    buffer_store_dwordx4 v[72:75], v8, s[52:55], s8 offen offset:1024 sc1
    v_pk_mul_f32 v[32:33], v[80:81], v[80:81]
    v_pk_mul_f32 v[34:35], v[82:83], v[82:83]
    v_pk_mul_f32 v[36:37], v[84:85], v[84:85]
    v_pk_mul_f32 v[38:39], v[86:87], v[86:87]
    v_fma_f32 v32, v32, s90, v26
    v_fma_f32 v33, v33, s90, v26
    v_fma_f32 v34, v34, s90, v26
    v_fma_f32 v35, v35, s90, v26
    v_fma_f32 v36, v36, s90, v26
    v_fma_f32 v37, v37, s90, v26
    v_fma_f32 v38, v38, s90, v26
    v_fma_f32 v39, v39, s90, v26
    v_pk_mul_f32 v[32:33], v[32:33], v[80:81]
    v_pk_mul_f32 v[34:35], v[34:35], v[82:83]
    v_pk_mul_f32 v[36:37], v[36:37], v[84:85]
    v_pk_mul_f32 v[38:39], v[38:39], v[86:87]
    v_exp_f32 v32, v32
    v_exp_f32 v33, v33
    v_exp_f32 v34, v34
    v_exp_f32 v35, v35
    v_exp_f32 v36, v36
    v_exp_f32 v37, v37
    v_exp_f32 v38, v38
    v_exp_f32 v39, v39
    v_pk_add_f32 v[32:33], v[32:33], 1.0 op_sel_hi:[1,0]
    v_pk_add_f32 v[34:35], v[34:35], 1.0 op_sel_hi:[1,0]
    v_pk_add_f32 v[36:37], v[36:37], 1.0 op_sel_hi:[1,0]
    v_pk_add_f32 v[38:39], v[38:39], 1.0 op_sel_hi:[1,0]
    v_rcp_f32 v32, v32
    v_rcp_f32 v33, v33
    v_rcp_f32 v34, v34
    v_rcp_f32 v35, v35
    v_rcp_f32 v36, v36
    v_rcp_f32 v37, v37
    v_rcp_f32 v38, v38
    v_rcp_f32 v39, v39
    v_pk_mul_f32 v[80:81], v[80:81], v[32:33]
    v_pk_mul_f32 v[82:83], v[82:83], v[34:35]
    v_pk_mul_f32 v[84:85], v[84:85], v[36:37]
    v_pk_mul_f32 v[86:87], v[86:87], v[38:39]
    v_cvt_pk_bf16_f32 v80, v80, v81
    v_cvt_pk_bf16_f32 v81, v82, v83
    v_cvt_pk_bf16_f32 v82, v84, v85
    v_cvt_pk_bf16_f32 v83, v86, v87
    buffer_store_dwordx4 v[80:83], v8, s[52:55], s9 offen offset:0 sc1
    v_pk_mul_f32 v[32:33], v[88:89], v[88:89]
    v_pk_mul_f32 v[34:35], v[90:91], v[90:91]
    v_pk_mul_f32 v[36:37], v[92:93], v[92:93]
    v_pk_mul_f32 v[38:39], v[94:95], v[94:95]
    v_fma_f32 v32, v32, s90, v26
    v_fma_f32 v33, v33, s90, v26
    v_fma_f32 v34, v34, s90, v26
    v_fma_f32 v35, v35, s90, v26
    v_fma_f32 v36, v36, s90, v26
    v_fma_f32 v37, v37, s90, v26
    v_fma_f32 v38, v38, s90, v26
    v_fma_f32 v39, v39, s90, v26
    v_pk_mul_f32 v[32:33], v[32:33], v[88:89]
    v_pk_mul_f32 v[34:35], v[34:35], v[90:91]
    v_pk_mul_f32 v[36:37], v[36:37], v[92:93]
    v_pk_mul_f32 v[38:39], v[38:39], v[94:95]
    v_exp_f32 v32, v32
    v_exp_f32 v33, v33
    v_exp_f32 v34, v34
    v_exp_f32 v35, v35
    v_exp_f32 v36, v36
    v_exp_f32 v37, v37
    v_exp_f32 v38, v38
    v_exp_f32 v39, v39
    v_pk_add_f32 v[32:33], v[32:33], 1.0 op_sel_hi:[1,0]
    v_pk_add_f32 v[34:35], v[34:35], 1.0 op_sel_hi:[1,0]
    v_pk_add_f32 v[36:37], v[36:37], 1.0 op_sel_hi:[1,0]
    v_pk_add_f32 v[38:39], v[38:39], 1.0 op_sel_hi:[1,0]
    v_rcp_f32 v32, v32
    v_rcp_f32 v33, v33
    v_rcp_f32 v34, v34
    v_rcp_f32 v35, v35
    v_rcp_f32 v36, v36
    v_rcp_f32 v37, v37
    v_rcp_f32 v38, v38
    v_rcp_f32 v39, v39
    v_pk_mul_f32 v[88:89], v[88:89], v[32:33]
    v_pk_mul_f32 v[90:91], v[90:91], v[34:35]
    v_pk_mul_f32 v[92:93], v[92:93], v[36:37]
    v_pk_mul_f32 v[94:95], v[94:95], v[38:39]
    v_cvt_pk_bf16_f32 v88, v88, v89
    v_cvt_pk_bf16_f32 v89, v90, v91
    v_cvt_pk_bf16_f32 v90, v92, v93
    v_cvt_pk_bf16_f32 v91, v94, v95
    buffer_store_dwordx4 v[88:91], v8, s[52:55], s9 offen offset:1024 sc1
    v_pk_mul_f32 v[32:33], v[96:97], v[96:97]
    v_pk_mul_f32 v[34:35], v[98:99], v[98:99]
    v_pk_mul_f32 v[36:37], v[100:101], v[100:101]
    v_pk_mul_f32 v[38:39], v[102:103], v[102:103]
    v_fma_f32 v32, v32, s90, v26
    v_fma_f32 v33, v33, s90, v26
    v_fma_f32 v34, v34, s90, v26
    v_fma_f32 v35, v35, s90, v26
    v_fma_f32 v36, v36, s90, v26
    v_fma_f32 v37, v37, s90, v26
    v_fma_f32 v38, v38, s90, v26
    v_fma_f32 v39, v39, s90, v26
    v_pk_mul_f32 v[32:33], v[32:33], v[96:97]
    v_pk_mul_f32 v[34:35], v[34:35], v[98:99]
    v_pk_mul_f32 v[36:37], v[36:37], v[100:101]
    v_pk_mul_f32 v[38:39], v[38:39], v[102:103]
    v_exp_f32 v32, v32
    v_exp_f32 v33, v33
    v_exp_f32 v34, v34
    v_exp_f32 v35, v35
    v_exp_f32 v36, v36
    v_exp_f32 v37, v37
    v_exp_f32 v38, v38
    v_exp_f32 v39, v39
    v_pk_add_f32 v[32:33], v[32:33], 1.0 op_sel_hi:[1,0]
    v_pk_add_f32 v[34:35], v[34:35], 1.0 op_sel_hi:[1,0]
    v_pk_add_f32 v[36:37], v[36:37], 1.0 op_sel_hi:[1,0]
    v_pk_add_f32 v[38:39], v[38:39], 1.0 op_sel_hi:[1,0]
    v_rcp_f32 v32, v32
    v_rcp_f32 v33, v33
    v_rcp_f32 v34, v34
    v_rcp_f32 v35, v35
    v_rcp_f32 v36, v36
    v_rcp_f32 v37, v37
    v_rcp_f32 v38, v38
    v_rcp_f32 v39, v39
    v_pk_mul_f32 v[96:97], v[96:97], v[32:33]
    v_pk_mul_f32 v[98:99], v[98:99], v[34:35]
    v_pk_mul_f32 v[100:101], v[100:101], v[36:37]
    v_pk_mul_f32 v[102:103], v[102:103], v[38:39]
    v_cvt_pk_bf16_f32 v96, v96, v97
    v_cvt_pk_bf16_f32 v97, v98, v99
    v_cvt_pk_bf16_f32 v98, v100, v101
    v_cvt_pk_bf16_f32 v99, v102, v103
    buffer_store_dwordx4 v[96:99], v8, s[52:55], s8 offen offset:2048 sc1
    v_pk_mul_f32 v[32:33], v[104:105], v[104:105]
    v_pk_mul_f32 v[34:35], v[106:107], v[106:107]
    v_pk_mul_f32 v[36:37], v[108:109], v[108:109]
    v_pk_mul_f32 v[38:39], v[110:111], v[110:111]
    v_fma_f32 v32, v32, s90, v26
    v_fma_f32 v33, v33, s90, v26
    v_fma_f32 v34, v34, s90, v26
    v_fma_f32 v35, v35, s90, v26
    v_fma_f32 v36, v36, s90, v26
    v_fma_f32 v37, v37, s90, v26
    v_fma_f32 v38, v38, s90, v26
    v_fma_f32 v39, v39, s90, v26
    v_pk_mul_f32 v[32:33], v[32:33], v[104:105]
    v_pk_mul_f32 v[34:35], v[34:35], v[106:107]
    v_pk_mul_f32 v[36:37], v[36:37], v[108:109]
    v_pk_mul_f32 v[38:39], v[38:39], v[110:111]
    v_exp_f32 v32, v32
    v_exp_f32 v33, v33
    v_exp_f32 v34, v34
    v_exp_f32 v35, v35
    v_exp_f32 v36, v36
    v_exp_f32 v37, v37
    v_exp_f32 v38, v38
    v_exp_f32 v39, v39
    v_pk_add_f32 v[32:33], v[32:33], 1.0 op_sel_hi:[1,0]
    v_pk_add_f32 v[34:35], v[34:35], 1.0 op_sel_hi:[1,0]
    v_pk_add_f32 v[36:37], v[36:37], 1.0 op_sel_hi:[1,0]
    v_pk_add_f32 v[38:39], v[38:39], 1.0 op_sel_hi:[1,0]
    v_rcp_f32 v32, v32
    v_rcp_f32 v33, v33
    v_rcp_f32 v34, v34
    v_rcp_f32 v35, v35
    v_rcp_f32 v36, v36
    v_rcp_f32 v37, v37
    v_rcp_f32 v38, v38
    v_rcp_f32 v39, v39
    v_pk_mul_f32 v[104:105], v[104:105], v[32:33]
    v_pk_mul_f32 v[106:107], v[106:107], v[34:35]
    v_pk_mul_f32 v[108:109], v[108:109], v[36:37]
    v_pk_mul_f32 v[110:111], v[110:111], v[38:39]
    v_cvt_pk_bf16_f32 v104, v104, v105
    v_cvt_pk_bf16_f32 v105, v106, v107
    v_cvt_pk_bf16_f32 v106, v108, v109
    v_cvt_pk_bf16_f32 v107, v110, v111
    buffer_store_dwordx4 v[104:107], v8, s[52:55], s8 offen offset:3072 sc1
    v_pk_mul_f32 v[32:33], v[112:113], v[112:113]
    v_pk_mul_f32 v[34:35], v[114:115], v[114:115]
    v_pk_mul_f32 v[36:37], v[116:117], v[116:117]
    v_pk_mul_f32 v[38:39], v[118:119], v[118:119]
    v_fma_f32 v32, v32, s90, v26
    v_fma_f32 v33, v33, s90, v26
    v_fma_f32 v34, v34, s90, v26
    v_fma_f32 v35, v35, s90, v26
    v_fma_f32 v36, v36, s90, v26
    v_fma_f32 v37, v37, s90, v26
    v_fma_f32 v38, v38, s90, v26
    v_fma_f32 v39, v39, s90, v26
    v_pk_mul_f32 v[32:33], v[32:33], v[112:113]
    v_pk_mul_f32 v[34:35], v[34:35], v[114:115]
    v_pk_mul_f32 v[36:37], v[36:37], v[116:117]
    v_pk_mul_f32 v[38:39], v[38:39], v[118:119]
    v_exp_f32 v32, v32
    v_exp_f32 v33, v33
    v_exp_f32 v34, v34
    v_exp_f32 v35, v35
    v_exp_f32 v36, v36
    v_exp_f32 v37, v37
    v_exp_f32 v38, v38
    v_exp_f32 v39, v39
    v_pk_add_f32 v[32:33], v[32:33], 1.0 op_sel_hi:[1,0]
    v_pk_add_f32 v[34:35], v[34:35], 1.0 op_sel_hi:[1,0]
    v_pk_add_f32 v[36:37], v[36:37], 1.0 op_sel_hi:[1,0]
    v_pk_add_f32 v[38:39], v[38:39], 1.0 op_sel_hi:[1,0]
    v_rcp_f32 v32, v32
    v_rcp_f32 v33, v33
    v_rcp_f32 v34, v34
    v_rcp_f32 v35, v35
    v_rcp_f32 v36, v36
    v_rcp_f32 v37, v37
    v_rcp_f32 v38, v38
    v_rcp_f32 v39, v39
    v_pk_mul_f32 v[112:113], v[112:113], v[32:33]
    v_pk_mul_f32 v[114:115], v[114:115], v[34:35]
    v_pk_mul_f32 v[116:117], v[116:117], v[36:37]
    v_pk_mul_f32 v[118:119], v[118:119], v[38:39]
    v_cvt_pk_bf16_f32 v112, v112, v113
    v_cvt_pk_bf16_f32 v113, v114, v115
    v_cvt_pk_bf16_f32 v114, v116, v117
    v_cvt_pk_bf16_f32 v115, v118, v119
    buffer_store_dwordx4 v[112:115], v8, s[52:55], s9 offen offset:2048 sc1
    v_pk_mul_f32 v[32:33], v[120:121], v[120:121]
    v_pk_mul_f32 v[34:35], v[122:123], v[122:123]
    v_pk_mul_f32 v[36:37], v[124:125], v[124:125]
    v_pk_mul_f32 v[38:39], v[126:127], v[126:127]
    v_fma_f32 v32, v32, s90, v26
    v_fma_f32 v33, v33, s90, v26
    v_fma_f32 v34, v34, s90, v26
    v_fma_f32 v35, v35, s90, v26
    v_fma_f32 v36, v36, s90, v26
    v_fma_f32 v37, v37, s90, v26
    v_fma_f32 v38, v38, s90, v26
    v_fma_f32 v39, v39, s90, v26
    v_pk_mul_f32 v[32:33], v[32:33], v[120:121]
    v_pk_mul_f32 v[34:35], v[34:35], v[122:123]
    v_pk_mul_f32 v[36:37], v[36:37], v[124:125]
    v_pk_mul_f32 v[38:39], v[38:39], v[126:127]
    v_exp_f32 v32, v32
    v_exp_f32 v33, v33
    v_exp_f32 v34, v34
    v_exp_f32 v35, v35
    v_exp_f32 v36, v36
    v_exp_f32 v37, v37
    v_exp_f32 v38, v38
    v_exp_f32 v39, v39
    v_pk_add_f32 v[32:33], v[32:33], 1.0 op_sel_hi:[1,0]
    v_pk_add_f32 v[34:35], v[34:35], 1.0 op_sel_hi:[1,0]
    v_pk_add_f32 v[36:37], v[36:37], 1.0 op_sel_hi:[1,0]
    v_pk_add_f32 v[38:39], v[38:39], 1.0 op_sel_hi:[1,0]
    v_rcp_f32 v32, v32
    v_rcp_f32 v33, v33
    v_rcp_f32 v34, v34
    v_rcp_f32 v35, v35
    v_rcp_f32 v36, v36
    v_rcp_f32 v37, v37
    v_rcp_f32 v38, v38
    v_rcp_f32 v39, v39
    v_pk_mul_f32 v[120:121], v[120:121], v[32:33]
    v_pk_mul_f32 v[122:123], v[122:123], v[34:35]
    v_pk_mul_f32 v[124:125], v[124:125], v[36:37]
    v_pk_mul_f32 v[126:127], v[126:127], v[38:39]
    v_cvt_pk_bf16_f32 v120, v120, v121
    v_cvt_pk_bf16_f32 v121, v122, v123
    v_cvt_pk_bf16_f32 v122, v124, v125
    v_cvt_pk_bf16_f32 v123, v126, v127
    buffer_store_dwordx4 v[120:123], v8, s[52:55], s9 offen offset:3072 sc1
    s_waitcnt vmcnt(0)
    s_barrier
    s_cmp_lg_u32 s74, 0
    s_mov_b32 s74, 0
    s_cbranch_scc1 G1_real_136
    s_mov_b32 s5, 0
    s_sub_u32 s6, s100, 144
    s_and_b32 s7, s6, 3
    s_lshl_b32 s7, s7, 7
    s_lshr_b32 s6, s6, 2
    s_lshl_b32 s6, s6, 2
    s_add_u32 s7, s7, s6
    s_add_u32 s7, s7, 12288
    s_mov_b32 s8, 1
    s_cmp_lg_u32 s4, 0
    s_cbranch_scc1 FS_141
    s_mov_b64 exec, 1
    v_mov_b32 v1, s8
    buffer_store_dword v1, off, s[52:55], s7 sc1
    s_mov_b64 exec, -1
FS_141:
W_g2_69:
    s_load_dwordx16 s[16:31], s[0:1], 0
    s_load_dwordx16 s[32:47], s[0:1], 64
    s_load_dwordx2 s[48:49], s[0:1], 128
    s_waitcnt lgkmcnt(0)
    v_and_b32 v1, 63, v0
    v_and_b32 v2, 15, v1
    v_lshrrev_b32 v3, 4, v1
    v_lshrrev_b32 v4, 2, v2
    v_and_b32 v5, 3, v2
    v_lshrrev_b32 v6, 1, v3
    v_and_b32 v7, 1, v3
    v_lshlrev_b32 v8, 4, v1
    s_mov_b32 s64, s44
    s_and_b32 s65, s45, 0xffff
    s_mov_b32 s66, 0x200000
    s_mov_b32 s67, 0x00020000
    s_mov_b32 s68, s38
    s_and_b32 s69, s39, 0xffff
    s_mov_b32 s70, 0x1000
    s_mov_b32 s71, 0x00020000
    v_lshl_add_u32 v10, v6, 2, v4
    v_lshlrev_b32 v10, 8, v10
    v_lshl_add_u32 v10, v7, 5, v10
    v_lshl_add_u32 v10, v5, 3, v10
    v_xor_b32 v11, s4, v4
    v_lshl_add_u32 v10, v11, 6, v10
    v_add_u32 v10, 65536, v10
    v_add_u32 v11, 0xc000, v10
    s_lshr_b32 s6, s101, 3
    s_and_b32 s5, s101, 7
    s_lshr_b32 s7, s4, 1
    s_lshl_b32 s8, s5, 1
    s_add_u32 s8, s8, s7
    s_mul_i32 s94, s8, 114688
    s_and_b32 s8, s4, 1
    s_lshl_b32 s8, s8, 11
    s_add_u32 s94, s94, s8
    s_add_u32 s94, s94, 7340032
    s_lshl_b32 s95, s4, 11
    v_mov_b64 v[64:65], 0
    v_mov_b64 v[66:67], 0
    v_mov_b64 v[68:69], 0
    v_mov_b64 v[70:71], 0
    v_mov_b64 v[72:73], 0
    v_mov_b64 v[74:75], 0
    v_mov_b64 v[76:77], 0
    v_mov_b64 v[78:79], 0
    v_mov_b64 v[80:81], 0
    v_mov_b64 v[82:83], 0
    v_mov_b64 v[84:85], 0
    v_mov_b64 v[86:87], 0
    v_mov_b64 v[88:89], 0
    v_mov_b64 v[90:91], 0
    v_mov_b64 v[92:93], 0
    v_mov_b64 v[94:95], 0
    v_lshlrev_b32 v13, 2, v1
    v_and_b32 v13, 127, v13
    v_min_u32 v14, 52, v13
    s_mov_b32 s8, 32384
    s_mov_b32 s9, 1
    s_lshr_b32 s10, s5, 1
    s_lshl_b32 s10, s10, 7
    s_add_u32 s10, s10, 12288
    s_cmp_eq_u32 s75, 1
    s_cselect_b64 s[98:99], 0, -1
    s_cselect_b32 s97, 0x40000000, 0
    s_cbranch_scc1 G2w_142
    s_cmp_lg_u32 s4, 0
    s_cbranch_scc1 G2w_142
FW_143:
    buffer_load_dword v12, v13, s[52:55], s8 offen sc1
    s_add_u32 s79, s79, 1
    s_cmp_gt_u32 s79, 2097152
    s_cbranch_scc1 mega_kernel_exit
    s_waitcnt vmcnt(0)
    v_cmp_gt_u32 vcc, s9, v12
    s_nop 0
    s_cbranch_vccz FWok_144
    s_sleep 40
    s_branch FW_143
FWok_144:
FW_145:
    buffer_load_dword v12, v14, s[52:55], s10 offen sc1
    s_add_u32 s79, s79, 1
    s_cmp_gt_u32 s79, 2097152
    s_cbranch_scc1 mega_kernel_exit
    s_waitcnt vmcnt(0)
    v_cmp_gt_u32 vcc, s9, v12
    s_nop 0
    s_cbranch_vccz FWok_146
    s_sleep 1
    s_branch FW_145
FWok_146:
G2w_142:
    s_barrier
    s_mov_b32 s93, 2
    s_mul_i32 s8, s5, 229376
    s_mul_i32 s9, s6, 14336
    s_add_u32 s8, s8, s9
    s_mul_i32 s9, s4, 3584
    s_add_u32 s8, s8, s9
    s_add_u32 s8, s8, 7340032
    v_lshlrev_b32 v12, 2, v8
    buffer_load_dword v13, v12, s[52:55], s8 offen sc1
    s_add_u32 s8, s95, 0
    s_mov_b32 m0, s8
    s_add_u32 s9, s94, 0
    buffer_load_dwordx4 v8, s[52:55], s9 offen sc1 lds
    buffer_load_dwordx4 v8, s[52:55], s9 offen offset:1024 sc1 lds
    s_add_u32 s8, s95, 8192
    s_mov_b32 m0, s8
    s_add_u32 s9, s94, 4096
    buffer_load_dwordx4 v8, s[52:55], s9 offen sc1 lds
    buffer_load_dwordx4 v8, s[52:55], s9 offen offset:1024 sc1 lds
    s_add_u32 s8, s95, 16384
    s_mov_b32 m0, s8
    s_add_u32 s9, s94, 8192
    buffer_load_dwordx4 v8, s[52:55], s9 offen sc1 lds
    buffer_load_dwordx4 v8, s[52:55], s9 offen offset:1024 sc1 lds
    s_add_u32 s8, s95, 24576
    s_mov_b32 m0, s8
    s_add_u32 s9, s94, 12288
    buffer_load_dwordx4 v8, s[52:55], s9 offen sc1 lds
    buffer_load_dwordx4 v8, s[52:55], s9 offen offset:1024 sc1 lds
    s_add_u32 s8, s95, 32768
    s_mov_b32 m0, s8
    s_add_u32 s9, s94, 16384
    buffer_load_dwordx4 v8, s[52:55], s9 offen sc1 lds
    buffer_load_dwordx4 v8, s[52:55], s9 offen offset:1024 sc1 lds
    s_add_u32 s8, s95, 40960
    s_mov_b32 m0, s8
    s_add_u32 s9, s94, 20480
    buffer_load_dwordx4 v8, s[52:55], s9 offen sc1 lds
    buffer_load_dwordx4 v8, s[52:55], s9 offen offset:1024 sc1 lds
    v_and_b32 v20, 31, v1
    s_lshl_b32 s8, s6, 7
    s_lshl_b32 s9, s4, 5
    s_add_u32 s8, s8, s9
    v_add_u32 v20, s8, v20
    v_lshlrev_b32 v19, 1, v20
    v_lshlrev_b32 v21, 10, v20
    v_lshl_add_u32 v21, v6, 6, v21
    s_lshl_b32 s96, s5, 7
    s_add_u32 s10, s96, 3145728
    s_add_u32 s96, s96, s97
    v_lshlrev_b32 v23, 4, v6
    s_lshl_b32 s11, s5, 8
    s_add_u32 s11, s11, 206848
    buffer_load_dword v13, v21, s[52:55], s10 offen sc1
    s_waitcnt vmcnt(11)
    s_barrier
    s_mov_b32 s93, 4
    ds_read_b128 v[24:27], v8 offset:0
    ds_read_b128 v[28:31], v8 offset:4096
    ds_read_b128 v[32:35], v8 offset:1024
    ds_read_b128 v[36:39], v8 offset:5120
    ds_read_b128 v[40:43], v8 offset:2048
    ds_read_b128 v[44:47], v8 offset:6144
    ds_read_b128 v[48:51], v8 offset:3072
    ds_read_b128 v[52:55], v8 offset:7168
    s_waitcnt lgkmcnt(0)
    v_mfma_f32_32x32x16_bf16 v[64:79], v[24:27], v[128:131], v[64:79]
    s_waitcnt vmcnt(7)
    s_barrier
    ds_read_b128 v[96:99], v8 offset:8192
    ds_read_b128 v[100:103], v8 offset:12288
    v_mfma_f32_32x32x16_bf16 v[80:95], v[28:31], v[128:131], v[80:95]
    ds_read_b128 v[104:107], v8 offset:9216
    ds_read_b128 v[108:111], v8 offset:13312
    v_mfma_f32_32x32x16_bf16 v[64:79], v[32:35], v[132:135], v[64:79]
    ds_read_b128 v[112:115], v8 offset:10240
    ds_read_b128 v[116:119], v8 offset:14336
    v_mfma_f32_32x32x16_bf16 v[80:95], v[36:39], v[132:135], v[80:95]
    ds_read_b128 v[120:123], v8 offset:11264
    ds_read_b128 v[124:127], v8 offset:15360
    v_mfma_f32_32x32x16_bf16 v[64:79], v[40:43], v[136:139], v[64:79]
    v_mfma_f32_32x32x16_bf16 v[80:95], v[44:47], v[136:139], v[80:95]
    v_mfma_f32_32x32x16_bf16 v[64:79], v[48:51], v[140:143], v[64:79]
    s_add_u32 s8, s95, 49152
    s_mov_b32 m0, s8
    s_add_u32 s9, s94, 24576
    buffer_load_dwordx4 v8, s[52:55], s9 offen sc1 lds
    buffer_load_dwordx4 v8, s[52:55], s9 offen offset:1024 sc1 lds
    v_mfma_f32_32x32x16_bf16 v[80:95], v[52:55], v[140:143], v[80:95]
    s_waitcnt lgkmcnt(0)
    v_mfma_f32_32x32x16_bf16 v[64:79], v[96:99], v[144:147], v[64:79]
    ds_read_b128 v[24:27], v8 offset:16384
    ds_read_b128 v[28:31], v8 offset:20480
    v_mfma_f32_32x32x16_bf16 v[80:95], v[100:103], v[144:147], v[80:95]
    ds_read_b128 v[32:35], v8 offset:17408
    ds_read_b128 v[36:39], v8 offset:21504
    v_mfma_f32_32x32x16_bf16 v[64:79], v[104:107], v[148:151], v[64:79]
    ds_read_b128 v[40:43], v8 offset:18432
    ds_read_b128 v[44:47], v8 offset:22528
    v_mfma_f32_32x32x16_bf16 v[80:95], v[108:111], v[148:151], v[80:95]
    ds_read_b128 v[48:51], v8 offset:19456
    ds_read_b128 v[52:55], v8 offset:23552
    v_mfma_f32_32x32x16_bf16 v[64:79], v[112:115], v[152:155], v[64:79]
    v_mfma_f32_32x32x16_bf16 v[80:95], v[116:119], v[152:155], v[80:95]
    v_mfma_f32_32x32x16_bf16 v[64:79], v[120:123], v[156:159], v[64:79]
    s_add_u32 s8, s95, 57344
    s_mov_b32 m0, s8
    s_add_u32 s9, s94, 28672
    buffer_load_dwordx4 v8, s[52:55], s9 offen sc1 lds
    buffer_load_dwordx4 v8, s[52:55], s9 offen offset:1024 sc1 lds
    v_mfma_f32_32x32x16_bf16 v[80:95], v[124:127], v[156:159], v[80:95]
    s_waitcnt lgkmcnt(0)
    v_mfma_f32_32x32x16_bf16 v[64:79], v[24:27], v[160:163], v[64:79]
    s_waitcnt vmcnt(7)
    s_barrier
    ds_read_b128 v[96:99], v8 offset:24576
    ds_read_b128 v[100:103], v8 offset:28672
    v_mfma_f32_32x32x16_bf16 v[80:95], v[28:31], v[160:163], v[80:95]
    ds_read_b128 v[104:107], v8 offset:25600
    ds_read_b128 v[108:111], v8 offset:29696
    v_mfma_f32_32x32x16_bf16 v[64:79], v[32:35], v[164:167], v[64:79]
    ds_read_b128 v[112:115], v8 offset:26624
    ds_read_b128 v[116:119], v8 offset:30720
    v_mfma_f32_32x32x16_bf16 v[80:95], v[36:39], v[164:167], v[80:95]
    ds_read_b128 v[120:123], v8 offset:27648
    ds_read_b128 v[124:127], v8 offset:31744
    v_mfma_f32_32x32x16_bf16 v[64:79], v[40:43], v[168:171], v[64:79]
    v_mfma_f32_32x32x16_bf16 v[80:95], v[44:47], v[168:171], v[80:95]
    v_mfma_f32_32x32x16_bf16 v[64:79], v[48:51], v[172:175], v[64:79]
    s_add_u32 s8, s95, 0
    s_mov_b32 m0, s8
    s_add_u32 s9, s94, 32768
    buffer_load_dwordx4 v8, s[52:55], s9 offen sc1 lds
    buffer_load_dwordx4 v8, s[52:55], s9 offen offset:1024 sc1 lds
    v_mfma_f32_32x32x16_bf16 v[80:95], v[52:55], v[172:175], v[80:95]
    s_waitcnt lgkmcnt(0)
    v_mfma_f32_32x32x16_bf16 v[64:79], v[96:99], v[176:179], v[64:79]
    ds_read_b128 v[24:27], v8 offset:32768
    ds_read_b128 v[28:31], v8 offset:36864
    v_mfma_f32_32x32x16_bf16 v[80:95], v[100:103], v[176:179], v[80:95]
    ds_read_b128 v[32:35], v8 offset:33792
    ds_read_b128 v[36:39], v8 offset:37888
    v_mfma_f32_32x32x16_bf16 v[64:79], v[104:107], v[180:183], v[64:79]
    ds_read_b128 v[40:43], v8 offset:34816
    ds_read_b128 v[44:47], v8 offset:38912
    v_mfma_f32_32x32x16_bf16 v[80:95], v[108:111], v[180:183], v[80:95]
    ds_read_b128 v[48:51], v8 offset:35840
    ds_read_b128 v[52:55], v8 offset:39936
    v_mfma_f32_32x32x16_bf16 v[64:79], v[112:115], v[184:187], v[64:79]
    ds_read_b64_tr_b16 v[236:237], v10 offset:0
    ds_read_b64_tr_b16 v[238:239], v10 offset:2048
    v_mfma_f32_32x32x16_bf16 v[80:95], v[116:119], v[184:187], v[80:95]
    v_mfma_f32_32x32x16_bf16 v[64:79], v[120:123], v[188:191], v[64:79]
    s_add_u32 s8, s95, 8192
    s_mov_b32 m0, s8
    s_add_u32 s9, s94, 36864
    buffer_load_dwordx4 v8, s[52:55], s9 offen sc1 lds
    buffer_load_dwordx4 v8, s[52:55], s9 offen offset:1024 sc1 lds
    v_mfma_f32_32x32x16_bf16 v[80:95], v[124:127], v[188:191], v[80:95]
    s_waitcnt lgkmcnt(0)
    v_mfma_f32_32x32x16_bf16 v[64:79], v[24:27], v[192:195], v[64:79]
    s_waitcnt vmcnt(6)
    s_barrier
    ds_read_b128 v[96:99], v8 offset:40960
    ds_read_b128 v[100:103], v8 offset:45056
    v_mfma_f32_32x32x16_bf16 v[80:95], v[28:31], v[192:195], v[80:95]
    ds_read_b128 v[104:107], v8 offset:41984
    ds_read_b128 v[108:111], v8 offset:46080
    v_mfma_f32_32x32x16_bf16 v[64:79], v[32:35], v[196:199], v[64:79]
    ds_read_b128 v[112:115], v8 offset:43008
    ds_read_b128 v[116:119], v8 offset:47104
    v_mfma_f32_32x32x16_bf16 v[80:95], v[36:39], v[196:199], v[80:95]
    ds_read_b128 v[120:123], v8 offset:44032
    ds_read_b128 v[124:127], v8 offset:48128
    v_mfma_f32_32x32x16_bf16 v[64:79], v[40:43], v[200:203], v[64:79]
    ds_read_b64_tr_b16 v[252:253], v10 offset:4096
    ds_read_b64_tr_b16 v[254:255], v10 offset:6144
    v_mfma_f32_32x32x16_bf16 v[80:95], v[44:47], v[200:203], v[80:95]
    v_mfma_f32_32x32x16_bf16 v[64:79], v[48:51], v[236:239], v[64:79]
    s_add_u32 s8, s95, 16384
    s_mov_b32 m0, s8
    s_add_u32 s9, s94, 40960
    buffer_load_dwordx4 v8, s[52:55], s9 offen sc1 lds
    buffer_load_dwordx4 v8, s[52:55], s9 offen offset:1024 sc1 lds
    v_mfma_f32_32x32x16_bf16 v[80:95], v[52:55], v[236:239], v[80:95]
    s_waitcnt lgkmcnt(0)
    v_mfma_f32_32x32x16_bf16 v[64:79], v[96:99], v[204:207], v[64:79]
    ds_read_b128 v[24:27], v8 offset:49152
    ds_read_b128 v[28:31], v8 offset:53248
    v_mfma_f32_32x32x16_bf16 v[80:95], v[100:103], v[204:207], v[80:95]
    ds_read_b128 v[32:35], v8 offset:50176
    ds_read_b128 v[36:39], v8 offset:54272
    v_mfma_f32_32x32x16_bf16 v[64:79], v[104:107], v[208:211], v[64:79]
    ds_read_b128 v[40:43], v8 offset:51200
    ds_read_b128 v[44:47], v8 offset:55296
    v_mfma_f32_32x32x16_bf16 v[80:95], v[108:111], v[208:211], v[80:95]
    ds_read_b128 v[48:51], v8 offset:52224
    ds_read_b128 v[52:55], v8 offset:56320
    v_mfma_f32_32x32x16_bf16 v[64:79], v[112:115], v[212:215], v[64:79]
    ds_read_b64_tr_b16 v[236:237], v10 offset:8192
    ds_read_b64_tr_b16 v[238:239], v10 offset:10240
    v_mfma_f32_32x32x16_bf16 v[80:95], v[116:119], v[212:215], v[80:95]
    v_mfma_f32_32x32x16_bf16 v[64:79], v[120:123], v[252:255], v[64:79]
    s_add_u32 s8, s95, 24576
    s_mov_b32 m0, s8
    s_add_u32 s9, s94, 45056
    buffer_load_dwordx4 v8, s[52:55], s9 offen sc1 lds
    buffer_load_dwordx4 v8, s[52:55], s9 offen offset:1024 sc1 lds
    v_mfma_f32_32x32x16_bf16 v[80:95], v[124:127], v[252:255], v[80:95]
    s_waitcnt lgkmcnt(0)
    v_mfma_f32_32x32x16_bf16 v[64:79], v[24:27], v[216:219], v[64:79]
    s_waitcnt vmcnt(6)
    s_barrier
    ds_read_b128 v[96:99], v8 offset:57344
    ds_read_b128 v[100:103], v8 offset:61440
    v_mfma_f32_32x32x16_bf16 v[80:95], v[28:31], v[216:219], v[80:95]
    ds_read_b128 v[104:107], v8 offset:58368
    ds_read_b128 v[108:111], v8 offset:62464
    v_mfma_f32_32x32x16_bf16 v[64:79], v[32:35], v[220:223], v[64:79]
    ds_read_b128 v[112:115], v8 offset:59392
    ds_read_b128 v[116:119], v8 offset:63488
    v_mfma_f32_32x32x16_bf16 v[80:95], v[36:39], v[220:223], v[80:95]
    ds_read_b128 v[120:123], v8 offset:60416
    ds_read_b128 v[124:127], v8 offset:64512
    v_mfma_f32_32x32x16_bf16 v[64:79], v[40:43], a[0:3], v[64:79]
    ds_read_b64_tr_b16 v[252:253], v10 offset:12288
    ds_read_b64_tr_b16 v[254:255], v10 offset:14336
    v_mfma_f32_32x32x16_bf16 v[80:95], v[44:47], a[0:3], v[80:95]
    v_mfma_f32_32x32x16_bf16 v[64:79], v[48:51], v[236:239], v[64:79]
    s_add_u32 s8, s95, 32768
    s_mov_b32 m0, s8
    s_add_u32 s9, s94, 49152
    buffer_load_dwordx4 v8, s[52:55], s9 offen sc1 lds
    buffer_load_dwordx4 v8, s[52:55], s9 offen offset:1024 sc1 lds
    v_mfma_f32_32x32x16_bf16 v[80:95], v[52:55], v[236:239], v[80:95]
    s_waitcnt lgkmcnt(0)
    v_mfma_f32_32x32x16_bf16 v[64:79], v[96:99], a[4:7], v[64:79]
    ds_read_b128 v[24:27], v8 offset:0
    ds_read_b128 v[28:31], v8 offset:4096
    v_mfma_f32_32x32x16_bf16 v[80:95], v[100:103], a[4:7], v[80:95]
    ds_read_b128 v[32:35], v8 offset:1024
    ds_read_b128 v[36:39], v8 offset:5120
    v_mfma_f32_32x32x16_bf16 v[64:79], v[104:107], a[8:11], v[64:79]
    ds_read_b128 v[40:43], v8 offset:2048
    ds_read_b128 v[44:47], v8 offset:6144
    v_mfma_f32_32x32x16_bf16 v[80:95], v[108:111], a[8:11], v[80:95]
    ds_read_b128 v[48:51], v8 offset:3072
    ds_read_b128 v[52:55], v8 offset:7168
    v_mfma_f32_32x32x16_bf16 v[64:79], v[112:115], a[12:15], v[64:79]
    ds_read_b64_tr_b16 v[236:237], v10 offset:16384
    ds_read_b64_tr_b16 v[238:239], v10 offset:18432
    v_mfma_f32_32x32x16_bf16 v[80:95], v[116:119], a[12:15], v[80:95]
    v_mfma_f32_32x32x16_bf16 v[64:79], v[120:123], v[252:255], v[64:79]
    s_add_u32 s8, s95, 40960
    s_mov_b32 m0, s8
    s_add_u32 s9, s94, 53248
    buffer_load_dwordx4 v8, s[52:55], s9 offen sc1 lds
    buffer_load_dwordx4 v8, s[52:55], s9 offen offset:1024 sc1 lds
    v_mfma_f32_32x32x16_bf16 v[80:95], v[124:127], v[252:255], v[80:95]
    s_waitcnt lgkmcnt(0)
    v_mfma_f32_32x32x16_bf16 v[64:79], v[24:27], a[16:19], v[64:79]
    s_waitcnt vmcnt(6)
    s_barrier
    ds_read_b128 v[96:99], v8 offset:8192
    ds_read_b128 v[100:103], v8 offset:12288
    v_mfma_f32_32x32x16_bf16 v[80:95], v[28:31], a[16:19], v[80:95]
    ds_read_b128 v[104:107], v8 offset:9216
    ds_read_b128 v[108:111], v8 offset:13312
    v_mfma_f32_32x32x16_bf16 v[64:79], v[32:35], a[20:23], v[64:79]
    ds_read_b128 v[112:115], v8 offset:10240
    ds_read_b128 v[116:119], v8 offset:14336
    v_mfma_f32_32x32x16_bf16 v[80:95], v[36:39], a[20:23], v[80:95]
    ds_read_b128 v[120:123], v8 offset:11264
    ds_read_b128 v[124:127], v8 offset:15360
    v_mfma_f32_32x32x16_bf16 v[64:79], v[40:43], a[24:27], v[64:79]
    ds_read_b64_tr_b16 v[252:253], v10 offset:20480
    ds_read_b64_tr_b16 v[254:255], v10 offset:22528
    v_mfma_f32_32x32x16_bf16 v[80:95], v[44:47], a[24:27], v[80:95]
    v_mfma_f32_32x32x16_bf16 v[64:79], v[48:51], v[236:239], v[64:79]
    s_add_u32 s8, s95, 49152
    s_mov_b32 m0, s8
    s_add_u32 s9, s94, 57344
    buffer_load_dwordx4 v8, s[52:55], s9 offen sc1 lds
    buffer_load_dwordx4 v8, s[52:55], s9 offen offset:1024 sc1 lds
    v_mfma_f32_32x32x16_bf16 v[80:95], v[52:55], v[236:239], v[80:95]
    s_waitcnt lgkmcnt(0)
    v_mfma_f32_32x32x16_bf16 v[64:79], v[96:99], a[28:31], v[64:79]
    ds_read_b128 v[24:27], v8 offset:16384
    ds_read_b128 v[28:31], v8 offset:20480
    v_mfma_f32_32x32x16_bf16 v[80:95], v[100:103], a[28:31], v[80:95]
    ds_read_b128 v[32:35], v8 offset:17408
    ds_read_b128 v[36:39], v8 offset:21504
    v_mfma_f32_32x32x16_bf16 v[64:79], v[104:107], a[32:35], v[64:79]
    ds_read_b128 v[40:43], v8 offset:18432
    ds_read_b128 v[44:47], v8 offset:22528
    v_mfma_f32_32x32x16_bf16 v[80:95], v[108:111], a[32:35], v[80:95]
    ds_read_b128 v[48:51], v8 offset:19456
    ds_read_b128 v[52:55], v8 offset:23552
    v_mfma_f32_32x32x16_bf16 v[64:79], v[112:115], a[36:39], v[64:79]
    ds_read_b64_tr_b16 v[236:237], v10 offset:24576
    ds_read_b64_tr_b16 v[238:239], v10 offset:26624
    v_mfma_f32_32x32x16_bf16 v[80:95], v[116:119], a[36:39], v[80:95]
    v_mfma_f32_32x32x16_bf16 v[64:79], v[120:123], v[252:255], v[64:79]
    s_add_u32 s8, s95, 57344
    s_mov_b32 m0, s8
    s_add_u32 s9, s94, 61440
    buffer_load_dwordx4 v8, s[52:55], s9 offen sc1 lds
    buffer_load_dwordx4 v8, s[52:55], s9 offen offset:1024 sc1 lds
    v_mfma_f32_32x32x16_bf16 v[80:95], v[124:127], v[252:255], v[80:95]
    s_waitcnt lgkmcnt(0)
    v_mfma_f32_32x32x16_bf16 v[64:79], v[24:27], a[40:43], v[64:79]
    s_waitcnt vmcnt(6)
    s_barrier
    ds_read_b128 v[96:99], v8 offset:24576
    ds_read_b128 v[100:103], v8 offset:28672
    v_mfma_f32_32x32x16_bf16 v[80:95], v[28:31], a[40:43], v[80:95]
    ds_read_b128 v[104:107], v8 offset:25600
    ds_read_b128 v[108:111], v8 offset:29696
    v_mfma_f32_32x32x16_bf16 v[64:79], v[32:35], a[44:47], v[64:79]
    ds_read_b128 v[112:115], v8 offset:26624
    ds_read_b128 v[116:119], v8 offset:30720
    v_mfma_f32_32x32x16_bf16 v[80:95], v[36:39], a[44:47], v[80:95]
    ds_read_b128 v[120:123], v8 offset:27648
    ds_read_b128 v[124:127], v8 offset:31744
    v_mfma_f32_32x32x16_bf16 v[64:79], v[40:43], a[48:51], v[64:79]
    ds_read_b64_tr_b16 v[252:253], v10 offset:28672
    ds_read_b64_tr_b16 v[254:255], v10 offset:30720
    v_mfma_f32_32x32x16_bf16 v[80:95], v[44:47], a[48:51], v[80:95]
    v_mfma_f32_32x32x16_bf16 v[64:79], v[48:51], v[236:239], v[64:79]
    s_add_u32 s8, s95, 0
    s_mov_b32 m0, s8
    s_add_u32 s9, s94, 65536
    buffer_load_dwordx4 v8, s[52:55], s9 offen sc1 lds
    buffer_load_dwordx4 v8, s[52:55], s9 offen offset:1024 sc1 lds
    v_mfma_f32_32x32x16_bf16 v[80:95], v[52:55], v[236:239], v[80:95]
    s_waitcnt lgkmcnt(0)
    v_mfma_f32_32x32x16_bf16 v[64:79], v[96:99], a[52:55], v[64:79]
    ds_read_b128 v[24:27], v8 offset:32768
    ds_read_b128 v[28:31], v8 offset:36864
    v_mfma_f32_32x32x16_bf16 v[80:95], v[100:103], a[52:55], v[80:95]
    ds_read_b128 v[32:35], v8 offset:33792
    ds_read_b128 v[36:39], v8 offset:37888
    v_mfma_f32_32x32x16_bf16 v[64:79], v[104:107], a[56:59], v[64:79]
    ds_read_b128 v[40:43], v8 offset:34816
    ds_read_b128 v[44:47], v8 offset:38912
    v_mfma_f32_32x32x16_bf16 v[80:95], v[108:111], a[56:59], v[80:95]
    ds_read_b128 v[48:51], v8 offset:35840
    ds_read_b128 v[52:55], v8 offset:39936
    v_mfma_f32_32x32x16_bf16 v[64:79], v[112:115], a[60:63], v[64:79]
    ds_read_b64_tr_b16 v[236:237], v10 offset:32768
    ds_read_b64_tr_b16 v[238:239], v10 offset:34816
    v_mfma_f32_32x32x16_bf16 v[80:95], v[116:119], a[60:63], v[80:95]
    v_mfma_f32_32x32x16_bf16 v[64:79], v[120:123], v[252:255], v[64:79]
    s_add_u32 s8, s95, 8192
    s_mov_b32 m0, s8
    s_add_u32 s9, s94, 69632
    buffer_load_dwordx4 v8, s[52:55], s9 offen sc1 lds
    buffer_load_dwordx4 v8, s[52:55], s9 offen offset:1024 sc1 lds
    v_mfma_f32_32x32x16_bf16 v[80:95], v[124:127], v[252:255], v[80:95]
    s_waitcnt lgkmcnt(0)
    v_mfma_f32_32x32x16_bf16 v[64:79], v[24:27], a[64:67], v[64:79]
    s_waitcnt vmcnt(6)
    s_barrier
    ds_read_b128 v[96:99], v8 offset:40960
    ds_read_b128 v[100:103], v8 offset:45056
    v_mfma_f32_32x32x16_bf16 v[80:95], v[28:31], a[64:67], v[80:95]
    ds_read_b128 v[104:107], v8 offset:41984
    ds_read_b128 v[108:111], v8 offset:46080
    v_mfma_f32_32x32x16_bf16 v[64:79], v[32:35], a[68:71], v[64:79]
    ds_read_b128 v[112:115], v8 offset:43008
    ds_read_b128 v[116:119], v8 offset:47104
    v_mfma_f32_32x32x16_bf16 v[80:95], v[36:39], a[68:71], v[80:95]
    ds_read_b128 v[120:123], v8 offset:44032
    ds_read_b128 v[124:127], v8 offset:48128
    v_mfma_f32_32x32x16_bf16 v[64:79], v[40:43], a[72:75], v[64:79]
    ds_read_b64_tr_b16 v[252:253], v10 offset:36864
    ds_read_b64_tr_b16 v[254:255], v10 offset:38912
    v_mfma_f32_32x32x16_bf16 v[80:95], v[44:47], a[72:75], v[80:95]
    v_mfma_f32_32x32x16_bf16 v[64:79], v[48:51], v[236:239], v[64:79]
    s_add_u32 s8, s95, 16384
    s_mov_b32 m0, s8
    s_add_u32 s9, s94, 73728
    buffer_load_dwordx4 v8, s[52:55], s9 offen sc1 lds
    buffer_load_dwordx4 v8, s[52:55], s9 offen offset:1024 sc1 lds
    v_mfma_f32_32x32x16_bf16 v[80:95], v[52:55], v[236:239], v[80:95]
    s_waitcnt lgkmcnt(0)
    v_mfma_f32_32x32x16_bf16 v[64:79], v[96:99], a[76:79], v[64:79]
    ds_read_b128 v[24:27], v8 offset:49152
    ds_read_b128 v[28:31], v8 offset:53248
    v_mfma_f32_32x32x16_bf16 v[80:95], v[100:103], a[76:79], v[80:95]
    ds_read_b128 v[32:35], v8 offset:50176
    ds_read_b128 v[36:39], v8 offset:54272
    v_mfma_f32_32x32x16_bf16 v[64:79], v[104:107], a[80:83], v[64:79]
    ds_read_b128 v[40:43], v8 offset:51200
    ds_read_b128 v[44:47], v8 offset:55296
    v_mfma_f32_32x32x16_bf16 v[80:95], v[108:111], a[80:83], v[80:95]
    ds_read_b128 v[48:51], v8 offset:52224
    ds_read_b128 v[52:55], v8 offset:56320
    v_mfma_f32_32x32x16_bf16 v[64:79], v[112:115], a[84:87], v[64:79]
    ds_read_b64_tr_b16 v[236:237], v10 offset:40960
    ds_read_b64_tr_b16 v[238:239], v10 offset:43008
    v_mfma_f32_32x32x16_bf16 v[80:95], v[116:119], a[84:87], v[80:95]
    v_mfma_f32_32x32x16_bf16 v[64:79], v[120:123], v[252:255], v[64:79]
    s_add_u32 s8, s95, 24576
    s_mov_b32 m0, s8
    s_add_u32 s9, s94, 77824
    buffer_load_dwordx4 v8, s[52:55], s9 offen sc1 lds
    buffer_load_dwordx4 v8, s[52:55], s9 offen offset:1024 sc1 lds
    v_mfma_f32_32x32x16_bf16 v[80:95], v[124:127], v[252:255], v[80:95]
    s_waitcnt lgkmcnt(0)
    v_mfma_f32_32x32x16_bf16 v[64:79], v[24:27], a[88:91], v[64:79]
    s_waitcnt vmcnt(6)
    s_barrier
    ds_read_b128 v[96:99], v8 offset:57344
    ds_read_b128 v[100:103], v8 offset:61440
    v_mfma_f32_32x32x16_bf16 v[80:95], v[28:31], a[88:91], v[80:95]
    ds_read_b128 v[104:107], v8 offset:58368
    ds_read_b128 v[108:111], v8 offset:62464
    v_mfma_f32_32x32x16_bf16 v[64:79], v[32:35], a[92:95], v[64:79]
    ds_read_b128 v[112:115], v8 offset:59392
    ds_read_b128 v[116:119], v8 offset:63488
    v_mfma_f32_32x32x16_bf16 v[80:95], v[36:39], a[92:95], v[80:95]
    ds_read_b128 v[120:123], v8 offset:60416
    ds_read_b128 v[124:127], v8 offset:64512
    v_mfma_f32_32x32x16_bf16 v[64:79], v[40:43], a[96:99], v[64:79]
    ds_read_b64_tr_b16 v[252:253], v10 offset:45056
    ds_read_b64_tr_b16 v[254:255], v10 offset:47104
    v_mfma_f32_32x32x16_bf16 v[80:95], v[44:47], a[96:99], v[80:95]
    v_mfma_f32_32x32x16_bf16 v[64:79], v[48:51], v[236:239], v[64:79]
    s_add_u32 s8, s95, 32768
    s_mov_b32 m0, s8
    s_add_u32 s9, s94, 81920
    buffer_load_dwordx4 v8, s[52:55], s9 offen sc1 lds
    buffer_load_dwordx4 v8, s[52:55], s9 offen offset:1024 sc1 lds
    v_mfma_f32_32x32x16_bf16 v[80:95], v[52:55], v[236:239], v[80:95]
    s_waitcnt lgkmcnt(0)
    v_mfma_f32_32x32x16_bf16 v[64:79], v[96:99], a[100:103], v[64:79]
    ds_read_b128 v[24:27], v8 offset:0
    ds_read_b128 v[28:31], v8 offset:4096
    v_mfma_f32_32x32x16_bf16 v[80:95], v[100:103], a[100:103], v[80:95]
    ds_read_b128 v[32:35], v8 offset:1024
    ds_read_b128 v[36:39], v8 offset:5120
    v_mfma_f32_32x32x16_bf16 v[64:79], v[104:107], a[104:107], v[64:79]
    ds_read_b128 v[40:43], v8 offset:2048
    ds_read_b128 v[44:47], v8 offset:6144
    v_mfma_f32_32x32x16_bf16 v[80:95], v[108:111], a[104:107], v[80:95]
    ds_read_b128 v[48:51], v8 offset:3072
    ds_read_b128 v[52:55], v8 offset:7168
    v_mfma_f32_32x32x16_bf16 v[64:79], v[112:115], a[108:111], v[64:79]
    ds_read_b64_tr_b16 v[236:237], v11 offset:0
    ds_read_b64_tr_b16 v[238:239], v11 offset:2048
    v_mfma_f32_32x32x16_bf16 v[80:95], v[116:119], a[108:111], v[80:95]
    v_mfma_f32_32x32x16_bf16 v[64:79], v[120:123], v[252:255], v[64:79]
    s_add_u32 s8, s95, 40960
    s_mov_b32 m0, s8
    s_add_u32 s9, s94, 86016
    buffer_load_dwordx4 v8, s[52:55], s9 offen sc1 lds
    buffer_load_dwordx4 v8, s[52:55], s9 offen offset:1024 sc1 lds
    v_mfma_f32_32x32x16_bf16 v[80:95], v[124:127], v[252:255], v[80:95]
    s_waitcnt lgkmcnt(0)
    v_mfma_f32_32x32x16_bf16 v[64:79], v[24:27], a[112:115], v[64:79]
    s_waitcnt vmcnt(6)
    s_barrier
    ds_read_b128 v[96:99], v8 offset:8192
    ds_read_b128 v[100:103], v8 offset:12288
    v_mfma_f32_32x32x16_bf16 v[80:95], v[28:31], a[112:115], v[80:95]
    ds_read_b128 v[104:107], v8 offset:9216
    ds_read_b128 v[108:111], v8 offset:13312
    v_mfma_f32_32x32x16_bf16 v[64:79], v[32:35], a[116:119], v[64:79]
    ds_read_b128 v[112:115], v8 offset:10240
    ds_read_b128 v[116:119], v8 offset:14336
    v_mfma_f32_32x32x16_bf16 v[80:95], v[36:39], a[116:119], v[80:95]
    ds_read_b128 v[120:123], v8 offset:11264
    ds_read_b128 v[124:127], v8 offset:15360
    v_mfma_f32_32x32x16_bf16 v[64:79], v[40:43], a[120:123], v[64:79]
    ds_read_b64_tr_b16 v[252:253], v11 offset:4096
    ds_read_b64_tr_b16 v[254:255], v11 offset:6144
    v_mfma_f32_32x32x16_bf16 v[80:95], v[44:47], a[120:123], v[80:95]
    v_mfma_f32_32x32x16_bf16 v[64:79], v[48:51], v[236:239], v[64:79]
    s_add_u32 s8, s95, 49152
    s_mov_b32 m0, s8
    s_add_u32 s9, s94, 90112
    buffer_load_dwordx4 v8, s[52:55], s9 offen sc1 lds
    buffer_load_dwordx4 v8, s[52:55], s9 offen offset:1024 sc1 lds
    v_mfma_f32_32x32x16_bf16 v[80:95], v[52:55], v[236:239], v[80:95]
    s_waitcnt lgkmcnt(0)
    v_mfma_f32_32x32x16_bf16 v[64:79], v[96:99], a[124:127], v[64:79]
    ds_read_b128 v[24:27], v8 offset:16384
    ds_read_b128 v[28:31], v8 offset:20480
    v_mfma_f32_32x32x16_bf16 v[80:95], v[100:103], a[124:127], v[80:95]
    ds_read_b128 v[32:35], v8 offset:17408
    ds_read_b128 v[36:39], v8 offset:21504
    v_mfma_f32_32x32x16_bf16 v[64:79], v[104:107], a[128:131], v[64:79]
    ds_read_b128 v[40:43], v8 offset:18432
    ds_read_b128 v[44:47], v8 offset:22528
    v_mfma_f32_32x32x16_bf16 v[80:95], v[108:111], a[128:131], v[80:95]
    ds_read_b128 v[48:51], v8 offset:19456
    ds_read_b128 v[52:55], v8 offset:23552
    v_mfma_f32_32x32x16_bf16 v[64:79], v[112:115], a[132:135], v[64:79]
    ds_read_b64_tr_b16 v[236:237], v11 offset:8192
    ds_read_b64_tr_b16 v[238:239], v11 offset:10240
    v_mfma_f32_32x32x16_bf16 v[80:95], v[116:119], a[132:135], v[80:95]
    v_mfma_f32_32x32x16_bf16 v[64:79], v[120:123], v[252:255], v[64:79]
    s_add_u32 s8, s95, 57344
    s_mov_b32 m0, s8
    s_add_u32 s9, s94, 94208
    buffer_load_dwordx4 v8, s[52:55], s9 offen sc1 lds
    buffer_load_dwordx4 v8, s[52:55], s9 offen offset:1024 sc1 lds
    v_mfma_f32_32x32x16_bf16 v[80:95], v[124:127], v[252:255], v[80:95]
    s_waitcnt lgkmcnt(0)
    v_mfma_f32_32x32x16_bf16 v[64:79], v[24:27], a[136:139], v[64:79]
    s_waitcnt vmcnt(6)
    s_barrier
    ds_read_b128 v[96:99], v8 offset:24576
    ds_read_b128 v[100:103], v8 offset:28672
    v_mfma_f32_32x32x16_bf16 v[80:95], v[28:31], a[136:139], v[80:95]
    ds_read_b128 v[104:107], v8 offset:25600
    ds_read_b128 v[108:111], v8 offset:29696
    v_mfma_f32_32x32x16_bf16 v[64:79], v[32:35], a[140:143], v[64:79]
    ds_read_b128 v[112:115], v8 offset:26624
    ds_read_b128 v[116:119], v8 offset:30720
    v_mfma_f32_32x32x16_bf16 v[80:95], v[36:39], a[140:143], v[80:95]
    ds_read_b128 v[120:123], v8 offset:27648
    ds_read_b128 v[124:127], v8 offset:31744
    v_mfma_f32_32x32x16_bf16 v[64:79], v[40:43], a[144:147], v[64:79]
    ds_read_b64_tr_b16 v[252:253], v11 offset:12288
    ds_read_b64_tr_b16 v[254:255], v11 offset:14336
    v_mfma_f32_32x32x16_bf16 v[80:95], v[44:47], a[144:147], v[80:95]
    v_mfma_f32_32x32x16_bf16 v[64:79], v[48:51], v[236:239], v[64:79]
    s_add_u32 s8, s95, 0
    s_mov_b32 m0, s8
    s_add_u32 s9, s94, 98304
    buffer_load_dwordx4 v8, s[52:55], s9 offen sc1 lds
    buffer_load_dwordx4 v8, s[52:55], s9 offen offset:1024 sc1 lds
    v_mfma_f32_32x32x16_bf16 v[80:95], v[52:55], v[236:239], v[80:95]
    s_waitcnt lgkmcnt(0)
    v_mfma_f32_32x32x16_bf16 v[64:79], v[96:99], a[148:151], v[64:79]
    ds_read_b128 v[24:27], v8 offset:32768
    ds_read_b128 v[28:31], v8 offset:36864
    v_mfma_f32_32x32x16_bf16 v[80:95], v[100:103], a[148:151], v[80:95]
    ds_read_b128 v[32:35], v8 offset:33792
    ds_read_b128 v[36:39], v8 offset:37888
    v_mfma_f32_32x32x16_bf16 v[64:79], v[104:107], a[152:155], v[64:79]
    ds_read_b128 v[40:43], v8 offset:34816
    ds_read_b128 v[44:47], v8 offset:38912
    v_mfma_f32_32x32x16_bf16 v[80:95], v[108:111], a[152:155], v[80:95]
    ds_read_b128 v[48:51], v8 offset:35840
    ds_read_b128 v[52:55], v8 offset:39936
    v_mfma_f32_32x32x16_bf16 v[64:79], v[112:115], a[156:159], v[64:79]
    ds_read_b64_tr_b16 v[236:237], v11 offset:16384
    ds_read_b64_tr_b16 v[238:239], v11 offset:18432
    v_mfma_f32_32x32x16_bf16 v[80:95], v[116:119], a[156:159], v[80:95]
    v_mfma_f32_32x32x16_bf16 v[64:79], v[120:123], v[252:255], v[64:79]
    s_add_u32 s8, s95, 8192
    s_mov_b32 m0, s8
    s_add_u32 s9, s94, 102400
    buffer_load_dwordx4 v8, s[52:55], s9 offen sc1 lds
    buffer_load_dwordx4 v8, s[52:55], s9 offen offset:1024 sc1 lds
    v_mfma_f32_32x32x16_bf16 v[80:95], v[124:127], v[252:255], v[80:95]
    s_waitcnt lgkmcnt(0)
    v_mfma_f32_32x32x16_bf16 v[64:79], v[24:27], a[160:163], v[64:79]
    s_waitcnt vmcnt(6)
    s_barrier
    ds_read_b128 v[96:99], v8 offset:40960
    ds_read_b128 v[100:103], v8 offset:45056
    v_mfma_f32_32x32x16_bf16 v[80:95], v[28:31], a[160:163], v[80:95]
    ds_read_b128 v[104:107], v8 offset:41984
    ds_read_b128 v[108:111], v8 offset:46080
    v_mfma_f32_32x32x16_bf16 v[64:79], v[32:35], a[164:167], v[64:79]
    ds_read_b128 v[112:115], v8 offset:43008
    ds_read_b128 v[116:119], v8 offset:47104
    v_mfma_f32_32x32x16_bf16 v[80:95], v[36:39], a[164:167], v[80:95]
    ds_read_b128 v[120:123], v8 offset:44032
    ds_read_b128 v[124:127], v8 offset:48128
    v_mfma_f32_32x32x16_bf16 v[64:79], v[40:43], a[168:171], v[64:79]
    ds_read_b64_tr_b16 v[252:253], v11 offset:20480
    ds_read_b64_tr_b16 v[254:255], v11 offset:22528
    v_mfma_f32_32x32x16_bf16 v[80:95], v[44:47], a[168:171], v[80:95]
    v_mfma_f32_32x32x16_bf16 v[64:79], v[48:51], v[236:239], v[64:79]
    s_add_u32 s8, s95, 16384
    s_mov_b32 m0, s8
    s_add_u32 s9, s94, 106496
    buffer_load_dwordx4 v8, s[52:55], s9 offen sc1 lds
    buffer_load_dwordx4 v8, s[52:55], s9 offen offset:1024 sc1 lds
    v_mfma_f32_32x32x16_bf16 v[80:95], v[52:55], v[236:239], v[80:95]
    s_waitcnt lgkmcnt(0)
    v_mfma_f32_32x32x16_bf16 v[64:79], v[96:99], a[172:175], v[64:79]
    ds_read_b128 v[24:27], v8 offset:49152
    ds_read_b128 v[28:31], v8 offset:53248
    v_mfma_f32_32x32x16_bf16 v[80:95], v[100:103], a[172:175], v[80:95]
    ds_read_b128 v[32:35], v8 offset:50176
    ds_read_b128 v[36:39], v8 offset:54272
    v_mfma_f32_32x32x16_bf16 v[64:79], v[104:107], a[176:179], v[64:79]
    ds_read_b128 v[40:43], v8 offset:51200
    ds_read_b128 v[44:47], v8 offset:55296
    v_mfma_f32_32x32x16_bf16 v[80:95], v[108:111], a[176:179], v[80:95]
    ds_read_b128 v[48:51], v8 offset:52224
    ds_read_b128 v[52:55], v8 offset:56320
    v_mfma_f32_32x32x16_bf16 v[64:79], v[112:115], a[180:183], v[64:79]
    ds_read_b64_tr_b16 v[236:237], v11 offset:24576
    ds_read_b64_tr_b16 v[238:239], v11 offset:26624
    v_mfma_f32_32x32x16_bf16 v[80:95], v[116:119], a[180:183], v[80:95]
    v_mfma_f32_32x32x16_bf16 v[64:79], v[120:123], v[252:255], v[64:79]
    s_add_u32 s8, s95, 24576
    s_mov_b32 m0, s8
    s_add_u32 s9, s94, 110592
    buffer_load_dwordx4 v8, s[52:55], s9 offen sc1 lds
    buffer_load_dwordx4 v8, s[52:55], s9 offen offset:1024 sc1 lds
    v_mfma_f32_32x32x16_bf16 v[80:95], v[124:127], v[252:255], v[80:95]
    s_mov_b64 exec, s[98:99]
    buffer_load_ushort v22, v19, s[68:71], 0 offen
    buffer_load_dwordx4 v[128:131], v21, s[52:55], s10 offen offset:0 sc1
    buffer_load_dwordx4 v[132:135], v21, s[52:55], s10 offen offset:16 sc1
    buffer_load_dwordx4 v[136:139], v21, s[52:55], s10 offen offset:32 sc1
    buffer_load_dwordx4 v[140:143], v21, s[52:55], s10 offen offset:48 sc1
    buffer_load_dwordx4 v[144:147], v23, s[52:55], s11 offen offset:0 sc1
    buffer_load_dwordx4 v[148:151], v23, s[52:55], s11 offen offset:32 sc1
    buffer_load_dwordx4 v[152:155], v23, s[52:55], s11 offen offset:64 sc1
    buffer_load_dwordx4 v[156:159], v23, s[52:55], s11 offen offset:96 sc1
    buffer_load_dwordx4 v[160:163], v23, s[52:55], s11 offen offset:128 sc1
    buffer_load_dwordx4 v[164:167], v23, s[52:55], s11 offen offset:160 sc1
    buffer_load_dwordx4 v[168:171], v23, s[52:55], s11 offen offset:192 sc1
    buffer_load_dwordx4 v[172:175], v23, s[52:55], s11 offen offset:224 sc1
    s_mov_b64 exec, -1
    s_waitcnt lgkmcnt(0)
    v_mfma_f32_32x32x16_bf16 v[64:79], v[24:27], a[184:187], v[64:79]
    s_waitcnt vmcnt(19)
    s_barrier
    ds_read_b128 v[96:99], v8 offset:57344
    ds_read_b128 v[100:103], v8 offset:61440
    v_mfma_f32_32x32x16_bf16 v[80:95], v[28:31], a[184:187], v[80:95]
    ds_read_b128 v[104:107], v8 offset:58368
    ds_read_b128 v[108:111], v8 offset:62464
    v_mfma_f32_32x32x16_bf16 v[64:79], v[32:35], a[188:191], v[64:79]
    ds_read_b128 v[112:115], v8 offset:59392
    ds_read_b128 v[116:119], v8 offset:63488
    v_mfma_f32_32x32x16_bf16 v[80:95], v[36:39], a[188:191], v[80:95]
    ds_read_b128 v[120:123], v8 offset:60416
    ds_read_b128 v[124:127], v8 offset:64512
    v_mfma_f32_32x32x16_bf16 v[64:79], v[40:43], a[192:195], v[64:79]
    ds_read_b64_tr_b16 v[252:253], v11 offset:28672
    ds_read_b64_tr_b16 v[254:255], v11 offset:30720
    v_mfma_f32_32x32x16_bf16 v[80:95], v[44:47], a[192:195], v[80:95]
    v_mfma_f32_32x32x16_bf16 v[64:79], v[48:51], v[236:239], v[64:79]
    v_mfma_f32_32x32x16_bf16 v[80:95], v[52:55], v[236:239], v[80:95]
    s_waitcnt lgkmcnt(0)
    v_mfma_f32_32x32x16_bf16 v[64:79], v[96:99], a[196:199], v[64:79]
    ds_read_b128 v[24:27], v8 offset:0
    ds_read_b128 v[28:31], v8 offset:4096
    v_mfma_f32_32x32x16_bf16 v[80:95], v[100:103], a[196:199], v[80:95]
    ds_read_b128 v[32:35], v8 offset:1024
    ds_read_b128 v[36:39], v8 offset:5120
    v_mfma_f32_32x32x16_bf16 v[64:79], v[104:107], a[200:203], v[64:79]
    ds_read_b128 v[40:43], v8 offset:2048
    ds_read_b128 v[44:47], v8 offset:6144
    v_mfma_f32_32x32x16_bf16 v[80:95], v[108:111], a[200:203], v[80:95]
    ds_read_b128 v[48:51], v8 offset:3072
    ds_read_b128 v[52:55], v8 offset:7168
    v_mfma_f32_32x32x16_bf16 v[64:79], v[112:115], a[204:207], v[64:79]
    ds_read_b64_tr_b16 v[236:237], v11 offset:32768
    ds_read_b64_tr_b16 v[238:239], v11 offset:34816
    v_mfma_f32_32x32x16_bf16 v[80:95], v[116:119], a[204:207], v[80:95]
    v_mfma_f32_32x32x16_bf16 v[64:79], v[120:123], v[252:255], v[64:79]
    v_mfma_f32_32x32x16_bf16 v[80:95], v[124:127], v[252:255], v[80:95]
    s_waitcnt lgkmcnt(0)
    v_mfma_f32_32x32x16_bf16 v[64:79], v[24:27], a[208:211], v[64:79]
    s_waitcnt vmcnt(15)
    s_barrier
    ds_read_b128 v[96:99], v8 offset:8192
    ds_read_b128 v[100:103], v8 offset:12288
    v_mfma_f32_32x32x16_bf16 v[80:95], v[28:31], a[208:211], v[80:95]
    ds_read_b128 v[104:107], v8 offset:9216
    ds_read_b128 v[108:111], v8 offset:13312
    v_mfma_f32_32x32x16_bf16 v[64:79], v[32:35], a[212:215], v[64:79]
    ds_read_b128 v[112:115], v8 offset:10240
    ds_read_b128 v[116:119], v8 offset:14336
    v_mfma_f32_32x32x16_bf16 v[80:95], v[36:39], a[212:215], v[80:95]
    ds_read_b128 v[120:123], v8 offset:11264
    ds_read_b128 v[124:127], v8 offset:15360
    v_mfma_f32_32x32x16_bf16 v[64:79], v[40:43], a[216:219], v[64:79]
    ds_read_b64_tr_b16 v[252:253], v11 offset:36864
    ds_read_b64_tr_b16 v[254:255], v11 offset:38912
    v_mfma_f32_32x32x16_bf16 v[80:95], v[44:47], a[216:219], v[80:95]
    v_mfma_f32_32x32x16_bf16 v[64:79], v[48:51], v[236:239], v[64:79]
    v_mfma_f32_32x32x16_bf16 v[80:95], v[52:55], v[236:239], v[80:95]
    s_waitcnt lgkmcnt(0)
    v_mfma_f32_32x32x16_bf16 v[64:79], v[96:99], a[220:223], v[64:79]
    ds_read_b128 v[24:27], v8 offset:16384
    ds_read_b128 v[28:31], v8 offset:20480
    v_mfma_f32_32x32x16_bf16 v[80:95], v[100:103], a[220:223], v[80:95]
    ds_read_b128 v[32:35], v8 offset:17408
    ds_read_b128 v[36:39], v8 offset:21504
    v_mfma_f32_32x32x16_bf16 v[64:79], v[104:107], a[224:227], v[64:79]
    ds_read_b128 v[40:43], v8 offset:18432
    ds_read_b128 v[44:47], v8 offset:22528
    v_mfma_f32_32x32x16_bf16 v[80:95], v[108:111], a[224:227], v[80:95]
    ds_read_b128 v[48:51], v8 offset:19456
    ds_read_b128 v[52:55], v8 offset:23552
    v_mfma_f32_32x32x16_bf16 v[64:79], v[112:115], a[228:231], v[64:79]
    ds_read_b64_tr_b16 v[236:237], v11 offset:40960
    ds_read_b64_tr_b16 v[238:239], v11 offset:43008
    v_mfma_f32_32x32x16_bf16 v[80:95], v[116:119], a[228:231], v[80:95]
    v_mfma_f32_32x32x16_bf16 v[64:79], v[120:123], v[252:255], v[64:79]
    v_mfma_f32_32x32x16_bf16 v[80:95], v[124:127], v[252:255], v[80:95]
    s_waitcnt lgkmcnt(0)
    v_mfma_f32_32x32x16_bf16 v[64:79], v[24:27], a[232:235], v[64:79]
    s_waitcnt vmcnt(13)
    s_barrier
    ds_read_b128 v[96:99], v8 offset:24576
    ds_read_b128 v[100:103], v8 offset:28672
    v_mfma_f32_32x32x16_bf16 v[80:95], v[28:31], a[232:235], v[80:95]
    ds_read_b128 v[104:107], v8 offset:25600
    ds_read_b128 v[108:111], v8 offset:29696
    v_mfma_f32_32x32x16_bf16 v[64:79], v[32:35], a[236:239], v[64:79]
    ds_read_b128 v[112:115], v8 offset:26624
    ds_read_b128 v[116:119], v8 offset:30720
    v_mfma_f32_32x32x16_bf16 v[80:95], v[36:39], a[236:239], v[80:95]
    ds_read_b128 v[120:123], v8 offset:27648
    ds_read_b128 v[124:127], v8 offset:31744
    v_mfma_f32_32x32x16_bf16 v[64:79], v[40:43], a[240:243], v[64:79]
    ds_read_b64_tr_b16 v[252:253], v11 offset:45056
    ds_read_b64_tr_b16 v[254:255], v11 offset:47104
    v_mfma_f32_32x32x16_bf16 v[80:95], v[44:47], a[240:243], v[80:95]
    v_mfma_f32_32x32x16_bf16 v[64:79], v[48:51], v[236:239], v[64:79]
    v_mfma_f32_32x32x16_bf16 v[80:95], v[52:55], v[236:239], v[80:95]
    s_waitcnt lgkmcnt(0)
    v_mfma_f32_32x32x16_bf16 v[64:79], v[96:99], a[244:247], v[64:79]
    v_mfma_f32_32x32x16_bf16 v[80:95], v[100:103], a[244:247], v[80:95]
    v_mfma_f32_32x32x16_bf16 v[64:79], v[104:107], a[248:251], v[64:79]
    v_mfma_f32_32x32x16_bf16 v[80:95], v[108:111], a[248:251], v[80:95]
    v_mfma_f32_32x32x16_bf16 v[64:79], v[112:115], a[252:255], v[64:79]
    v_mfma_f32_32x32x16_bf16 v[80:95], v[116:119], a[252:255], v[80:95]
    v_mfma_f32_32x32x16_bf16 v[64:79], v[120:123], v[252:255], v[64:79]
    v_mfma_f32_32x32x16_bf16 v[80:95], v[124:127], v[252:255], v[80:95]
    s_mov_b32 s93, 4
    s_mov_b32 s93, 2
    s_waitcnt vmcnt(0)
    v_lshlrev_b32 v22, 16, v22
    v_mov_b32 v24, v128
    v_mov_b32 v25, v129
    v_mov_b32 v26, v130
    v_mov_b32 v27, v131
    v_mov_b32 v28, v132
    v_mov_b32 v29, v133
    v_mov_b32 v30, v134
    v_mov_b32 v31, v135
    v_mov_b32 v32, v136
    v_mov_b32 v33, v137
    v_mov_b32 v34, v138
    v_mov_b32 v35, v139
    v_mov_b32 v36, v140
    v_mov_b32 v37, v141
    v_mov_b32 v38, v142
    v_mov_b32 v39, v143
    v_permlane32_swap_b32 v24, v26
    v_permlane32_swap_b32 v25, v27
    v_permlane32_swap_b32 v28, v30
    v_permlane32_swap_b32 v29, v31
    v_permlane32_swap_b32 v32, v34
    v_permlane32_swap_b32 v33, v35
    v_permlane32_swap_b32 v36, v38
    v_permlane32_swap_b32 v37, v39
    v_lshlrev_b32 v20, 16, v24
    v_add_f32 v64, v64, v22
    v_fma_f32 v64, v64, v144, v20
    v_and_b32 v20, 0xffff0000, v24
    v_add_f32 v65, v65, v22
    v_fma_f32 v65, v65, v145, v20
    v_cvt_pk_bf16_f32 v40, v64, v65
    v_lshlrev_b32 v20, 16, v25
    v_add_f32 v66, v66, v22
    v_fma_f32 v66, v66, v146, v20
    v_and_b32 v20, 0xffff0000, v25
    v_add_f32 v67, v67, v22
    v_fma_f32 v67, v67, v147, v20
    v_cvt_pk_bf16_f32 v41, v66, v67
    v_lshlrev_b32 v20, 16, v28
    v_add_f32 v68, v68, v22
    v_fma_f32 v68, v68, v148, v20
    v_and_b32 v20, 0xffff0000, v28
    v_add_f32 v69, v69, v22
    v_fma_f32 v69, v69, v149, v20
    v_cvt_pk_bf16_f32 v44, v68, v69
    v_lshlrev_b32 v20, 16, v29
    v_add_f32 v70, v70, v22
    v_fma_f32 v70, v70, v150, v20
    v_and_b32 v20, 0xffff0000, v29
    v_add_f32 v71, v71, v22
    v_fma_f32 v71, v71, v151, v20
    v_cvt_pk_bf16_f32 v45, v70, v71
    v_lshlrev_b32 v20, 16, v32
    v_add_f32 v72, v72, v22
    v_fma_f32 v72, v72, v152, v20
    v_and_b32 v20, 0xffff0000, v32
    v_add_f32 v73, v73, v22
    v_fma_f32 v73, v73, v153, v20
    v_cvt_pk_bf16_f32 v48, v72, v73
    v_lshlrev_b32 v20, 16, v33
    v_add_f32 v74, v74, v22
    v_fma_f32 v74, v74, v154, v20
    v_and_b32 v20, 0xffff0000, v33
    v_add_f32 v75, v75, v22
    v_fma_f32 v75, v75, v155, v20
    v_cvt_pk_bf16_f32 v49, v74, v75
    v_lshlrev_b32 v20, 16, v36
    v_add_f32 v76, v76, v22
    v_fma_f32 v76, v76, v156, v20
    v_and_b32 v20, 0xffff0000, v36
    v_add_f32 v77, v77, v22
    v_fma_f32 v77, v77, v157, v20
    v_cvt_pk_bf16_f32 v52, v76, v77
    v_lshlrev_b32 v20, 16, v37
    v_add_f32 v78, v78, v22
    v_fma_f32 v78, v78, v158, v20
    v_and_b32 v20, 0xffff0000, v37
    v_add_f32 v79, v79, v22
    v_fma_f32 v79, v79, v159, v20
    v_cvt_pk_bf16_f32 v53, v78, v79
    v_lshlrev_b32 v20, 16, v26
    v_add_f32 v80, v80, v22
    v_fma_f32 v80, v80, v160, v20
    v_and_b32 v20, 0xffff0000, v26
    v_add_f32 v81, v81, v22
    v_fma_f32 v81, v81, v161, v20
    v_cvt_pk_bf16_f32 v42, v80, v81
    v_lshlrev_b32 v20, 16, v27
    v_add_f32 v82, v82, v22
    v_fma_f32 v82, v82, v162, v20
    v_and_b32 v20, 0xffff0000, v27
    v_add_f32 v83, v83, v22
    v_fma_f32 v83, v83, v163, v20
    v_cvt_pk_bf16_f32 v43, v82, v83
    v_lshlrev_b32 v20, 16, v30
    v_add_f32 v84, v84, v22
    v_fma_f32 v84, v84, v164, v20
    v_and_b32 v20, 0xffff0000, v30
    v_add_f32 v85, v85, v22
    v_fma_f32 v85, v85, v165, v20
    v_cvt_pk_bf16_f32 v46, v84, v85
    v_lshlrev_b32 v20, 16, v31
    v_add_f32 v86, v86, v22
    v_fma_f32 v86, v86, v166, v20
    v_and_b32 v20, 0xffff0000, v31
    v_add_f32 v87, v87, v22
    v_fma_f32 v87, v87, v167, v20
    v_cvt_pk_bf16_f32 v47, v86, v87
    v_lshlrev_b32 v20, 16, v34
    v_add_f32 v88, v88, v22
    v_fma_f32 v88, v88, v168, v20
    v_and_b32 v20, 0xffff0000, v34
    v_add_f32 v89, v89, v22
    v_fma_f32 v89, v89, v169, v20
    v_cvt_pk_bf16_f32 v50, v88, v89
    v_lshlrev_b32 v20, 16, v35
    v_add_f32 v90, v90, v22
    v_fma_f32 v90, v90, v170, v20
    v_and_b32 v20, 0xffff0000, v35
    v_add_f32 v91, v91, v22
    v_fma_f32 v91, v91, v171, v20
    v_cvt_pk_bf16_f32 v51, v90, v91
    v_lshlrev_b32 v20, 16, v38
    v_add_f32 v92, v92, v22
    v_fma_f32 v92, v92, v172, v20
    v_and_b32 v20, 0xffff0000, v38
    v_add_f32 v93, v93, v22
    v_fma_f32 v93, v93, v173, v20
    v_cvt_pk_bf16_f32 v54, v92, v93
    v_lshlrev_b32 v20, 16, v39
    v_add_f32 v94, v94, v22
    v_fma_f32 v94, v94, v174, v20
    v_and_b32 v20, 0xffff0000, v39
    v_add_f32 v95, v95, v22
    v_fma_f32 v95, v95, v175, v20
    v_cvt_pk_bf16_f32 v55, v94, v95
    v_permlane32_swap_b32 v40, v42
    v_permlane32_swap_b32 v41, v43
    buffer_store_dwordx4 v[40:43], v21, s[64:67], s96 offen offset:0
    v_permlane32_swap_b32 v44, v46
    v_permlane32_swap_b32 v45, v47
    buffer_store_dwordx4 v[44:47], v21, s[64:67], s96 offen offset:16
    v_permlane32_swap_b32 v48, v50
    v_permlane32_swap_b32 v49, v51
    buffer_store_dwordx4 v[48:51], v21, s[64:67], s96 offen offset:32
    v_permlane32_swap_b32 v52, v54
    v_permlane32_swap_b32 v53, v55
    buffer_store_dwordx4 v[52:55], v21, s[64:67], s96 offen offset:48
    s_waitcnt vmcnt(0)
    s_cmp_eq_u32 s75, 1
    s_mov_b32 s75, 0
    s_barrier
    s_cbranch_scc1 W_back_71
mega_kernel_exit:
    s_endpgm
.section .rodata,"a"
.p2align 6
.amdhsa_kernel mega_kernel
  .amdhsa_next_free_vgpr 512
  .amdhsa_next_free_sgpr 102
  .amdhsa_accum_offset 256
  .amdhsa_group_segment_fixed_size 0
  .amdhsa_kernarg_size 136
  .amdhsa_user_sgpr_count 2
  .amdhsa_user_sgpr_kernarg_segment_ptr 1
  .amdhsa_system_sgpr_workgroup_id_x 1
.end_amdhsa_kernel
```
